```python
import torch

def _softmax(x, axis=-1):
    return torch.softmax(x, dim=axis)
def _gelu(x):
    return torch.nn.functional.gelu(x, approximate="tanh")
def _silu(x):
    return torch.nn.functional.silu(x)
def _sigmoid(x):
    return torch.sigmoid(x)
def _layernorm(x, axis=-1, eps=1e-5):
    m = x.mean(dim=axis, keepdim=True)
    v = x.var(dim=axis, keepdim=True, unbiased=False)
    return (x - m) / torch.sqrt(v + eps)
def _scatter_add(tgt, idx, src, axis=0):
    return tgt.clone().index_add_(axis, idx, src)
def _segment_sum(src, seg, n):
    out = torch.zeros((n,) + src.shape[1:], dtype=src.dtype)
    return out.index_add_(0, seg, src)
def _pad(x, pw):
    flat = tuple(v for pair in reversed(pw) for v in pair)
    return torch.nn.functional.pad(x, flat)

kernel_name = 'parallel_sum__sliding_block__mixer_channel_mlp__prompt'

def setup_inputs():

    _w = (lambda a: (lambda t: t.to(torch.bfloat16) if t.is_floating_point() else t)(torch.as_tensor(a)))
    def _A_setup():
        B, S, D = 1, 2048, 640
        return {
            "x": _w((lambda *s: torch.randn(*s, dtype=torch.bfloat16) * 0.05)(B, S, D)),
            "wqkv": _w((lambda *s: torch.randn(*s, dtype=torch.bfloat16) * 0.05)(D, 3 * D)),
            "wo": _w((lambda *s: torch.randn(*s, dtype=torch.bfloat16) * 0.05)(D, D)),
        }
    _A_in = _A_setup()

    def _B_setup():
        B, S, D, F = 1, 2048, 640, 1728
        return {
            "x": _w((lambda *s: torch.randn(*s, dtype=torch.bfloat16) * 0.05)(B, S, D)),
            "w1": _w((lambda *s: torch.randn(*s, dtype=torch.bfloat16) * 3.2)(D, F) * (D ** -0.5)),
            "b1": _w((lambda *s: torch.randn(*s, dtype=torch.bfloat16) * 1.6)(F)),
            "w2": _w((lambda *s: torch.randn(*s, dtype=torch.bfloat16) * 0.2)(F, D) * (F ** -0.5)),
            "b2": _w((lambda *s: torch.randn(*s, dtype=torch.bfloat16) * 0.4)(D)),
        }
    _B_in = _B_setup()

    return {
        "A_x": _A_in["x"],
        "A_wqkv": _A_in["wqkv"],
        "A_wo": _A_in["wo"],
        "B_x": _B_in["x"],
        "B_w1": _B_in["w1"],
        "B_b1": _B_in["b1"],
        "B_w2": _B_in["w2"],
        "B_b2": _B_in["b2"],
    }

def reference(A_x, A_wqkv, A_wo, B_x, B_w1, B_b1, B_w2, B_b2):
    def _A_ref(x, wqkv, wo):
        B, S, D = x.shape
        H = 32; Dh = D // H; W = 256
        qkv = (lambda x, *d: x.permute(*d))((x @ wqkv).reshape(B, S, 3, H, Dh), 2, 0, 3, 1, 4)
        q, k, v = qkv[0], qkv[1], qkv[2]
        scores = torch.einsum("bhqd,bhkd->bhqk", q, k) * (Dh ** -0.5)
        idx = torch.arange(S)
        mask = (idx[:, None] - idx[None, :] >= 0) & (idx[:, None] - idx[None, :] < W)
        scores = torch.where(mask[None, None], scores, -1e9)
        p = _softmax(scores, axis=-1)
        o = torch.einsum("bhqk,bhkd->bhqd", p, v)
        return (lambda x, *d: x.permute(*d))(o, 0, 2, 1, 3).reshape(B, S, D) @ wo

    def _B_ref(x, w1, b1, w2, b2):
        y = _layernorm(x, axis=-1)
        h = _gelu(torch.einsum("bsd,df->bsf", y, w1) + b1)
        return torch.einsum("bsf,fd->bsd", h, w2) + b2

    x = A_x
    xn = _layernorm(x, axis=-1)
    return x + _A_ref(xn, A_wqkv, A_wo) + _B_ref(xn, B_w1, B_b1, B_w2, B_b2)
```

```asm
; @launch grid=(256,1,1) block=(256,1,1) lds=163840
.amdgcn_target "amdgcn-amd-amdhsa--gfx950"
.text
.globl parallel_sum__sliding_block__mixer_channel_mlp__prompt_kernel
.p2align 8
.type parallel_sum__sliding_block__mixer_channel_mlp__prompt_kernel,@function
parallel_sum__sliding_block__mixer_channel_mlp__prompt_kernel:
  s_load_dwordx2 s[4:5], s[0:1], 0
  s_load_dwordx2 s[8:9], s[0:1], 80
  s_load_dwordx2 s[16:17], s[0:1], 8
  s_load_dwordx16 s[64:79], s[0:1], 16
  s_cmp_ge_u32 s2, 256
  s_cbranch_scc1 L_end
  s_getpc_b64 s[48:49]
L_pc:
  s_mov_b32 s50, L_end-L_pc
  s_mov_b32 s51, 0x00020000
  v_lshlrev_b32 v186, 4, v0
  s_lshr_b32 s44, s2, 3
  s_lshl_b32 s44, s44, 12
  v_lshrrev_b32 v1, 6, v0
  v_and_b32 v0, 63, v0
  v_readfirstlane_b32 s3, v1
  v_and_b32 v2, 7, v0
  v_lshrrev_b32 v3, 3, v0
  s_lshl_b32 s52, s2, 3
  v_add_u32 v164, s52, v2
  v_mul_u32_u24 v164, 1280, v164
  v_lshl_add_u32 v164, v3, 4, v164
  s_lshl_b32 s53, s3, 7
  s_add_u32 s54, s53, 1024
  s_cmp_lt_u32 s3, 2
  s_cselect_b32 s54, s54, 1073741824
  s_mov_b32 s6, 2621440
  s_mov_b32 s7, 0x00020000
  s_mov_b32 s10, 0x10000000
  s_mov_b32 s11, 0x00020000
  s_mov_b32 s18, 2457600
  s_mov_b32 s19, 0x00020000
  s_and_b32 s40, s2, 7
  s_lshr_b32 s41, s2, 3
  s_waitcnt lgkmcnt(0)
  buffer_load_dwordx4 v[128:131], v164, s[4:7], s53 offen
  buffer_load_dwordx4 v[132:135], v164, s[4:7], s53 offen offset:512
  buffer_load_dwordx4 v[136:139], v164, s[4:7], s54 offen
  buffer_load_dwordx4 v[186:189], v186, s[48:51], s44 offen
  s_mov_b32 s12, s68
  s_mov_b32 s13, s69
  s_mov_b32 s14, 2211840
  s_mov_b32 s15, 0x00020000
  s_mov_b32 s32, s70
  s_mov_b32 s33, s71
  s_mov_b32 s34, 3456
  s_mov_b32 s35, 0x00020000
  s_mov_b32 s24, s74
  s_mov_b32 s25, s75
  s_mov_b32 s26, 1280
  s_mov_b32 s27, 0x00020000
  s_mov_b32 s20, s76
  s_mov_b32 s21, s77
  s_mov_b32 s22, 2621440
  s_mov_b32 s23, 0x00020000
  s_mul_i32 s84, s2, 3
  s_add_u32 s84, s84, s3
  s_cmp_lt_u32 s3, 3
  s_cselect_b32 s84, s84, 1000
  s_mul_i32 s85, s84, 6554
  s_lshr_b32 s85, s85, 16
  s_cmp_lt_u32 s85, 54
  s_cselect_b32 s28, s72, s64
  s_cselect_b32 s29, s73, s65
  s_mov_b32 s30, 819200
  s_cmov_b32 s30, 2211840
  s_mov_b32 s31, 0x00020000
  s_cselect_b32 s87, 0, 54
  s_and_b32 s62, s40, 1
  s_lshl_b32 s62, s62, 3
  s_and_b32 s72, s41, 7
  s_add_u32 s62, s62, s72
  s_lshr_b32 s63, s40, 1
  s_lshr_b32 s44, s41, 3
  s_lshl_b32 s45, s44, 2
  s_add_u32 s63, s63, s45
  s_lshl_b32 s93, s63, 1
  s_sub_u32 s93, s93, 5
  s_add_u32 s45, s63, 1
  s_cmp_lt_u32 s63, 6
  s_cselect_b32 s93, s45, s93
  s_cmp_lt_u32 s63, 4
  s_cselect_b32 s93, s63, s93
  s_mul_i32 s44, s44, 3
  s_mul_i32 s72, s72, 1
  s_add_u32 s72, s72, s44
  s_sub_u32 s44, s72, 10
  s_cmp_ge_u32 s72, 10
  s_cselect_b32 s72, s44, s72
  s_lshl_b32 s44, s63, 8
  s_mul_i32 s45, s3, 61440
  s_add_u32 s44, s44, s45
  s_cmp_lt_u32 s63, 15
  s_cselect_b32 s65, s44, 1073741824
  s_lshl_b32 s69, s3, 12
  v_bfe_u32 v4, v0, 2, 2
  v_and_b32 v5, 3, v0
  v_lshrrev_b32 v6, 4, v0
  v_mul_u32_u24 v104, 3840, v4
  v_lshl_add_u32 v104, v6, 6, v104
  v_lshl_add_u32 v104, v5, 4, v104
  v_add_u32 v65, 14336, v104
  v_add_u32 v66, 28672, v104
  v_add_u32 v67, 43008, v104
  s_add_u32 s55, s72, 0
  s_sub_u32 s68, s55, 10
  s_cmp_ge_u32 s55, 10
  s_cselect_b32 s55, s68, s55
  s_mul_i32 s55, s55, 245760
  s_add_u32 m0, s69, 0
  s_add_u32 s55, s55, s65
  buffer_load_dwordx4 v104, s[16:19], s55 offen offset:0 lds
  buffer_load_dwordx4 v65, s[16:19], s55 offen offset:1024 lds
  buffer_load_dwordx4 v66, s[16:19], s55 offen offset:2048 lds
  buffer_load_dwordx4 v67, s[16:19], s55 offen offset:3072 lds
  v_mov_b32 v1, 0
  s_mov_b32 s44, 23494656
  s_and_b32 s45, s3, 1
  s_lshl_b32 s45, s45, 6
  v_add_u32 v127, s45, v0
  v_lshlrev_b32 v7, 1, v127
  s_lshl_b32 s45, s93, 7
  buffer_load_dword v38, v1, s[8:11], s44 offen sc1
  buffer_load_ushort v126, v7, s[32:35], s45 offen
  s_and_b32 s44, s41, 7
  s_mul_i32 s43, s44, 160
  s_mov_b32 m0, 162304
  v_lshlrev_b32 v35, 4, v0
  buffer_load_dwordx4 v35, s[24:27], s43 offen lds
  s_cmp_eq_u32 s3, 0
  s_cselect_b32 s44, 0, 1073741824
  v_mov_b32 v1, 1073741824
  v_mov_b32 v7, s44
  v_cmp_eq_u32 vcc, 0, v0
  s_nop 1
  v_cndmask_b32 v36, v1, v7, vcc
  s_mul_i32 s86, s85, 10
  s_sub_u32 s86, s84, s86
  s_sub_u32 s87, s85, s87
  s_mul_i32 s87, s87, 40960
  s_lshl_b32 s45, s86, 7
  s_add_u32 s87, s87, s45
  s_cmp_lt_u32 s84, 740
  s_cselect_b32 s87, s87, 1073741824
  v_lshlrev_b32 v127, 2, v127
  v_add_u32 v127, 131072, v127
  v_lshrrev_b32 v64, 3, v0
  v_mul_u32_u24 v64, 1280, v64
  v_and_b32 v1, 7, v0
  v_lshl_add_u32 v64, v1, 4, v64
  v_lshlrev_b32 v165, 9, v3
  v_lshl_add_u32 v165, v2, 4, v165
  s_lshr_b32 s52, s2, 2
  s_mul_i32 s52, s52, 40960
  s_and_b32 s53, s2, 3
  s_lshl_b32 s53, s53, 7
  s_add_u32 s52, s52, s53
  s_add_u32 s52, s52, s69
  s_add_u32 s53, s52, 16384
  s_add_u32 s54, s52, 32768
  s_cmp_lt_u32 s3, 2
  s_cselect_b32 s54, s54, 1073741824
  v_lshlrev_b32 v170, 3, v2
  v_add_u32 v170, 131584, v170
  s_lshl_b32 s55, s3, 6
  v_add_u32 v171, s55, v170
  v_lshlrev_b32 v164, 2, v2
  v_cmp_lt_u32 vcc, 7, v0
  v_mov_b32 v1, 1073741824
  s_nop 0
  v_cndmask_b32 v164, v164, v1, vcc
  s_lshl_b32 s55, s2, 5
  s_add_u32 s55, s55, 2621440
  s_cmp_eq_u32 s3, 0
  s_cselect_b32 s55, s55, 1073741824
  v_lshlrev_b32 v35, 4, v0
  s_lshl_b32 s64, s62, 2
  s_add_u32 s64, s64, s3
  s_lshr_b32 s44, s3, 1
  s_add_u32 s97, s72, s44
  s_sub_u32 s44, s97, 10
  s_cmp_ge_u32 s97, 10
  s_cselect_b32 s97, s44, s97
  s_lshl_b32 s44, s93, 7
  s_and_b32 s45, s3, 1
  s_mul_i32 s45, s45, 110592
  s_add_u32 s66, s44, s45
  s_add_u32 s44, s66, 128
  s_mov_b32 s45, 0x37
  s_bitcmp0_b32 s45, s63
  s_cselect_b32 s67, s44, 1073741824
  v_lshrrev_b32 v7, 5, v0
  v_lshl_add_u32 v105, v7, 2, v4
  v_mul_u32_u24 v105, 3456, v105
  v_and_b32 v1, 1, v6
  v_lshl_add_u32 v105, v1, 6, v105
  v_lshl_add_u32 v105, v5, 4, v105
  v_lshlrev_b32 v124, 10, v6
  v_lshl_add_u32 v124, v4, 7, v124
  v_lshl_add_u32 v124, v5, 3, v124
  s_add_u32 s44, s69, 132096
  v_add_u32 v124, s44, v124
  v_lshlrev_b32 v4, 6, v4
  v_lshl_add_u32 v4, v1, 5, v4
  v_lshrrev_b32 v1, 1, v5
  v_and_b32 v6, 1, v5
  v_lshl_add_u32 v1, v6, 1, v1
  v_lshl_add_u32 v6, v1, 3, v4
  v_lshl_add_u32 v1, v5, 3, v4
  v_lshl_add_u32 v102, v7, 10, v6
  v_add_u32 v103, 0x10000, v102
  s_cmp_lt_u32 s63, 10
  s_cselect_b64 vcc, -1, 0
  v_cndmask_b32 v1, v1, v6, vcc
  v_lshl_add_u32 v100, v7, 11, v1
  v_add_u32 v101, 0x10000, v100
  v_and_b32 v125, 31, v0
  v_lshlrev_b32 v1, 5, v125
  v_lshl_add_u32 v1, v7, 4, v1
  v_cndmask_b32 v106, v1, v35, vcc
  s_mul_i32 s44, s64, 160
  s_lshl_b32 s45, s63, 4
  s_add_u32 s44, s44, s45
  s_lshl_b32 s44, s44, 9
  s_add_u32 s44, s44, 2686976
  s_mul_i32 s71, s64, 40960
  s_sub_u32 s46, s63, 10
  s_lshl_b32 s46, s46, 12
  s_add_u32 s45, s71, s46
  s_add_u32 s45, s45, 7929856
  s_cmp_lt_u32 s63, 10
  s_cselect_b32 s44, s44, s45
  s_mov_b32 s45, 20480
  s_cmov_b32 s45, 1024
  s_mov_b32 s46, 1024
  s_cmov_b32 s46, 2048
  s_cmp_lt_u32 s63, 15
  s_cselect_b32 s74, s44, 1073741824
  s_add_u32 s75, s74, s45
  s_add_u32 s76, s74, s46
  s_add_u32 s77, s75, s46
  s_add_u32 s78, s76, s46
  s_add_u32 s79, s77, s46
  s_add_u32 s80, s78, s46
  s_add_u32 s81, s79, s46
  s_cmp_lt_u32 s63, 5
  s_cselect_b32 s70, 0x3ea52b5c, 1.0
  s_mul_i32 s44, s64, 216
  s_lshl_b32 s45, s93, 3
  s_add_u32 s44, s44, s45
  s_lshl_b32 s44, s44, 9
  s_add_u32 s61, s44, 10551296
  s_add_u32 s44, s61, 4096
  s_mov_b32 s45, 0x37
  s_bitcmp0_b32 s45, s63
  s_cselect_b32 s60, s44, 1073741824
  v_mov_b32 v109, 0xbdd2d3e8
  v_mov_b32 v110, 0xc0135761
  v_lshlrev_b32 v108, 5, v7
  v_add_u32 v108, 131072, v108
  s_lshl_b32 s38, s62, 4
  s_add_u32 s38, s38, s63
  s_waitcnt vmcnt(10)
  v_lshlrev_b32 v140, 16, v128
  v_and_b32 v141, 0xffff0000, v128
  v_lshlrev_b32 v142, 16, v129
  v_and_b32 v143, 0xffff0000, v129
  v_lshlrev_b32 v144, 16, v130
  v_and_b32 v145, 0xffff0000, v130
  v_lshlrev_b32 v146, 16, v131
  v_and_b32 v147, 0xffff0000, v131
  v_mov_b32 v166, v140
  v_mul_f32 v167, v140, v140
  v_add_f32 v166, v166, v141
  v_fmac_f32 v167, v141, v141
  v_add_f32 v166, v166, v142
  v_fmac_f32 v167, v142, v142
  v_add_f32 v166, v166, v143
  v_fmac_f32 v167, v143, v143
  v_add_f32 v166, v166, v144
  v_fmac_f32 v167, v144, v144
  v_add_f32 v166, v166, v145
  v_fmac_f32 v167, v145, v145
  v_add_f32 v166, v166, v146
  v_fmac_f32 v167, v146, v146
  v_add_f32 v166, v166, v147
  v_fmac_f32 v167, v147, v147
  s_waitcnt vmcnt(9)
  v_lshlrev_b32 v148, 16, v132
  v_and_b32 v149, 0xffff0000, v132
  v_lshlrev_b32 v150, 16, v133
  v_and_b32 v151, 0xffff0000, v133
  v_lshlrev_b32 v152, 16, v134
  v_and_b32 v153, 0xffff0000, v134
  v_lshlrev_b32 v154, 16, v135
  v_and_b32 v155, 0xffff0000, v135
  v_add_f32 v166, v166, v148
  v_fmac_f32 v167, v148, v148
  v_add_f32 v166, v166, v149
  v_fmac_f32 v167, v149, v149
  v_add_f32 v166, v166, v150
  v_fmac_f32 v167, v150, v150
  v_add_f32 v166, v166, v151
  v_fmac_f32 v167, v151, v151
  v_add_f32 v166, v166, v152
  v_fmac_f32 v167, v152, v152
  v_add_f32 v166, v166, v153
  v_fmac_f32 v167, v153, v153
  v_add_f32 v166, v166, v154
  v_fmac_f32 v167, v154, v154
  v_add_f32 v166, v166, v155
  v_fmac_f32 v167, v155, v155
  s_waitcnt vmcnt(8)
  v_lshlrev_b32 v156, 16, v136
  v_and_b32 v157, 0xffff0000, v136
  v_lshlrev_b32 v158, 16, v137
  v_and_b32 v159, 0xffff0000, v137
  v_lshlrev_b32 v160, 16, v138
  v_and_b32 v161, 0xffff0000, v138
  v_lshlrev_b32 v162, 16, v139
  v_and_b32 v163, 0xffff0000, v139
  v_add_f32 v166, v166, v156
  v_fmac_f32 v167, v156, v156
  v_add_f32 v166, v166, v157
  v_fmac_f32 v167, v157, v157
  v_add_f32 v166, v166, v158
  v_fmac_f32 v167, v158, v158
  v_add_f32 v166, v166, v159
  v_fmac_f32 v167, v159, v159
  v_add_f32 v166, v166, v160
  v_fmac_f32 v167, v160, v160
  v_add_f32 v166, v166, v161
  v_fmac_f32 v167, v161, v161
  v_add_f32 v166, v166, v162
  v_fmac_f32 v167, v162, v162
  v_add_f32 v166, v166, v163
  v_fmac_f32 v167, v163, v163
  s_nop 0
  v_add_f32_dpp v166, v166, v166 row_ror:8 row_mask:0xf bank_mask:0xf
  v_add_f32_dpp v167, v167, v167 row_ror:8 row_mask:0xf bank_mask:0xf
  v_mov_b32 v168, v166
  v_mov_b32 v169, v167
  s_nop 0
  v_permlane16_swap_b32 v168, v166
  v_permlane16_swap_b32 v169, v167
  v_add_f32 v166, v168, v166
  v_add_f32 v167, v169, v167
  v_mov_b32 v168, v166
  v_mov_b32 v169, v167
  s_nop 0
  v_permlane32_swap_b32 v168, v166
  v_permlane32_swap_b32 v169, v167
  v_add_f32 v166, v168, v166
  v_add_f32 v167, v169, v167
  ds_write_b64 v171, v[166:167]
  s_waitcnt lgkmcnt(0)
  s_barrier
  ds_read_b64 v[172:173], v170 offset:0
  ds_read_b64 v[174:175], v170 offset:64
  ds_read_b64 v[176:177], v170 offset:128
  ds_read_b64 v[178:179], v170 offset:192
  s_waitcnt lgkmcnt(0)
  v_add_f32 v172, v172, v174
  v_add_f32 v173, v173, v175
  v_add_f32 v176, v176, v178
  v_add_f32 v177, v177, v179
  v_add_f32 v172, v172, v176
  v_add_f32 v173, v173, v177
  v_mul_f32 v172, 0x3acccccd, v172
  v_mul_f32 v173, 0x3acccccd, v173
  v_fma_f32 v173, -v172, v172, v173
  v_max_f32 v173, 0, v173
  v_cvt_pk_bf16_f32 v174, v173, v173
  v_and_b32 v174, 0xffff0000, v174
  v_add_f32 v174, 0x3727c5ac, v174
  v_cvt_pk_bf16_f32 v174, v174, v174
  v_and_b32 v174, 0xffff0000, v174
  v_sqrt_f32 v174, v174
  s_nop 0
  v_cvt_pk_bf16_f32 v174, v174, v174
  v_and_b32 v174, 0xffff0000, v174
  v_rcp_f32 v174, v174
  s_nop 0
  v_mul_f32 v175, v172, v174
  v_fma_f32 v140, v140, v174, -v175
  v_fma_f32 v141, v141, v174, -v175
  v_fma_f32 v142, v142, v174, -v175
  v_fma_f32 v143, v143, v174, -v175
  v_fma_f32 v144, v144, v174, -v175
  v_fma_f32 v145, v145, v174, -v175
  v_fma_f32 v146, v146, v174, -v175
  v_fma_f32 v147, v147, v174, -v175
  v_cvt_pk_bf16_f32 v128, v140, v141
  v_cvt_pk_bf16_f32 v129, v142, v143
  v_cvt_pk_bf16_f32 v130, v144, v145
  v_cvt_pk_bf16_f32 v131, v146, v147
  buffer_store_dwordx4 v[128:131], v165, s[8:11], s52 offen sc1
  v_fma_f32 v148, v148, v174, -v175
  v_fma_f32 v149, v149, v174, -v175
  v_fma_f32 v150, v150, v174, -v175
  v_fma_f32 v151, v151, v174, -v175
  v_fma_f32 v152, v152, v174, -v175
  v_fma_f32 v153, v153, v174, -v175
  v_fma_f32 v154, v154, v174, -v175
  v_fma_f32 v155, v155, v174, -v175
  v_cvt_pk_bf16_f32 v132, v148, v149
  v_cvt_pk_bf16_f32 v133, v150, v151
  v_cvt_pk_bf16_f32 v134, v152, v153
  v_cvt_pk_bf16_f32 v135, v154, v155
  buffer_store_dwordx4 v[132:135], v165, s[8:11], s53 offen sc1
  v_fma_f32 v156, v156, v174, -v175
  v_fma_f32 v157, v157, v174, -v175
  v_fma_f32 v158, v158, v174, -v175
  v_fma_f32 v159, v159, v174, -v175
  v_fma_f32 v160, v160, v174, -v175
  v_fma_f32 v161, v161, v174, -v175
  v_fma_f32 v162, v162, v174, -v175
  v_fma_f32 v163, v163, v174, -v175
  v_cvt_pk_bf16_f32 v136, v156, v157
  v_cvt_pk_bf16_f32 v137, v158, v159
  v_cvt_pk_bf16_f32 v138, v160, v161
  v_cvt_pk_bf16_f32 v139, v162, v163
  buffer_store_dwordx4 v[136:139], v165, s[8:11], s54 offen sc1
  v_mul_f32 v176, v173, v174
  v_mul_f32 v176, v176, v174
  v_cvt_pk_bf16_f32 v176, v176, v176
  v_and_b32 v176, 0xffff0000, v176
  v_add_f32 v176, 0x3727c5ac, v176
  v_cvt_pk_bf16_f32 v176, v176, v176
  v_and_b32 v176, 0xffff0000, v176
  v_sqrt_f32 v176, v176
  s_nop 0
  v_cvt_pk_bf16_f32 v176, v176, v176
  v_and_b32 v176, 0xffff0000, v176
  v_rcp_f32 v176, v176
  s_nop 0
  buffer_store_dword v176, v164, s[8:11], s55 offen sc1
  s_add_u32 s55, s72, 1
  s_sub_u32 s68, s55, 10
  s_cmp_ge_u32 s55, 10
  s_cselect_b32 s55, s68, s55
  s_mul_i32 s55, s55, 245760
  s_add_u32 m0, s69, 16384
  s_add_u32 s55, s55, s65
  buffer_load_dwordx4 v104, s[16:19], s55 offen offset:0 lds
  s_lshl_b32 s48, s40, 2
  s_and_b32 s44, s41, 3
  s_add_u32 s48, s48, s44
  s_lshr_b32 s49, s41, 2
  s_and_b32 s50, s48, 1
  s_lshr_b32 s51, s48, 1
  s_mul_i32 s51, s51, 5
  s_lshl_b32 s44, s50, 1
  s_add_u32 s51, s51, s44
  s_lshl_b32 s37, s49, 5
  s_add_u32 s37, s37, s48
  s_lshl_b32 s44, s49, 3
  buffer_load_dwordx4 v65, s[16:19], s55 offen offset:1024 lds
  s_lshl_b32 s45, s3, 2
  s_add_u32 s44, s44, s45
  s_sub_u32 s45, s44, 8
  s_cmp_lt_u32 s44, 8
  s_cselect_b32 s44, s44, s45
  s_mul_i32 s32, s44, 160
  s_add_u32 s32, s32, s51
  s_add_u32 s32, s32, 80
  s_lshl_b32 s32, s32, 9
  s_add_u32 s32, s32, 2686976
  s_mul_i32 s33, s44, 40960
  buffer_load_dwordx4 v66, s[16:19], s55 offen offset:2048 lds
  s_mul_i32 s45, s48, 640
  s_add_u32 s33, s33, s45
  s_add_u32 s33, s33, 7929856
  s_lshl_b32 s44, s49, 3
  s_lshl_b32 s45, s3, 1
  s_add_u32 s44, s44, s45
  s_mul_i32 s34, s44, 160
  s_add_u32 s34, s34, s51
  s_lshl_b32 s34, s34, 9
  s_add_u32 s34, s34, 2686976
  s_mul_i32 s35, s44, 80
  s_add_u32 s35, s35, s51
  buffer_load_dwordx4 v67, s[16:19], s55 offen offset:3072 lds
  s_lshl_b32 s35, s35, 9
  s_add_u32 s35, s35, 17629184
  s_sub_u32 s45, 8, s45
  s_cmp_eq_u32 s49, 0
  s_cselect_b32 s36, s45, 0
  s_mov_b32 s58, 0xfffff
  s_mov_b32 s59, 0xfffff
  v_lshrrev_b32 v1, 4, v0
  s_lshl_b32 s44, s49, 1
  s_sub_u32 s44, s44, 2
  s_add_u32 s55, s72, 2
  s_sub_u32 s68, s55, 10
  s_cmp_ge_u32 s55, 10
  s_cselect_b32 s55, s68, s55
  s_mul_i32 s55, s55, 245760
  s_add_u32 m0, s69, 32768
  s_add_u32 s55, s55, s65
  buffer_load_dwordx4 v104, s[16:19], s55 offen offset:0 lds
  v_add_u32 v1, s44, v1
  v_max_i32 v1, 0, v1
  v_and_b32 v4, 15, v0
  v_min_u32 v4, 14, v4
  v_lshl_add_u32 v1, v1, 4, v4
  v_lshlrev_b32 v111, 3, v1
  s_lshl_b32 s44, s50, 9
  v_add_u32 v29, s44, v35
  v_lshlrev_b32 v1, 4, v125
  s_cmp_eq_u32 s50, 0
  s_cselect_b32 s44, 1024, 8
  v_add_u32 v32, s44, v1
  buffer_load_dwordx4 v65, s[16:19], s55 offen offset:1024 lds
  v_mov_b32 v4, 1073741824
  v_cmp_lt_u32 vcc, 31, v0
  s_nop 1
  v_cndmask_b32 v30, v32, v4, vcc
  v_mov_b32 v1, 1.0
  v_cndmask_b32 v34, v1, 0, vcc
  v_mov_b32 v1, 0x3f80
  v_cndmask_b32 v14, v1, 0, vcc
  v_mov_b32 v15, 0
  v_mov_b32 v22, v14
  v_mov_b32 v23, 0
  s_add_u32 s44, s69, 65536
  buffer_load_dwordx4 v66, s[16:19], s55 offen offset:2048 lds
  v_add_u32 v31, s44, v29
  v_add_u32 v32, s44, v32
  v_bfe_u32 v1, v0, 2, 1
  v_bfe_u32 v4, v0, 3, 1
  v_lshl_add_u32 v5, v1, 3, v5
  v_lshl_add_u32 v5, v4, 2, v5
  s_lshl_b32 s44, s50, 2
  v_add_u32 v5, s44, v5
  s_lshl_b32 s44, s50, 4
  v_subrev_u32 v4, s44, v125
  v_cmp_gt_u32 vcc, 16, v125
  s_nop 1
  v_cndmask_b32 v5, v4, v5, vcc
  buffer_load_dwordx4 v67, s[16:19], s55 offen offset:3072 lds
  v_lshlrev_b32 v5, 5, v5
  v_lshl_add_u32 v5, v7, 4, v5
  s_mul_i32 s44, s3, 2560
  s_add_u32 s44, s44, 139264
  v_add_u32 v33, s44, v5
  v_lshlrev_b32 v125, 2, v125
  v_add_u32 v1, 0, v0
  v_mul_u32_u24 v4, 1639, v1
  v_lshrrev_b32 v4, 16, v4
  v_mul_u32_u24 v5, 40, v4
  v_sub_u32 v1, v1, v5
  s_add_u32 s55, s72, 3
  s_sub_u32 s68, s55, 10
  s_cmp_ge_u32 s55, 10
  s_cselect_b32 s55, s68, s55
  s_mul_i32 s55, s55, 245760
  s_add_u32 m0, s69, 49152
  s_add_u32 s55, s55, s65
  buffer_load_dwordx4 v104, s[16:19], s55 offen offset:0 lds
  v_mul_u32_u24 v4, 20480, v4
  v_lshl_add_u32 v24, v1, 4, v4
  v_add_u32 v1, 64, v0
  v_mul_u32_u24 v4, 1639, v1
  v_lshrrev_b32 v4, 16, v4
  v_mul_u32_u24 v5, 40, v4
  v_sub_u32 v1, v1, v5
  v_mul_u32_u24 v4, 20480, v4
  v_lshl_add_u32 v25, v1, 4, v4
  v_subrev_u32 v25, 1024, v25
  v_add_u32 v1, 128, v0
  v_mul_u32_u24 v4, 1639, v1
  buffer_load_dwordx4 v65, s[16:19], s55 offen offset:1024 lds
  v_lshrrev_b32 v4, 16, v4
  v_mul_u32_u24 v5, 40, v4
  v_sub_u32 v1, v1, v5
  v_mul_u32_u24 v4, 20480, v4
  v_lshl_add_u32 v26, v1, 4, v4
  v_subrev_u32 v26, 2048, v26
  v_add_u32 v1, 192, v0
  v_mul_u32_u24 v4, 1639, v1
  v_lshrrev_b32 v4, 16, v4
  v_mul_u32_u24 v5, 40, v4
  v_sub_u32 v1, v1, v5
  buffer_load_dwordx4 v66, s[16:19], s55 offen offset:2048 lds
  v_mul_u32_u24 v4, 20480, v4
  v_lshl_add_u32 v27, v1, 4, v4
  v_subrev_u32 v27, 3072, v27
  v_add_u32 v1, 256, v0
  v_mul_u32_u24 v4, 1639, v1
  v_lshrrev_b32 v4, 16, v4
  v_mul_u32_u24 v5, 40, v4
  v_sub_u32 v1, v1, v5
  v_mul_u32_u24 v4, 20480, v4
  v_lshl_add_u32 v28, v1, 4, v4
  v_mov_b32 v40, 0x3f803f80
  v_mov_b32 v41, 0x3f803f80
  buffer_load_dwordx4 v67, s[16:19], s55 offen offset:3072 lds
  v_mov_b32 v42, 0x3f803f80
  v_mov_b32 v43, 0x3f803f80
  v_mov_b32 v44, 0x3f803f80
  v_mov_b32 v45, 0x3f803f80
  v_mov_b32 v46, 0x3f803f80
  v_mov_b32 v47, 0x3f803f80
  v_mov_b32 v48, 0x3f803f80
  v_mov_b32 v49, 0x3f803f80
  v_mov_b32 v50, 0x3f803f80
  v_mov_b32 v51, 0x3f803f80
  v_mov_b32 v52, 0x3f803f80
  v_mov_b32 v53, 0x3f803f80
  v_mov_b32 v54, 0x3f803f80
  v_mov_b32 v55, 0x3f803f80
  v_mov_b32 v56, 0x3f803f80
  v_mov_b32 v57, 0x3f803f80
  v_mov_b32 v58, 0x3f803f80
  v_mov_b32 v59, 0x3f803f80
  v_mov_b32 v60, 0x3f803f80
  v_mov_b32 v61, 0x3f803f80
  v_mov_b32 v62, 0x3f803f80
  v_mov_b32 v63, 0x3f803f80
  s_waitcnt vmcnt(17)
  v_add_u32 v38, 1, v38
  s_mov_b32 s44, 0x9e3779b1
  v_mul_lo_u32 v39, v38, s44
  v_xor_b32 v39, 0x5bd1e995, v39
  v_lshlrev_b32 v126, 16, v126
  ds_write_b32 v127, v126
  s_waitcnt vmcnt(12)
  s_barrier
  s_lshl_b32 s56, s2, 7
  s_add_u32 s56, s56, 23330816
  buffer_store_dwordx2 v[38:39], v36, s[8:11], s56 offen sc1
  s_add_u32 s55, s72, 4
  s_sub_u32 s68, s55, 10
  s_cmp_ge_u32 s55, 10
  s_cselect_b32 s55, s68, s55
  s_mul_i32 s55, s55, 245760
  s_add_u32 m0, s69, 65536
  s_add_u32 s55, s55, s65
  buffer_load_dwordx4 v104, s[16:19], s55 offen offset:0 lds
  s_lshl_b32 s96, s40, 2
  s_lshr_b32 s44, s41, 3
  s_add_u32 s96, s96, s44
  s_and_b32 s48, s41, 7
  s_mul_i32 s44, s3, 14
  s_cmp_eq_u32 s3, 3
  s_cselect_b32 s45, 1, 0
  buffer_load_dwordx4 v65, s[16:19], s55 offen offset:1024 lds
  s_sub_u32 s44, s44, s45
  s_mul_i32 s46, s48, 74
  s_add_u32 s88, s46, s44
  s_mul_i32 s88, s88, 5120
  buffer_load_dwordx4 v66, s[16:19], s55 offen offset:2048 lds
  s_add_u32 s88, s88, 20250624
  s_mul_i32 s39, s96, 221184
  s_lshl_b32 s45, s44, 11
  s_add_u32 s39, s39, s45
  s_add_u32 s39, s39, 10551296
  buffer_load_dwordx4 v67, s[16:19], s55 offen offset:3072 lds
  s_mul_i32 s44, s3, 5
  s_add_u32 s89, s46, s44
  s_add_u32 s89, s89, 54
  s_mul_i32 s89, s89, 5120
  s_add_u32 s89, s89, 20250624
  s_mul_i32 s42, s96, 81920
  s_add_u32 s55, s72, 5
  s_sub_u32 s68, s55, 10
  s_cmp_ge_u32 s55, 10
  s_cselect_b32 s55, s68, s55
  s_mul_i32 s55, s55, 245760
  s_add_u32 m0, s69, 81920
  s_add_u32 s55, s55, s65
  buffer_load_dwordx4 v104, s[16:19], s55 offen offset:0 lds
  s_lshl_b32 s45, s44, 11
  s_add_u32 s42, s42, s45
  s_add_u32 s42, s42, 17629184
  v_lshrrev_b32 v1, 4, v0
  v_and_b32 v4, 15, v0
  buffer_load_dwordx4 v65, s[16:19], s55 offen offset:1024 lds
  v_lshlrev_b32 v5, 9, v1
  v_lshl_add_u32 v5, v4, 4, v5
  s_lshl_b32 s44, s96, 6
  s_lshl_b32 s45, s3, 4
  s_add_u32 s44, s44, s45
  buffer_load_dwordx4 v66, s[16:19], s55 offen offset:2048 lds
  v_add_u32 v122, s44, v4
  v_mul_u32_u24 v122, 1280, v122
  v_lshlrev_b32 v123, 3, v1
  v_add_u32 v122, v122, v123
  s_lshr_b32 s44, s96, 1
  s_lshl_b32 s44, s44, 4
  buffer_load_dwordx4 v67, s[16:19], s55 offen offset:3072 lds
  v_and_b32 v1, 15, v0
  v_add_u32 v1, s44, v1
  v_lshlrev_b32 v120, 3, v1
  s_lshr_b32 s44, s96, 2
  s_lshl_b32 s44, s44, 5
  s_add_u32 s55, s72, 6
  s_sub_u32 s68, s55, 10
  s_cmp_ge_u32 s55, 10
  s_cselect_b32 s55, s68, s55
  s_mul_i32 s55, s55, 245760
  s_add_u32 m0, s69, 98304
  s_add_u32 s55, s55, s65
  buffer_load_dwordx4 v104, s[16:19], s55 offen offset:0 lds
  v_and_b32 v1, 31, v0
  v_add_u32 v1, s44, v1
  v_lshlrev_b32 v121, 3, v1
  s_add_u32 s44, s3, 0
  s_and_b32 s44, s44, 3
  buffer_load_dwordx4 v65, s[16:19], s55 offen offset:1024 lds
  s_lshr_b32 s45, s44, 1
  s_and_b32 s44, s44, 1
  s_lshl_b32 s44, s44, 8
  s_mul_i32 s46, s45, 110592
  s_add_u32 s46, s46, s44
  buffer_load_dwordx4 v66, s[16:19], s55 offen offset:2048 lds
  v_add_u32 v112, s46, v5
  s_mul_i32 s46, s45, 40960
  s_add_u32 s46, s46, s44
  v_add_u32 v116, s46, v5
  s_add_u32 s44, s3, 1
  s_and_b32 s44, s44, 3
  buffer_load_dwordx4 v67, s[16:19], s55 offen offset:3072 lds
  s_lshr_b32 s45, s44, 1
  s_and_b32 s44, s44, 1
  s_lshl_b32 s44, s44, 8
  s_mul_i32 s46, s45, 110592
  s_add_u32 s46, s46, s44
  s_add_u32 s55, s72, 7
  s_sub_u32 s68, s55, 10
  s_cmp_ge_u32 s55, 10
  s_cselect_b32 s55, s68, s55
  s_mul_i32 s55, s55, 245760
  s_add_u32 m0, s69, 114688
  s_add_u32 s55, s55, s65
  buffer_load_dwordx4 v104, s[16:19], s55 offen offset:0 lds
  v_add_u32 v113, s46, v5
  s_mul_i32 s46, s45, 40960
  s_add_u32 s46, s46, s44
  v_add_u32 v117, s46, v5
  s_add_u32 s44, s3, 2
  buffer_load_dwordx4 v65, s[16:19], s55 offen offset:1024 lds
  s_and_b32 s44, s44, 3
  s_lshr_b32 s45, s44, 1
  s_and_b32 s44, s44, 1
  s_lshl_b32 s44, s44, 8
  s_mul_i32 s46, s45, 110592
  s_add_u32 s46, s46, s44
  buffer_load_dwordx4 v66, s[16:19], s55 offen offset:2048 lds
  v_add_u32 v114, s46, v5
  s_mul_i32 s46, s45, 40960
  s_add_u32 s46, s46, s44
  v_add_u32 v118, s46, v5
  s_add_u32 s44, s3, 3
  buffer_load_dwordx4 v67, s[16:19], s55 offen offset:3072 lds
  s_and_b32 s44, s44, 3
  s_lshr_b32 s45, s44, 1
  s_and_b32 s44, s44, 1
  s_lshl_b32 s44, s44, 8
  s_mul_i32 s46, s45, 110592
  s_add_u32 s46, s46, s44
  v_add_u32 v115, s46, v5
  s_mul_i32 s46, s45, 40960
  s_add_u32 s46, s46, s44
  v_add_u32 v119, s46, v5
  v_and_b32 v1, 15, v0
  v_lshlrev_b32 v1, 7, v1
  s_lshl_b32 s82, s62, 11
  s_add_u32 s82, s82, 23330816
  buffer_load_dwordx2 v[6:7], v1, s[8:11], s82 offen sc1
  s_and_b32 s44, s41, 7
  s_lshl_b32 s44, s44, 2
  s_add_u32 s44, s44, s3
  s_lshl_b32 s46, s93, 7
  s_mul_i32 s45, s44, 69120
  s_add_u32 s54, s45, s46
  v_lshrrev_b32 v4, 4, v0
  v_mul_u32_u24 v4, 3456, v4
  v_and_b32 v5, 15, v0
  v_lshl_add_u32 v4, v5, 4, v4
  s_waitcnt vmcnt(0)
  v_xor_b32 v6, v38, v6
  v_xor_b32 v7, v39, v7
  v_or_b32 v6, v6, v7
  v_cmp_ne_u32 vcc, 0, v6
  s_nop 4
  s_cbranch_vccz L_pok0
  s_mov_b32 s57, 0
L_pspin0:
  s_sleep 1
  buffer_load_dwordx2 v[6:7], v1, s[8:11], s82 offen sc1
  s_add_u32 s57, s57, 1
  s_waitcnt vmcnt(0)
  v_xor_b32 v6, v38, v6
  v_xor_b32 v7, v39, v7
  v_or_b32 v6, v6, v7
  v_cmp_ne_u32 vcc, 0, v6
  s_nop 4
  s_cmp_gt_u32 s57, 100000
  s_cbranch_scc1 L_pok0
  s_cbranch_vccnz L_pspin0
L_pok0:
  s_add_u32 s83, s72, 0
  s_sub_u32 s68, s83, 10
  s_cmp_ge_u32 s83, 10
  s_cselect_b32 s83, s68, s83
  s_lshl_b32 s83, s83, 12
  s_add_u32 s83, s83, s71
  buffer_load_dwordx4 a[0:3], v35, s[8:11], s83 offen offset:0 sc1
  buffer_load_dwordx4 a[4:7], v35, s[8:11], s83 offen offset:1024 sc1
  buffer_load_dwordx4 a[8:11], v35, s[8:11], s83 offen offset:2048 sc1
  buffer_load_dwordx4 a[12:15], v35, s[8:11], s83 offen offset:3072 sc1
  s_add_u32 s83, s72, 1
  s_sub_u32 s68, s83, 10
  s_cmp_ge_u32 s83, 10
  s_cselect_b32 s83, s68, s83
  s_lshl_b32 s83, s83, 12
  s_add_u32 s83, s83, s71
  buffer_load_dwordx4 a[16:19], v35, s[8:11], s83 offen offset:0 sc1
  buffer_load_dwordx4 a[20:23], v35, s[8:11], s83 offen offset:1024 sc1
  buffer_load_dwordx4 a[24:27], v35, s[8:11], s83 offen offset:2048 sc1
  buffer_load_dwordx4 a[28:31], v35, s[8:11], s83 offen offset:3072 sc1
  s_lshl_b32 s44, s64, 7
  s_add_u32 s44, s44, 2621440
  buffer_load_dword v107, v125, s[8:11], s44 offen sc1
  v_add_u32 v1, 26624, v105
  v_add_u32 v2, 53248, v105
  v_add_u32 v3, 79872, v105
  s_waitcnt lgkmcnt(0)
  s_barrier
  ds_read_b64_tr_b16 v[224:225], v100 offset:0
  ds_read_b64_tr_b16 v[226:227], v100 offset:1024
  ds_read_b64_tr_b16 v[228:229], v100 offset:256
  ds_read_b64_tr_b16 v[230:231], v100 offset:1280
  ds_read_b64_tr_b16 v[232:233], v100 offset:512
  ds_read_b64_tr_b16 v[234:235], v100 offset:1536
  ds_read_b64_tr_b16 v[236:237], v100 offset:768
  ds_read_b64_tr_b16 v[238:239], v100 offset:1792
  ds_read_b64_tr_b16 v[240:241], v100 offset:4096
  ds_read_b64_tr_b16 v[242:243], v100 offset:5120
  ds_read_b64_tr_b16 v[244:245], v100 offset:4352
  ds_read_b64_tr_b16 v[246:247], v100 offset:5376
  s_cmp_ge_u32 s63, 10
  s_cbranch_scc1 L_p1v
  s_waitcnt lgkmcnt(8)
  s_waitcnt vmcnt(8)
  v_mfma_f32_32x32x16_bf16 v[128:143], v[224:227], a[0:3], 0
  ds_read_b64_tr_b16 v[248:249], v100 offset:4608
  ds_read_b64_tr_b16 v[250:251], v100 offset:5632
  v_mfma_f32_32x32x16_bf16 v[144:159], v[228:231], a[0:3], 0
  ds_read_b64_tr_b16 v[252:253], v100 offset:4864
  ds_read_b64_tr_b16 v[254:255], v100 offset:5888
  s_add_u32 s83, s72, 2
  s_sub_u32 s68, s83, 10
  s_cmp_ge_u32 s83, 10
  s_cselect_b32 s83, s68, s83
  s_lshl_b32 s83, s83, 12
  s_add_u32 s83, s83, s71
  buffer_load_dwordx4 a[32:35], v35, s[8:11], s83 offen offset:0 sc1
  s_waitcnt lgkmcnt(8)
  v_mfma_f32_32x32x16_bf16 v[160:175], v[232:235], a[0:3], 0
  ds_read_b64_tr_b16 v[224:225], v100 offset:8192
  ds_read_b64_tr_b16 v[226:227], v100 offset:9216
  v_mfma_f32_32x32x16_bf16 v[176:191], v[236:239], a[0:3], 0
  ds_read_b64_tr_b16 v[228:229], v100 offset:8448
  ds_read_b64_tr_b16 v[230:231], v100 offset:9472
  buffer_load_dwordx4 a[36:39], v35, s[8:11], s83 offen offset:1024 sc1
  s_waitcnt lgkmcnt(8)
  s_waitcnt vmcnt(9)
  v_mfma_f32_32x32x16_bf16 v[128:143], v[240:243], a[4:7], v[128:143]
  ds_read_b64_tr_b16 v[232:233], v100 offset:8704
  ds_read_b64_tr_b16 v[234:235], v100 offset:9728
  v_mfma_f32_32x32x16_bf16 v[144:159], v[244:247], a[4:7], v[144:159]
  ds_read_b64_tr_b16 v[236:237], v100 offset:8960
  ds_read_b64_tr_b16 v[238:239], v100 offset:9984
  buffer_load_dwordx4 a[40:43], v35, s[8:11], s83 offen offset:2048 sc1
  s_waitcnt lgkmcnt(8)
  v_mfma_f32_32x32x16_bf16 v[160:175], v[248:251], a[4:7], v[160:175]
  ds_read_b64_tr_b16 v[240:241], v100 offset:12288
  ds_read_b64_tr_b16 v[242:243], v100 offset:13312
  v_mfma_f32_32x32x16_bf16 v[176:191], v[252:255], a[4:7], v[176:191]
  ds_read_b64_tr_b16 v[244:245], v100 offset:12544
  ds_read_b64_tr_b16 v[246:247], v100 offset:13568
  buffer_load_dwordx4 a[44:47], v35, s[8:11], s83 offen offset:3072 sc1
  s_waitcnt lgkmcnt(8)
  s_waitcnt vmcnt(10)
  v_mfma_f32_32x32x16_bf16 v[128:143], v[224:227], a[8:11], v[128:143]
  ds_read_b64_tr_b16 v[248:249], v100 offset:12800
  ds_read_b64_tr_b16 v[250:251], v100 offset:13824
  v_mfma_f32_32x32x16_bf16 v[144:159], v[228:231], a[8:11], v[144:159]
  ds_read_b64_tr_b16 v[252:253], v100 offset:13056
  ds_read_b64_tr_b16 v[254:255], v100 offset:14080
  s_waitcnt lgkmcnt(8)
  v_mfma_f32_32x32x16_bf16 v[160:175], v[232:235], a[8:11], v[160:175]
  ds_read_b64_tr_b16 v[224:225], v100 offset:16384
  ds_read_b64_tr_b16 v[226:227], v100 offset:17408
  s_add_u32 s83, s72, 3
  s_sub_u32 s68, s83, 10
  s_cmp_ge_u32 s83, 10
  s_cselect_b32 s83, s68, s83
  s_lshl_b32 s83, s83, 12
  s_add_u32 s83, s83, s71
  buffer_load_dwordx4 a[48:51], v35, s[8:11], s83 offen offset:0 sc1
  v_mfma_f32_32x32x16_bf16 v[176:191], v[236:239], a[8:11], v[176:191]
  ds_read_b64_tr_b16 v[228:229], v100 offset:16640
  ds_read_b64_tr_b16 v[230:231], v100 offset:17664
  s_waitcnt lgkmcnt(8)
  s_waitcnt vmcnt(10)
  v_mfma_f32_32x32x16_bf16 v[128:143], v[240:243], a[12:15], v[128:143]
  ds_read_b64_tr_b16 v[232:233], v100 offset:16896
  ds_read_b64_tr_b16 v[234:235], v100 offset:17920
  buffer_load_dwordx4 a[52:55], v35, s[8:11], s83 offen offset:1024 sc1
  v_mfma_f32_32x32x16_bf16 v[144:159], v[244:247], a[12:15], v[144:159]
  ds_read_b64_tr_b16 v[236:237], v100 offset:17152
  ds_read_b64_tr_b16 v[238:239], v100 offset:18176
  s_waitcnt lgkmcnt(8)
  v_mfma_f32_32x32x16_bf16 v[160:175], v[248:251], a[12:15], v[160:175]
  ds_read_b64_tr_b16 v[240:241], v100 offset:20480
  ds_read_b64_tr_b16 v[242:243], v100 offset:21504
  buffer_load_dwordx4 a[56:59], v35, s[8:11], s83 offen offset:2048 sc1
  v_mfma_f32_32x32x16_bf16 v[176:191], v[252:255], a[12:15], v[176:191]
  ds_read_b64_tr_b16 v[244:245], v100 offset:20736
  ds_read_b64_tr_b16 v[246:247], v100 offset:21760
  s_waitcnt lgkmcnt(8)
  s_waitcnt vmcnt(11)
  v_mfma_f32_32x32x16_bf16 v[128:143], v[224:227], a[16:19], v[128:143]
  ds_read_b64_tr_b16 v[248:249], v100 offset:20992
  ds_read_b64_tr_b16 v[250:251], v100 offset:22016
  v_mfma_f32_32x32x16_bf16 v[144:159], v[228:231], a[16:19], v[144:159]
  ds_read_b64_tr_b16 v[252:253], v100 offset:21248
  ds_read_b64_tr_b16 v[254:255], v100 offset:22272
  buffer_load_dwordx4 a[60:63], v35, s[8:11], s83 offen offset:3072 sc1
  s_waitcnt lgkmcnt(8)
  v_mfma_f32_32x32x16_bf16 v[160:175], v[232:235], a[16:19], v[160:175]
  ds_read_b64_tr_b16 v[224:225], v100 offset:24576
  ds_read_b64_tr_b16 v[226:227], v100 offset:25600
  v_mfma_f32_32x32x16_bf16 v[176:191], v[236:239], a[16:19], v[176:191]
  ds_read_b64_tr_b16 v[228:229], v100 offset:24832
  ds_read_b64_tr_b16 v[230:231], v100 offset:25856
  s_add_u32 s83, s72, 4
  s_sub_u32 s68, s83, 10
  s_cmp_ge_u32 s83, 10
  s_cselect_b32 s83, s68, s83
  s_lshl_b32 s83, s83, 12
  s_add_u32 s83, s83, s71
  buffer_load_dwordx4 a[64:67], v35, s[8:11], s83 offen offset:0 sc1
  s_waitcnt lgkmcnt(8)
  s_waitcnt vmcnt(12)
  v_mfma_f32_32x32x16_bf16 v[128:143], v[240:243], a[20:23], v[128:143]
  ds_read_b64_tr_b16 v[232:233], v100 offset:25088
  ds_read_b64_tr_b16 v[234:235], v100 offset:26112
  v_mfma_f32_32x32x16_bf16 v[144:159], v[244:247], a[20:23], v[144:159]
  ds_read_b64_tr_b16 v[236:237], v100 offset:25344
  ds_read_b64_tr_b16 v[238:239], v100 offset:26368
  buffer_load_dwordx4 a[68:71], v35, s[8:11], s83 offen offset:1024 sc1
  s_waitcnt lgkmcnt(8)
  v_mfma_f32_32x32x16_bf16 v[160:175], v[248:251], a[20:23], v[160:175]
  ds_read_b64_tr_b16 v[240:241], v100 offset:28672
  ds_read_b64_tr_b16 v[242:243], v100 offset:29696
  v_mfma_f32_32x32x16_bf16 v[176:191], v[252:255], a[20:23], v[176:191]
  ds_read_b64_tr_b16 v[244:245], v100 offset:28928
  ds_read_b64_tr_b16 v[246:247], v100 offset:29952
  s_waitcnt lgkmcnt(8)
  s_waitcnt vmcnt(12)
  v_mfma_f32_32x32x16_bf16 v[128:143], v[224:227], a[24:27], v[128:143]
  ds_read_b64_tr_b16 v[248:249], v100 offset:29184
  ds_read_b64_tr_b16 v[250:251], v100 offset:30208
  buffer_load_dwordx4 a[72:75], v35, s[8:11], s83 offen offset:2048 sc1
  v_mfma_f32_32x32x16_bf16 v[144:159], v[228:231], a[24:27], v[144:159]
  ds_read_b64_tr_b16 v[252:253], v100 offset:29440
  ds_read_b64_tr_b16 v[254:255], v100 offset:30464
  s_waitcnt lgkmcnt(8)
  v_mfma_f32_32x32x16_bf16 v[160:175], v[232:235], a[24:27], v[160:175]
  ds_read_b64_tr_b16 v[224:225], v100 offset:32768
  ds_read_b64_tr_b16 v[226:227], v100 offset:33792
  buffer_load_dwordx4 a[76:79], v35, s[8:11], s83 offen offset:3072 sc1
  v_mfma_f32_32x32x16_bf16 v[176:191], v[236:239], a[24:27], v[176:191]
  ds_read_b64_tr_b16 v[228:229], v100 offset:33024
  ds_read_b64_tr_b16 v[230:231], v100 offset:34048
  s_waitcnt lgkmcnt(8)
  s_waitcnt vmcnt(13)
  v_mfma_f32_32x32x16_bf16 v[128:143], v[240:243], a[28:31], v[128:143]
  ds_read_b64_tr_b16 v[232:233], v100 offset:33280
  ds_read_b64_tr_b16 v[234:235], v100 offset:34304
  buffer_load_dwordx4 v[80:83], v4, s[12:15], s54 offen
  s_add_u32 s54, s54, 13824
  v_mfma_f32_32x32x16_bf16 v[144:159], v[244:247], a[28:31], v[144:159]
  ds_read_b64_tr_b16 v[236:237], v100 offset:33536
  ds_read_b64_tr_b16 v[238:239], v100 offset:34560
  s_waitcnt lgkmcnt(8)
  v_mfma_f32_32x32x16_bf16 v[160:175], v[248:251], a[28:31], v[160:175]
  ds_read_b64_tr_b16 v[240:241], v100 offset:36864
  ds_read_b64_tr_b16 v[242:243], v100 offset:37888
  buffer_load_dwordx4 v[80:83], v4, s[12:15], s54 offen
  s_add_u32 s54, s54, 13824
  v_mfma_f32_32x32x16_bf16 v[176:191], v[252:255], a[28:31], v[176:191]
  ds_read_b64_tr_b16 v[244:245], v100 offset:37120
  ds_read_b64_tr_b16 v[246:247], v100 offset:38144
  s_waitcnt lgkmcnt(8)
  s_waitcnt vmcnt(13)
  v_mfma_f32_32x32x16_bf16 v[128:143], v[224:227], a[32:35], v[128:143]
  ds_read_b64_tr_b16 v[248:249], v100 offset:37376
  ds_read_b64_tr_b16 v[250:251], v100 offset:38400
  v_mfma_f32_32x32x16_bf16 v[144:159], v[228:231], a[32:35], v[144:159]
  ds_read_b64_tr_b16 v[252:253], v100 offset:37632
  ds_read_b64_tr_b16 v[254:255], v100 offset:38656
  buffer_load_dwordx4 v[80:83], v4, s[12:15], s54 offen
  s_add_u32 s54, s54, 13824
  s_waitcnt lgkmcnt(8)
  v_mfma_f32_32x32x16_bf16 v[160:175], v[232:235], a[32:35], v[160:175]
  ds_read_b64_tr_b16 v[224:225], v100 offset:40960
  ds_read_b64_tr_b16 v[226:227], v100 offset:41984
  v_mfma_f32_32x32x16_bf16 v[176:191], v[236:239], a[32:35], v[176:191]
  ds_read_b64_tr_b16 v[228:229], v100 offset:41216
  ds_read_b64_tr_b16 v[230:231], v100 offset:42240
  buffer_load_dwordx4 v[80:83], v4, s[12:15], s54 offen
  s_add_u32 s54, s54, 13824
  s_waitcnt lgkmcnt(8)
  s_waitcnt vmcnt(14)
  v_mfma_f32_32x32x16_bf16 v[128:143], v[240:243], a[36:39], v[128:143]
  ds_read_b64_tr_b16 v[232:233], v100 offset:41472
  ds_read_b64_tr_b16 v[234:235], v100 offset:42496
  v_mfma_f32_32x32x16_bf16 v[144:159], v[244:247], a[36:39], v[144:159]
  ds_read_b64_tr_b16 v[236:237], v100 offset:41728
  ds_read_b64_tr_b16 v[238:239], v100 offset:42752
  buffer_load_dwordx4 v[80:83], v4, s[12:15], s54 offen
  s_add_u32 s54, s54, 13824
  s_waitcnt lgkmcnt(8)
  v_mfma_f32_32x32x16_bf16 v[160:175], v[248:251], a[36:39], v[160:175]
  ds_read_b64_tr_b16 v[240:241], v100 offset:45056
  ds_read_b64_tr_b16 v[242:243], v100 offset:46080
  v_mfma_f32_32x32x16_bf16 v[176:191], v[252:255], a[36:39], v[176:191]
  ds_read_b64_tr_b16 v[244:245], v100 offset:45312
  ds_read_b64_tr_b16 v[246:247], v100 offset:46336
  s_waitcnt lgkmcnt(8)
  s_waitcnt vmcnt(14)
  v_mfma_f32_32x32x16_bf16 v[128:143], v[224:227], a[40:43], v[128:143]
  ds_read_b64_tr_b16 v[248:249], v100 offset:45568
  ds_read_b64_tr_b16 v[250:251], v100 offset:46592
  s_add_u32 s83, s72, 5
  s_sub_u32 s68, s83, 10
  s_cmp_ge_u32 s83, 10
  s_cselect_b32 s83, s68, s83
  s_lshl_b32 s83, s83, 12
  s_add_u32 s83, s83, s71
  buffer_load_dwordx4 a[80:83], v35, s[8:11], s83 offen offset:0 sc1
  v_mfma_f32_32x32x16_bf16 v[144:159], v[228:231], a[40:43], v[144:159]
  ds_read_b64_tr_b16 v[252:253], v100 offset:45824
  ds_read_b64_tr_b16 v[254:255], v100 offset:46848
  s_waitcnt lgkmcnt(8)
  v_mfma_f32_32x32x16_bf16 v[160:175], v[232:235], a[40:43], v[160:175]
  ds_read_b64_tr_b16 v[224:225], v100 offset:49152
  ds_read_b64_tr_b16 v[226:227], v100 offset:50176
  buffer_load_dwordx4 a[84:87], v35, s[8:11], s83 offen offset:1024 sc1
  v_mfma_f32_32x32x16_bf16 v[176:191], v[236:239], a[40:43], v[176:191]
  ds_read_b64_tr_b16 v[228:229], v100 offset:49408
  ds_read_b64_tr_b16 v[230:231], v100 offset:50432
  s_waitcnt lgkmcnt(8)
  s_waitcnt vmcnt(15)
  v_mfma_f32_32x32x16_bf16 v[128:143], v[240:243], a[44:47], v[128:143]
  ds_read_b64_tr_b16 v[232:233], v100 offset:49664
  ds_read_b64_tr_b16 v[234:235], v100 offset:50688
  buffer_load_dwordx4 a[88:91], v35, s[8:11], s83 offen offset:2048 sc1
  v_mfma_f32_32x32x16_bf16 v[144:159], v[244:247], a[44:47], v[144:159]
  ds_read_b64_tr_b16 v[236:237], v100 offset:49920
  ds_read_b64_tr_b16 v[238:239], v100 offset:50944
  s_waitcnt lgkmcnt(8)
  v_mfma_f32_32x32x16_bf16 v[160:175], v[248:251], a[44:47], v[160:175]
  ds_read_b64_tr_b16 v[240:241], v100 offset:53248
  ds_read_b64_tr_b16 v[242:243], v100 offset:54272
  buffer_load_dwordx4 a[92:95], v35, s[8:11], s83 offen offset:3072 sc1
  v_mfma_f32_32x32x16_bf16 v[176:191], v[252:255], a[44:47], v[176:191]
  ds_read_b64_tr_b16 v[244:245], v100 offset:53504
  ds_read_b64_tr_b16 v[246:247], v100 offset:54528
  s_waitcnt lgkmcnt(8)
  s_waitcnt vmcnt(16)
  v_mfma_f32_32x32x16_bf16 v[128:143], v[224:227], a[48:51], v[128:143]
  ds_read_b64_tr_b16 v[248:249], v100 offset:53760
  ds_read_b64_tr_b16 v[250:251], v100 offset:54784
  v_mfma_f32_32x32x16_bf16 v[144:159], v[228:231], a[48:51], v[144:159]
  ds_read_b64_tr_b16 v[252:253], v100 offset:54016
  ds_read_b64_tr_b16 v[254:255], v100 offset:55040
  s_add_u32 s83, s72, 6
  s_sub_u32 s68, s83, 10
  s_cmp_ge_u32 s83, 10
  s_cselect_b32 s83, s68, s83
  s_lshl_b32 s83, s83, 12
  s_add_u32 s83, s83, s71
  buffer_load_dwordx4 a[96:99], v35, s[8:11], s83 offen offset:0 sc1
  s_waitcnt lgkmcnt(8)
  v_mfma_f32_32x32x16_bf16 v[160:175], v[232:235], a[48:51], v[160:175]
  ds_read_b64_tr_b16 v[224:225], v100 offset:57344
  ds_read_b64_tr_b16 v[226:227], v100 offset:58368
  v_mfma_f32_32x32x16_bf16 v[176:191], v[236:239], a[48:51], v[176:191]
  ds_read_b64_tr_b16 v[228:229], v100 offset:57600
  ds_read_b64_tr_b16 v[230:231], v100 offset:58624
  buffer_load_dwordx4 a[100:103], v35, s[8:11], s83 offen offset:1024 sc1
  s_waitcnt lgkmcnt(8)
  s_waitcnt vmcnt(17)
  v_mfma_f32_32x32x16_bf16 v[128:143], v[240:243], a[52:55], v[128:143]
  ds_read_b64_tr_b16 v[232:233], v100 offset:57856
  ds_read_b64_tr_b16 v[234:235], v100 offset:58880
  v_mfma_f32_32x32x16_bf16 v[144:159], v[244:247], a[52:55], v[144:159]
  ds_read_b64_tr_b16 v[236:237], v100 offset:58112
  ds_read_b64_tr_b16 v[238:239], v100 offset:59136
  buffer_load_dwordx4 a[104:107], v35, s[8:11], s83 offen offset:2048 sc1
  s_waitcnt lgkmcnt(8)
  v_mfma_f32_32x32x16_bf16 v[160:175], v[248:251], a[52:55], v[160:175]
  ds_read_b64_tr_b16 v[240:241], v100 offset:61440
  ds_read_b64_tr_b16 v[242:243], v100 offset:62464
  v_mfma_f32_32x32x16_bf16 v[176:191], v[252:255], a[52:55], v[176:191]
  ds_read_b64_tr_b16 v[244:245], v100 offset:61696
  ds_read_b64_tr_b16 v[246:247], v100 offset:62720
  s_waitcnt lgkmcnt(8)
  s_waitcnt vmcnt(17)
  v_mfma_f32_32x32x16_bf16 v[128:143], v[224:227], a[56:59], v[128:143]
  ds_read_b64_tr_b16 v[248:249], v100 offset:61952
  ds_read_b64_tr_b16 v[250:251], v100 offset:62976
  buffer_load_dwordx4 a[108:111], v35, s[8:11], s83 offen offset:3072 sc1
  v_mfma_f32_32x32x16_bf16 v[144:159], v[228:231], a[56:59], v[144:159]
  ds_read_b64_tr_b16 v[252:253], v100 offset:62208
  ds_read_b64_tr_b16 v[254:255], v100 offset:63232
  s_waitcnt lgkmcnt(8)
  v_mfma_f32_32x32x16_bf16 v[160:175], v[232:235], a[56:59], v[160:175]
  ds_read_b64_tr_b16 v[224:225], v101 offset:0
  ds_read_b64_tr_b16 v[226:227], v101 offset:1024
  s_add_u32 m0, s69, 132096
  s_add_u32 s45, s87, 0
  buffer_load_dwordx4 v64, s[28:31], s45 offen lds
  v_mfma_f32_32x32x16_bf16 v[176:191], v[236:239], a[56:59], v[176:191]
  ds_read_b64_tr_b16 v[228:229], v101 offset:256
  ds_read_b64_tr_b16 v[230:231], v101 offset:1280
  s_waitcnt lgkmcnt(8)
  s_waitcnt vmcnt(18)
  v_mfma_f32_32x32x16_bf16 v[128:143], v[240:243], a[60:63], v[128:143]
  ds_read_b64_tr_b16 v[232:233], v101 offset:512
  ds_read_b64_tr_b16 v[234:235], v101 offset:1536
  s_add_u32 m0, s69, 133120
  s_add_u32 s45, s87, 10240
  buffer_load_dwordx4 v64, s[28:31], s45 offen lds
  v_mfma_f32_32x32x16_bf16 v[144:159], v[244:247], a[60:63], v[144:159]
  ds_read_b64_tr_b16 v[236:237], v101 offset:768
  ds_read_b64_tr_b16 v[238:239], v101 offset:1792
  s_waitcnt lgkmcnt(8)
  v_mfma_f32_32x32x16_bf16 v[160:175], v[248:251], a[60:63], v[160:175]
  ds_read_b64_tr_b16 v[240:241], v101 offset:4096
  ds_read_b64_tr_b16 v[242:243], v101 offset:5120
  v_mfma_f32_32x32x16_bf16 v[176:191], v[252:255], a[60:63], v[176:191]
  ds_read_b64_tr_b16 v[244:245], v101 offset:4352
  ds_read_b64_tr_b16 v[246:247], v101 offset:5376
  s_add_u32 m0, s69, 134144
  s_add_u32 s45, s87, 20480
  buffer_load_dwordx4 v64, s[28:31], s45 offen lds
  s_waitcnt lgkmcnt(8)
  s_waitcnt vmcnt(19)
  v_mfma_f32_32x32x16_bf16 v[128:143], v[224:227], a[64:67], v[128:143]
  ds_read_b64_tr_b16 v[248:249], v101 offset:4608
  ds_read_b64_tr_b16 v[250:251], v101 offset:5632
  v_mfma_f32_32x32x16_bf16 v[144:159], v[228:231], a[64:67], v[144:159]
  ds_read_b64_tr_b16 v[252:253], v101 offset:4864
  ds_read_b64_tr_b16 v[254:255], v101 offset:5888
  s_add_u32 m0, s69, 135168
  s_add_u32 s45, s87, 30720
  buffer_load_dwordx4 v64, s[28:31], s45 offen lds
  s_waitcnt lgkmcnt(8)
  v_mfma_f32_32x32x16_bf16 v[160:175], v[232:235], a[64:67], v[160:175]
  s_barrier
  ds_read_b64_tr_b16 v[224:225], v101 offset:8192
  ds_read_b64_tr_b16 v[226:227], v101 offset:9216
  v_mfma_f32_32x32x16_bf16 v[176:191], v[236:239], a[64:67], v[176:191]
  ds_read_b64_tr_b16 v[228:229], v101 offset:8448
  ds_read_b64_tr_b16 v[230:231], v101 offset:9472
  s_add_u32 s83, s72, 7
  s_sub_u32 s68, s83, 10
  s_cmp_ge_u32 s83, 10
  s_cselect_b32 s83, s68, s83
  s_lshl_b32 s83, s83, 12
  s_add_u32 s83, s83, s71
  buffer_load_dwordx4 a[112:115], v35, s[8:11], s83 offen offset:0 sc1
  s_waitcnt lgkmcnt(8)
  s_waitcnt vmcnt(20)
  v_mfma_f32_32x32x16_bf16 v[128:143], v[240:243], a[68:71], v[128:143]
  ds_read_b64_tr_b16 v[232:233], v101 offset:8704
  ds_read_b64_tr_b16 v[234:235], v101 offset:9728
  v_mfma_f32_32x32x16_bf16 v[144:159], v[244:247], a[68:71], v[144:159]
  ds_read_b64_tr_b16 v[236:237], v101 offset:8960
  ds_read_b64_tr_b16 v[238:239], v101 offset:9984
  buffer_load_dwordx4 a[116:119], v35, s[8:11], s83 offen offset:1024 sc1
  s_waitcnt lgkmcnt(8)
  v_mfma_f32_32x32x16_bf16 v[160:175], v[248:251], a[68:71], v[160:175]
  ds_read_b64_tr_b16 v[240:241], v101 offset:12288
  ds_read_b64_tr_b16 v[242:243], v101 offset:13312
  v_mfma_f32_32x32x16_bf16 v[176:191], v[252:255], a[68:71], v[176:191]
  ds_read_b64_tr_b16 v[244:245], v101 offset:12544
  ds_read_b64_tr_b16 v[246:247], v101 offset:13568
  s_waitcnt lgkmcnt(8)
  s_waitcnt vmcnt(20)
  v_mfma_f32_32x32x16_bf16 v[128:143], v[224:227], a[72:75], v[128:143]
  ds_read_b64_tr_b16 v[248:249], v101 offset:12800
  ds_read_b64_tr_b16 v[250:251], v101 offset:13824
  buffer_load_dwordx4 a[120:123], v35, s[8:11], s83 offen offset:2048 sc1
  v_mfma_f32_32x32x16_bf16 v[144:159], v[228:231], a[72:75], v[144:159]
  ds_read_b64_tr_b16 v[252:253], v101 offset:13056
  ds_read_b64_tr_b16 v[254:255], v101 offset:14080
  s_waitcnt lgkmcnt(8)
  v_mfma_f32_32x32x16_bf16 v[160:175], v[232:235], a[72:75], v[160:175]
  ds_read_b64_tr_b16 v[224:225], v101 offset:16384
  ds_read_b64_tr_b16 v[226:227], v101 offset:17408
  buffer_load_dwordx4 a[124:127], v35, s[8:11], s83 offen offset:3072 sc1
  v_mfma_f32_32x32x16_bf16 v[176:191], v[236:239], a[72:75], v[176:191]
  ds_read_b64_tr_b16 v[228:229], v101 offset:16640
  ds_read_b64_tr_b16 v[230:231], v101 offset:17664
  s_waitcnt lgkmcnt(8)
  s_waitcnt vmcnt(21)
  v_mfma_f32_32x32x16_bf16 v[128:143], v[240:243], a[76:79], v[128:143]
  ds_read_b64_tr_b16 v[232:233], v101 offset:16896
  ds_read_b64_tr_b16 v[234:235], v101 offset:17920
  s_add_u32 s55, s72, 8
  s_sub_u32 s68, s55, 10
  s_cmp_ge_u32 s55, 10
  s_cselect_b32 s55, s68, s55
  s_mul_i32 s55, s55, 245760
  s_add_u32 m0, s69, 0
  s_add_u32 s55, s55, s65
  buffer_load_dwordx4 v104, s[16:19], s55 offen offset:0 lds
  v_mfma_f32_32x32x16_bf16 v[144:159], v[244:247], a[76:79], v[144:159]
  ds_read_b64_tr_b16 v[236:237], v101 offset:17152
  ds_read_b64_tr_b16 v[238:239], v101 offset:18176
  s_waitcnt lgkmcnt(8)
  v_mfma_f32_32x32x16_bf16 v[160:175], v[248:251], a[76:79], v[160:175]
  ds_read_b64_tr_b16 v[240:241], v101 offset:20480
  ds_read_b64_tr_b16 v[242:243], v101 offset:21504
  v_mfma_f32_32x32x16_bf16 v[176:191], v[252:255], a[76:79], v[176:191]
  ds_read_b64_tr_b16 v[244:245], v101 offset:20736
  ds_read_b64_tr_b16 v[246:247], v101 offset:21760
  buffer_load_dwordx4 v65, s[16:19], s55 offen offset:1024 lds
  s_waitcnt lgkmcnt(8)
  s_waitcnt vmcnt(17)
  v_mfma_f32_32x32x16_bf16 v[128:143], v[224:227], a[80:83], v[128:143]
  ds_read_b64_tr_b16 v[248:249], v101 offset:20992
  ds_read_b64_tr_b16 v[250:251], v101 offset:22016
  s_waitcnt vmcnt(6)
  ds_read_b64_tr_b16 v[192:193], v124 offset:0
  v_mfma_f32_32x32x16_bf16 v[144:159], v[228:231], a[80:83], v[144:159]
  ds_read_b64_tr_b16 v[252:253], v101 offset:21248
  ds_read_b64_tr_b16 v[254:255], v101 offset:22272
  buffer_load_dwordx4 v66, s[16:19], s55 offen offset:2048 lds
  ds_read_b64_tr_b16 v[194:195], v124 offset:512
  s_waitcnt lgkmcnt(10)
  v_mfma_f32_32x32x16_bf16 v[160:175], v[232:235], a[80:83], v[160:175]
  ds_read_b64_tr_b16 v[224:225], v101 offset:24576
  ds_read_b64_tr_b16 v[226:227], v101 offset:25600
  ds_read_b64_tr_b16 v[196:197], v124 offset:32
  ds_read_b64_tr_b16 v[198:199], v124 offset:544
  v_mfma_f32_32x32x16_bf16 v[176:191], v[236:239], a[80:83], v[176:191]
  ds_read_b64_tr_b16 v[228:229], v101 offset:24832
  ds_read_b64_tr_b16 v[230:231], v101 offset:25856
  buffer_load_dwordx4 v67, s[16:19], s55 offen offset:3072 lds
  ds_read_b64_tr_b16 v[200:201], v124 offset:64
  s_waitcnt lgkmcnt(13)
  v_mfma_f32_32x32x16_bf16 v[128:143], v[240:243], a[84:87], v[128:143]
  ds_read_b64_tr_b16 v[232:233], v101 offset:25088
  ds_read_b64_tr_b16 v[234:235], v101 offset:26112
  ds_read_b64_tr_b16 v[202:203], v124 offset:576
  ds_read_b64_tr_b16 v[204:205], v124 offset:96
  v_mfma_f32_32x32x16_bf16 v[144:159], v[244:247], a[84:87], v[144:159]
  ds_read_b64_tr_b16 v[236:237], v101 offset:25344
  ds_read_b64_tr_b16 v[238:239], v101 offset:26368
  ds_read_b64_tr_b16 v[206:207], v124 offset:608
  s_waitcnt lgkmcnt(15)
  v_mfma_f32_32x32x16_bf16 v[160:175], v[248:251], a[84:87], v[160:175]
  ds_read_b64_tr_b16 v[240:241], v101 offset:28672
  ds_read_b64_tr_b16 v[242:243], v101 offset:29696
  s_add_u32 s83, s72, 8
  s_sub_u32 s68, s83, 10
  s_cmp_ge_u32 s83, 10
  s_cselect_b32 s83, s68, s83
  s_lshl_b32 s83, s83, 12
  s_add_u32 s83, s83, s71
  buffer_load_dwordx4 a[128:131], v35, s[8:11], s83 offen offset:0 sc1
  s_lshl_b32 s46, s86, 2
  v_mfma_f32_32x32x16_bf16 v[176:191], v[252:255], a[84:87], v[176:191]
  ds_read_b64_tr_b16 v[244:245], v101 offset:28928
  ds_read_b64_tr_b16 v[246:247], v101 offset:29952
  s_add_u32 s46, s46, 0
  s_mul_i32 s47, s46, 13108
  s_waitcnt lgkmcnt(12)
  v_mfma_f32_32x32x16_bf16 v[128:143], v[224:227], a[88:91], v[128:143]
  ds_read_b64_tr_b16 v[248:249], v101 offset:29184
  ds_read_b64_tr_b16 v[250:251], v101 offset:30208
  buffer_load_dwordx4 a[132:135], v35, s[8:11], s83 offen offset:1024 sc1
  s_lshr_b32 s47, s47, 16
  v_mfma_f32_32x32x16_bf16 v[144:159], v[228:231], a[88:91], v[144:159]
  ds_read_b64_tr_b16 v[252:253], v101 offset:29440
  ds_read_b64_tr_b16 v[254:255], v101 offset:30464
  s_mul_i32 s47, s47, 365
  s_add_u32 s46, s46, s47
  s_waitcnt lgkmcnt(9)
  v_mfma_f32_32x32x16_bf16 v[160:175], v[232:235], a[88:91], v[160:175]
  ds_read_b64_tr_b16 v[224:225], v101 offset:32768
  ds_read_b64_tr_b16 v[226:227], v101 offset:33792
  buffer_load_dwordx4 a[136:139], v35, s[8:11], s83 offen offset:2048 sc1
  s_mul_i32 s47, s85, 5
  v_mfma_f32_32x32x16_bf16 v[176:191], v[236:239], a[88:91], v[176:191]
  ds_read_b64_tr_b16 v[228:229], v101 offset:33024
  ds_read_b64_tr_b16 v[230:231], v101 offset:34048
  s_add_u32 s47, s47, s46
  s_waitcnt lgkmcnt(8)
  v_mfma_f32_32x32x16_bf16 v[128:143], v[240:243], a[92:95], v[128:143]
  ds_read_b64_tr_b16 v[232:233], v101 offset:33280
  ds_read_b64_tr_b16 v[234:235], v101 offset:34304
  buffer_load_dwordx4 a[140:143], v35, s[8:11], s83 offen offset:3072 sc1
  s_lshl_b32 s47, s47, 10
  s_add_u32 s48, s47, 20250624
  v_mfma_f32_32x32x16_bf16 v[144:159], v[244:247], a[92:95], v[144:159]
  ds_read_b64_tr_b16 v[236:237], v101 offset:33536
  ds_read_b64_tr_b16 v[238:239], v101 offset:34560
  s_waitcnt lgkmcnt(8)
  v_mfma_f32_32x32x16_bf16 v[160:175], v[248:251], a[92:95], v[160:175]
  ds_read_b64_tr_b16 v[240:241], v101 offset:36864
  ds_read_b64_tr_b16 v[242:243], v101 offset:37888
  s_cmp_lt_u32 s84, 740
  s_cselect_b32 s48, s48, 1073741824
  s_lshl_b32 s46, s86, 2
  v_mfma_f32_32x32x16_bf16 v[176:191], v[252:255], a[92:95], v[176:191]
  ds_read_b64_tr_b16 v[244:245], v101 offset:37120
  ds_read_b64_tr_b16 v[246:247], v101 offset:38144
  s_add_u32 s55, s72, 9
  s_sub_u32 s68, s55, 10
  s_cmp_ge_u32 s55, 10
  s_cselect_b32 s55, s68, s55
  s_mul_i32 s55, s55, 245760
  s_add_u32 m0, s69, 16384
  s_add_u32 s55, s55, s65
  buffer_load_dwordx4 v104, s[16:19], s55 offen offset:0 lds
  s_add_u32 s46, s46, 1
  s_waitcnt lgkmcnt(8)
  v_mfma_f32_32x32x16_bf16 v[128:143], v[224:227], a[96:99], v[128:143]
  ds_read_b64_tr_b16 v[248:249], v101 offset:37376
  ds_read_b64_tr_b16 v[250:251], v101 offset:38400
  s_mul_i32 s47, s46, 13108
  v_mfma_f32_32x32x16_bf16 v[144:159], v[228:231], a[96:99], v[144:159]
  ds_read_b64_tr_b16 v[252:253], v101 offset:37632
  ds_read_b64_tr_b16 v[254:255], v101 offset:38656
  buffer_load_dwordx4 v65, s[16:19], s55 offen offset:1024 lds
  s_lshr_b32 s47, s47, 16
  s_mul_i32 s47, s47, 365
  s_waitcnt lgkmcnt(8)
  v_mfma_f32_32x32x16_bf16 v[160:175], v[232:235], a[96:99], v[160:175]
  ds_read_b64_tr_b16 v[224:225], v101 offset:40960
  ds_read_b64_tr_b16 v[226:227], v101 offset:41984
  s_add_u32 s46, s46, s47
  v_mfma_f32_32x32x16_bf16 v[176:191], v[236:239], a[96:99], v[176:191]
  ds_read_b64_tr_b16 v[228:229], v101 offset:41216
  ds_read_b64_tr_b16 v[230:231], v101 offset:42240
  buffer_load_dwordx4 v66, s[16:19], s55 offen offset:2048 lds
  s_mul_i32 s47, s85, 5
  s_add_u32 s47, s47, s46
  s_waitcnt lgkmcnt(8)
  v_mfma_f32_32x32x16_bf16 v[128:143], v[240:243], a[100:103], v[128:143]
  ds_read_b64_tr_b16 v[232:233], v101 offset:41472
  ds_read_b64_tr_b16 v[234:235], v101 offset:42496
  s_lshl_b32 s47, s47, 10
  v_mfma_f32_32x32x16_bf16 v[144:159], v[244:247], a[100:103], v[144:159]
  ds_read_b64_tr_b16 v[236:237], v101 offset:41728
  ds_read_b64_tr_b16 v[238:239], v101 offset:42752
  s_add_u32 s49, s47, 20250624
  s_waitcnt lgkmcnt(8)
  v_mfma_f32_32x32x16_bf16 v[160:175], v[248:251], a[100:103], v[160:175]
  ds_read_b64_tr_b16 v[240:241], v101 offset:45056
  ds_read_b64_tr_b16 v[242:243], v101 offset:46080
  buffer_load_dwordx4 v67, s[16:19], s55 offen offset:3072 lds
  s_cmp_lt_u32 s84, 740
  s_cselect_b32 s49, s49, 1073741824
  v_mfma_f32_32x32x16_bf16 v[176:191], v[252:255], a[100:103], v[176:191]
  ds_read_b64_tr_b16 v[244:245], v101 offset:45312
  ds_read_b64_tr_b16 v[246:247], v101 offset:46336
  s_lshl_b32 s46, s86, 2
  s_waitcnt lgkmcnt(8)
  v_mfma_f32_32x32x16_bf16 v[128:143], v[224:227], a[104:107], v[128:143]
  ds_read_b64_tr_b16 v[248:249], v101 offset:45568
  ds_read_b64_tr_b16 v[250:251], v101 offset:46592
  s_add_u32 s83, s72, 9
  s_sub_u32 s68, s83, 10
  s_cmp_ge_u32 s83, 10
  s_cselect_b32 s83, s68, s83
  s_lshl_b32 s83, s83, 12
  s_add_u32 s83, s83, s71
  buffer_load_dwordx4 a[144:147], v35, s[8:11], s83 offen offset:0 sc1
  s_add_u32 s46, s46, 2
  s_mul_i32 s47, s46, 13108
  v_mfma_f32_32x32x16_bf16 v[144:159], v[228:231], a[104:107], v[144:159]
  ds_read_b64_tr_b16 v[252:253], v101 offset:45824
  ds_read_b64_tr_b16 v[254:255], v101 offset:46848
  s_lshr_b32 s47, s47, 16
  s_waitcnt lgkmcnt(8)
  v_mfma_f32_32x32x16_bf16 v[160:175], v[232:235], a[104:107], v[160:175]
  ds_read_b64_tr_b16 v[224:225], v101 offset:49152
  ds_read_b64_tr_b16 v[226:227], v101 offset:50176
  buffer_load_dwordx4 a[148:151], v35, s[8:11], s83 offen offset:1024 sc1
  s_mul_i32 s47, s47, 365
  v_mfma_f32_32x32x16_bf16 v[176:191], v[236:239], a[104:107], v[176:191]
  ds_read_b64_tr_b16 v[228:229], v101 offset:49408
  ds_read_b64_tr_b16 v[230:231], v101 offset:50432
  s_add_u32 s46, s46, s47
  s_mul_i32 s47, s85, 5
  s_waitcnt lgkmcnt(8)
  v_mfma_f32_32x32x16_bf16 v[128:143], v[240:243], a[108:111], v[128:143]
  ds_read_b64_tr_b16 v[232:233], v101 offset:49664
  ds_read_b64_tr_b16 v[234:235], v101 offset:50688
  s_add_u32 s47, s47, s46
  v_mfma_f32_32x32x16_bf16 v[144:159], v[244:247], a[108:111], v[144:159]
  ds_read_b64_tr_b16 v[236:237], v101 offset:49920
  ds_read_b64_tr_b16 v[238:239], v101 offset:50944
  buffer_load_dwordx4 a[152:155], v35, s[8:11], s83 offen offset:2048 sc1
  s_lshl_b32 s47, s47, 10
  s_add_u32 s50, s47, 20250624
  s_waitcnt lgkmcnt(8)
  v_mfma_f32_32x32x16_bf16 v[160:175], v[248:251], a[108:111], v[160:175]
  ds_read_b64_tr_b16 v[240:241], v101 offset:53248
  ds_read_b64_tr_b16 v[242:243], v101 offset:54272
  v_mfma_f32_32x32x16_bf16 v[176:191], v[252:255], a[108:111], v[176:191]
  ds_read_b64_tr_b16 v[244:245], v101 offset:53504
  ds_read_b64_tr_b16 v[246:247], v101 offset:54528
  buffer_load_dwordx4 a[156:159], v35, s[8:11], s83 offen offset:3072 sc1
  s_cmp_lt_u32 s84, 740
  s_cselect_b32 s50, s50, 1073741824
  s_waitcnt lgkmcnt(8)
  s_waitcnt vmcnt(19)
  v_mfma_f32_32x32x16_bf16 v[128:143], v[224:227], a[112:115], v[128:143]
  ds_read_b64_tr_b16 v[248:249], v101 offset:53760
  ds_read_b64_tr_b16 v[250:251], v101 offset:54784
  s_lshl_b32 s46, s86, 2
  s_add_u32 s46, s46, 3
  v_mfma_f32_32x32x16_bf16 v[144:159], v[228:231], a[112:115], v[144:159]
  ds_read_b64_tr_b16 v[252:253], v101 offset:54016
  ds_read_b64_tr_b16 v[254:255], v101 offset:55040
  s_add_u32 s55, s97, 0
  s_sub_u32 s68, s55, 10
  s_cmp_ge_u32 s55, 10
  s_cselect_b32 s55, s68, s55
  s_mul_i32 s55, s55, 221184
  s_add_u32 m0, s69, 32768
  s_add_u32 s55, s55, s66
  buffer_load_dwordx4 v105, s[12:15], s55 offen offset:0 lds
  s_mul_i32 s47, s46, 13108
  s_waitcnt lgkmcnt(8)
  v_mfma_f32_32x32x16_bf16 v[160:175], v[232:235], a[112:115], v[160:175]
  ds_read_b64_tr_b16 v[224:225], v101 offset:57344
  ds_read_b64_tr_b16 v[226:227], v101 offset:58368
  s_lshr_b32 s47, s47, 16
  s_mul_i32 s47, s47, 365
  v_mfma_f32_32x32x16_bf16 v[176:191], v[236:239], a[112:115], v[176:191]
  ds_read_b64_tr_b16 v[228:229], v101 offset:57600
  ds_read_b64_tr_b16 v[230:231], v101 offset:58624
  buffer_load_dwordx4 v1, s[12:15], s55 offen offset:1024 lds
  s_add_u32 s46, s46, s47
  s_waitcnt lgkmcnt(8)
  s_waitcnt vmcnt(20)
  v_mfma_f32_32x32x16_bf16 v[128:143], v[240:243], a[116:119], v[128:143]
  ds_read_b64_tr_b16 v[232:233], v101 offset:57856
  ds_read_b64_tr_b16 v[234:235], v101 offset:58880
  s_mul_i32 s47, s85, 5
  v_mfma_f32_32x32x16_bf16 v[144:159], v[244:247], a[116:119], v[144:159]
  ds_read_b64_tr_b16 v[236:237], v101 offset:58112
  ds_read_b64_tr_b16 v[238:239], v101 offset:59136
  s_add_u32 s47, s47, s46
  s_lshl_b32 s47, s47, 10
  s_waitcnt lgkmcnt(8)
  v_mfma_f32_32x32x16_bf16 v[160:175], v[248:251], a[116:119], v[160:175]
  ds_read_b64_tr_b16 v[240:241], v101 offset:61440
  ds_read_b64_tr_b16 v[242:243], v101 offset:62464
  buffer_load_dwordx4 v2, s[12:15], s55 offen offset:2048 lds
  s_add_u32 s51, s47, 20250624
  v_mfma_f32_32x32x16_bf16 v[176:191], v[252:255], a[116:119], v[176:191]
  ds_read_b64_tr_b16 v[244:245], v101 offset:61696
  ds_read_b64_tr_b16 v[246:247], v101 offset:62720
  s_cmp_lt_u32 s84, 740
  s_cselect_b32 s51, s51, 1073741824
  s_waitcnt lgkmcnt(8)
  s_waitcnt vmcnt(20)
  v_mfma_f32_32x32x16_bf16 v[128:143], v[224:227], a[120:123], v[128:143]
  ds_read_b64_tr_b16 v[248:249], v101 offset:61952
  ds_read_b64_tr_b16 v[250:251], v101 offset:62976
  buffer_load_dwordx4 v3, s[12:15], s55 offen offset:3072 lds
  v_mfma_f32_32x32x16_bf16 v[144:159], v[228:231], a[120:123], v[144:159]
  ds_read_b64_tr_b16 v[252:253], v101 offset:62208
  ds_read_b64_tr_b16 v[254:255], v101 offset:63232
  s_waitcnt lgkmcnt(8)
  v_mfma_f32_32x32x16_bf16 v[160:175], v[232:235], a[120:123], v[160:175]
  s_waitcnt vmcnt(16)
  s_waitcnt vmcnt(8)
  s_barrier
  ds_read_b64_tr_b16 v[224:225], v100 offset:0
  ds_read_b64_tr_b16 v[226:227], v100 offset:1024
  s_add_u32 s55, s97, 2
  s_sub_u32 s68, s55, 10
  s_cmp_ge_u32 s55, 10
  s_cselect_b32 s55, s68, s55
  s_mul_i32 s55, s55, 221184
  s_add_u32 m0, s69, 49152
  s_add_u32 s55, s55, s66
  buffer_load_dwordx4 v105, s[12:15], s55 offen offset:0 lds
  v_mfma_f32_32x32x16_bf16 v[176:191], v[236:239], a[120:123], v[176:191]
  ds_read_b64_tr_b16 v[228:229], v100 offset:256
  ds_read_b64_tr_b16 v[230:231], v100 offset:1280
  s_waitcnt lgkmcnt(8)
  v_mfma_f32_32x32x16_bf16 v[128:143], v[240:243], a[124:127], v[128:143]
  ds_read_b64_tr_b16 v[232:233], v100 offset:512
  ds_read_b64_tr_b16 v[234:235], v100 offset:1536
  v_mfma_f32_32x32x16_bf16 v[144:159], v[244:247], a[124:127], v[144:159]
  ds_read_b64_tr_b16 v[236:237], v100 offset:768
  ds_read_b64_tr_b16 v[238:239], v100 offset:1792
  buffer_load_dwordx4 v1, s[12:15], s55 offen offset:1024 lds
  s_waitcnt lgkmcnt(8)
  v_mfma_f32_32x32x16_bf16 v[160:175], v[248:251], a[124:127], v[160:175]
  ds_read_b64_tr_b16 v[240:241], v100 offset:4096
  ds_read_b64_tr_b16 v[242:243], v100 offset:5120
  v_mfma_f32_32x32x16_bf16 v[176:191], v[252:255], a[124:127], v[176:191]
  ds_read_b64_tr_b16 v[244:245], v100 offset:4352
  ds_read_b64_tr_b16 v[246:247], v100 offset:5376
  buffer_load_dwordx4 v2, s[12:15], s55 offen offset:2048 lds
  s_waitcnt lgkmcnt(8)
  v_mfma_f32_32x32x16_bf16 v[128:143], v[224:227], a[128:131], v[128:143]
  ds_read_b64_tr_b16 v[248:249], v100 offset:4608
  ds_read_b64_tr_b16 v[250:251], v100 offset:5632
  v_mfma_f32_32x32x16_bf16 v[144:159], v[228:231], a[128:131], v[144:159]
  ds_read_b64_tr_b16 v[252:253], v100 offset:4864
  ds_read_b64_tr_b16 v[254:255], v100 offset:5888
  buffer_load_dwordx4 v3, s[12:15], s55 offen offset:3072 lds
  s_waitcnt lgkmcnt(8)
  v_mfma_f32_32x32x16_bf16 v[160:175], v[232:235], a[128:131], v[160:175]
  ds_read_b64_tr_b16 v[224:225], v100 offset:8192
  ds_read_b64_tr_b16 v[226:227], v100 offset:9216
  v_mfma_f32_32x32x16_bf16 v[176:191], v[236:239], a[128:131], v[176:191]
  ds_read_b64_tr_b16 v[228:229], v100 offset:8448
  ds_read_b64_tr_b16 v[230:231], v100 offset:9472
  s_waitcnt lgkmcnt(8)
  v_mfma_f32_32x32x16_bf16 v[128:143], v[240:243], a[132:135], v[128:143]
  ds_read_b64_tr_b16 v[232:233], v100 offset:8704
  ds_read_b64_tr_b16 v[234:235], v100 offset:9728
  buffer_store_dwordx4 v[192:195], v35, s[8:11], s48 offen sc1
  v_mfma_f32_32x32x16_bf16 v[144:159], v[244:247], a[132:135], v[144:159]
  ds_read_b64_tr_b16 v[236:237], v100 offset:8960
  ds_read_b64_tr_b16 v[238:239], v100 offset:9984
  buffer_store_dwordx4 v[196:199], v35, s[8:11], s49 offen sc1
  s_waitcnt lgkmcnt(8)
  v_mfma_f32_32x32x16_bf16 v[160:175], v[248:251], a[132:135], v[160:175]
  ds_read_b64_tr_b16 v[240:241], v100 offset:12288
  ds_read_b64_tr_b16 v[242:243], v100 offset:13312
  buffer_store_dwordx4 v[200:203], v35, s[8:11], s50 offen sc1
  v_mfma_f32_32x32x16_bf16 v[176:191], v[252:255], a[132:135], v[176:191]
  ds_read_b64_tr_b16 v[244:245], v100 offset:12544
  ds_read_b64_tr_b16 v[246:247], v100 offset:13568
  buffer_store_dwordx4 v[204:207], v35, s[8:11], s51 offen sc1
  s_waitcnt lgkmcnt(8)
  v_mfma_f32_32x32x16_bf16 v[128:143], v[224:227], a[136:139], v[128:143]
  ds_read_b64_tr_b16 v[248:249], v100 offset:12800
  ds_read_b64_tr_b16 v[250:251], v100 offset:13824
  s_add_u32 s55, s97, 4
  s_sub_u32 s68, s55, 10
  s_cmp_ge_u32 s55, 10
  s_cselect_b32 s55, s68, s55
  s_mul_i32 s55, s55, 221184
  s_add_u32 m0, s69, 65536
  s_add_u32 s55, s55, s66
  buffer_load_dwordx4 v105, s[12:15], s55 offen offset:0 lds
  v_mfma_f32_32x32x16_bf16 v[144:159], v[228:231], a[136:139], v[144:159]
  ds_read_b64_tr_b16 v[252:253], v100 offset:13056
  ds_read_b64_tr_b16 v[254:255], v100 offset:14080
  s_waitcnt lgkmcnt(8)
  v_mfma_f32_32x32x16_bf16 v[160:175], v[232:235], a[136:139], v[160:175]
  ds_read_b64_tr_b16 v[224:225], v100 offset:16384
  ds_read_b64_tr_b16 v[226:227], v100 offset:17408
  buffer_load_dwordx4 v1, s[12:15], s55 offen offset:1024 lds
  v_mfma_f32_32x32x16_bf16 v[176:191], v[236:239], a[136:139], v[176:191]
  ds_read_b64_tr_b16 v[228:229], v100 offset:16640
  ds_read_b64_tr_b16 v[230:231], v100 offset:17664
  s_waitcnt lgkmcnt(8)
  v_mfma_f32_32x32x16_bf16 v[128:143], v[240:243], a[140:143], v[128:143]
  ds_read_b64_tr_b16 v[232:233], v100 offset:16896
  ds_read_b64_tr_b16 v[234:235], v100 offset:17920
  buffer_load_dwordx4 v2, s[12:15], s55 offen offset:2048 lds
  v_mfma_f32_32x32x16_bf16 v[144:159], v[244:247], a[140:143], v[144:159]
  ds_read_b64_tr_b16 v[236:237], v100 offset:17152
  ds_read_b64_tr_b16 v[238:239], v100 offset:18176
  s_waitcnt lgkmcnt(8)
  v_mfma_f32_32x32x16_bf16 v[160:175], v[248:251], a[140:143], v[160:175]
  ds_read_b64_tr_b16 v[240:241], v100 offset:20480
  ds_read_b64_tr_b16 v[242:243], v100 offset:21504
  buffer_load_dwordx4 v3, s[12:15], s55 offen offset:3072 lds
  v_mfma_f32_32x32x16_bf16 v[176:191], v[252:255], a[140:143], v[176:191]
  ds_read_b64_tr_b16 v[244:245], v100 offset:20736
  ds_read_b64_tr_b16 v[246:247], v100 offset:21760
  s_waitcnt lgkmcnt(8)
  s_waitcnt vmcnt(19)
  v_mfma_f32_32x32x16_bf16 v[128:143], v[224:227], a[144:147], v[128:143]
  ds_read_b64_tr_b16 v[248:249], v100 offset:20992
  ds_read_b64_tr_b16 v[250:251], v100 offset:22016
  v_mfma_f32_32x32x16_bf16 v[144:159], v[228:231], a[144:147], v[144:159]
  ds_read_b64_tr_b16 v[252:253], v100 offset:21248
  ds_read_b64_tr_b16 v[254:255], v100 offset:22272
  s_add_u32 s55, s97, 6
  s_sub_u32 s68, s55, 10
  s_cmp_ge_u32 s55, 10
  s_cselect_b32 s55, s68, s55
  s_mul_i32 s55, s55, 221184
  s_add_u32 m0, s69, 81920
  s_add_u32 s55, s55, s66
  buffer_load_dwordx4 v105, s[12:15], s55 offen offset:0 lds
  s_waitcnt lgkmcnt(8)
  v_mfma_f32_32x32x16_bf16 v[160:175], v[232:235], a[144:147], v[160:175]
  ds_read_b64_tr_b16 v[224:225], v100 offset:24576
  ds_read_b64_tr_b16 v[226:227], v100 offset:25600
  v_mfma_f32_32x32x16_bf16 v[176:191], v[236:239], a[144:147], v[176:191]
  ds_read_b64_tr_b16 v[228:229], v100 offset:24832
  ds_read_b64_tr_b16 v[230:231], v100 offset:25856
  buffer_load_dwordx4 v1, s[12:15], s55 offen offset:1024 lds
  s_waitcnt lgkmcnt(8)
  s_waitcnt vmcnt(20)
  v_mfma_f32_32x32x16_bf16 v[128:143], v[240:243], a[148:151], v[128:143]
  ds_read_b64_tr_b16 v[232:233], v100 offset:25088
  ds_read_b64_tr_b16 v[234:235], v100 offset:26112
  v_mfma_f32_32x32x16_bf16 v[144:159], v[244:247], a[148:151], v[144:159]
  ds_read_b64_tr_b16 v[236:237], v100 offset:25344
  ds_read_b64_tr_b16 v[238:239], v100 offset:26368
  buffer_load_dwordx4 v2, s[12:15], s55 offen offset:2048 lds
  s_waitcnt lgkmcnt(8)
  v_mfma_f32_32x32x16_bf16 v[160:175], v[248:251], a[148:151], v[160:175]
  ds_read_b64_tr_b16 v[240:241], v100 offset:28672
  ds_read_b64_tr_b16 v[242:243], v100 offset:29696
  v_mfma_f32_32x32x16_bf16 v[176:191], v[252:255], a[148:151], v[176:191]
  ds_read_b64_tr_b16 v[244:245], v100 offset:28928
  ds_read_b64_tr_b16 v[246:247], v100 offset:29952
  s_waitcnt lgkmcnt(8)
  s_waitcnt vmcnt(20)
  v_mfma_f32_32x32x16_bf16 v[128:143], v[224:227], a[152:155], v[128:143]
  ds_read_b64_tr_b16 v[248:249], v100 offset:29184
  ds_read_b64_tr_b16 v[250:251], v100 offset:30208
  buffer_load_dwordx4 v3, s[12:15], s55 offen offset:3072 lds
  v_mfma_f32_32x32x16_bf16 v[144:159], v[228:231], a[152:155], v[144:159]
  ds_read_b64_tr_b16 v[252:253], v100 offset:29440
  ds_read_b64_tr_b16 v[254:255], v100 offset:30464
  s_waitcnt lgkmcnt(8)
  v_mfma_f32_32x32x16_bf16 v[160:175], v[232:235], a[152:155], v[160:175]
  s_waitcnt vmcnt(16)
  s_waitcnt vmcnt(12)
  s_barrier
  ds_read_b64_tr_b16 v[224:225], v102 offset:32768
  ds_read_b64_tr_b16 v[226:227], v102 offset:33280
  s_add_u32 s55, s97, 8
  s_sub_u32 s68, s55, 10
  s_cmp_ge_u32 s55, 10
  s_cselect_b32 s55, s68, s55
  s_mul_i32 s55, s55, 221184
  s_add_u32 m0, s69, 98304
  s_add_u32 s55, s55, s66
  buffer_load_dwordx4 v105, s[12:15], s55 offen offset:0 lds
  v_mfma_f32_32x32x16_bf16 v[176:191], v[236:239], a[152:155], v[176:191]
  ds_read_b64_tr_b16 v[228:229], v102 offset:34816
  ds_read_b64_tr_b16 v[230:231], v102 offset:35328
  s_waitcnt lgkmcnt(8)
  v_mfma_f32_32x32x16_bf16 v[128:143], v[240:243], a[156:159], v[128:143]
  ds_read_b64_tr_b16 v[232:233], v102 offset:36864
  ds_read_b64_tr_b16 v[234:235], v102 offset:37376
  buffer_load_dwordx4 v1, s[12:15], s55 offen offset:1024 lds
  v_mfma_f32_32x32x16_bf16 v[144:159], v[244:247], a[156:159], v[144:159]
  ds_read_b64_tr_b16 v[236:237], v102 offset:38912
  ds_read_b64_tr_b16 v[238:239], v102 offset:39424
  s_waitcnt lgkmcnt(8)
  v_mfma_f32_32x32x16_bf16 v[160:175], v[248:251], a[156:159], v[160:175]
  ds_read_b64_tr_b16 v[240:241], v102 offset:40960
  ds_read_b64_tr_b16 v[242:243], v102 offset:41472
  v_mfma_f32_32x32x16_bf16 v[176:191], v[252:255], a[156:159], v[176:191]
  ds_read_b64_tr_b16 v[244:245], v102 offset:43008
  ds_read_b64_tr_b16 v[246:247], v102 offset:43520
  buffer_load_dwordx4 v2, s[12:15], s55 offen offset:2048 lds
  s_branch L_p1j
L_p1v:
  s_waitcnt lgkmcnt(8)
  s_waitcnt vmcnt(8)
  v_mfma_f32_32x32x16_bf16 v[128:143], a[0:3], v[224:227], 0
  ds_read_b64_tr_b16 v[248:249], v100 offset:4608
  ds_read_b64_tr_b16 v[250:251], v100 offset:5632
  v_mfma_f32_32x32x16_bf16 v[144:159], a[0:3], v[228:231], 0
  ds_read_b64_tr_b16 v[252:253], v100 offset:4864
  ds_read_b64_tr_b16 v[254:255], v100 offset:5888
  s_add_u32 s83, s72, 2
  s_sub_u32 s68, s83, 10
  s_cmp_ge_u32 s83, 10
  s_cselect_b32 s83, s68, s83
  s_lshl_b32 s83, s83, 12
  s_add_u32 s83, s83, s71
  buffer_load_dwordx4 a[32:35], v35, s[8:11], s83 offen offset:0 sc1
  s_waitcnt lgkmcnt(8)
  v_mfma_f32_32x32x16_bf16 v[160:175], a[0:3], v[232:235], 0
  ds_read_b64_tr_b16 v[224:225], v100 offset:8192
  ds_read_b64_tr_b16 v[226:227], v100 offset:9216
  v_mfma_f32_32x32x16_bf16 v[176:191], a[0:3], v[236:239], 0
  ds_read_b64_tr_b16 v[228:229], v100 offset:8448
  ds_read_b64_tr_b16 v[230:231], v100 offset:9472
  buffer_load_dwordx4 a[36:39], v35, s[8:11], s83 offen offset:1024 sc1
  s_waitcnt lgkmcnt(8)
  s_waitcnt vmcnt(9)
  v_mfma_f32_32x32x16_bf16 v[128:143], a[4:7], v[240:243], v[128:143]
  ds_read_b64_tr_b16 v[232:233], v100 offset:8704
  ds_read_b64_tr_b16 v[234:235], v100 offset:9728
  v_mfma_f32_32x32x16_bf16 v[144:159], a[4:7], v[244:247], v[144:159]
  ds_read_b64_tr_b16 v[236:237], v100 offset:8960
  ds_read_b64_tr_b16 v[238:239], v100 offset:9984
  buffer_load_dwordx4 a[40:43], v35, s[8:11], s83 offen offset:2048 sc1
  s_waitcnt lgkmcnt(8)
  v_mfma_f32_32x32x16_bf16 v[160:175], a[4:7], v[248:251], v[160:175]
  ds_read_b64_tr_b16 v[240:241], v100 offset:12288
  ds_read_b64_tr_b16 v[242:243], v100 offset:13312
  v_mfma_f32_32x32x16_bf16 v[176:191], a[4:7], v[252:255], v[176:191]
  ds_read_b64_tr_b16 v[244:245], v100 offset:12544
  ds_read_b64_tr_b16 v[246:247], v100 offset:13568
  buffer_load_dwordx4 a[44:47], v35, s[8:11], s83 offen offset:3072 sc1
  s_waitcnt lgkmcnt(8)
  s_waitcnt vmcnt(10)
  v_mfma_f32_32x32x16_bf16 v[128:143], a[8:11], v[224:227], v[128:143]
  ds_read_b64_tr_b16 v[248:249], v100 offset:12800
  ds_read_b64_tr_b16 v[250:251], v100 offset:13824
  v_mfma_f32_32x32x16_bf16 v[144:159], a[8:11], v[228:231], v[144:159]
  ds_read_b64_tr_b16 v[252:253], v100 offset:13056
  ds_read_b64_tr_b16 v[254:255], v100 offset:14080
  s_waitcnt lgkmcnt(8)
  v_mfma_f32_32x32x16_bf16 v[160:175], a[8:11], v[232:235], v[160:175]
  ds_read_b64_tr_b16 v[224:225], v100 offset:16384
  ds_read_b64_tr_b16 v[226:227], v100 offset:17408
  s_add_u32 s83, s72, 3
  s_sub_u32 s68, s83, 10
  s_cmp_ge_u32 s83, 10
  s_cselect_b32 s83, s68, s83
  s_lshl_b32 s83, s83, 12
  s_add_u32 s83, s83, s71
  buffer_load_dwordx4 a[48:51], v35, s[8:11], s83 offen offset:0 sc1
  v_mfma_f32_32x32x16_bf16 v[176:191], a[8:11], v[236:239], v[176:191]
  ds_read_b64_tr_b16 v[228:229], v100 offset:16640
  ds_read_b64_tr_b16 v[230:231], v100 offset:17664
  s_waitcnt lgkmcnt(8)
  s_waitcnt vmcnt(10)
  v_mfma_f32_32x32x16_bf16 v[128:143], a[12:15], v[240:243], v[128:143]
  ds_read_b64_tr_b16 v[232:233], v100 offset:16896
  ds_read_b64_tr_b16 v[234:235], v100 offset:17920
  buffer_load_dwordx4 a[52:55], v35, s[8:11], s83 offen offset:1024 sc1
  v_mfma_f32_32x32x16_bf16 v[144:159], a[12:15], v[244:247], v[144:159]
  ds_read_b64_tr_b16 v[236:237], v100 offset:17152
  ds_read_b64_tr_b16 v[238:239], v100 offset:18176
  s_waitcnt lgkmcnt(8)
  v_mfma_f32_32x32x16_bf16 v[160:175], a[12:15], v[248:251], v[160:175]
  ds_read_b64_tr_b16 v[240:241], v100 offset:20480
  ds_read_b64_tr_b16 v[242:243], v100 offset:21504
  buffer_load_dwordx4 a[56:59], v35, s[8:11], s83 offen offset:2048 sc1
  v_mfma_f32_32x32x16_bf16 v[176:191], a[12:15], v[252:255], v[176:191]
  ds_read_b64_tr_b16 v[244:245], v100 offset:20736
  ds_read_b64_tr_b16 v[246:247], v100 offset:21760
  s_waitcnt lgkmcnt(8)
  s_waitcnt vmcnt(11)
  v_mfma_f32_32x32x16_bf16 v[128:143], a[16:19], v[224:227], v[128:143]
  ds_read_b64_tr_b16 v[248:249], v100 offset:20992
  ds_read_b64_tr_b16 v[250:251], v100 offset:22016
  v_mfma_f32_32x32x16_bf16 v[144:159], a[16:19], v[228:231], v[144:159]
  ds_read_b64_tr_b16 v[252:253], v100 offset:21248
  ds_read_b64_tr_b16 v[254:255], v100 offset:22272
  buffer_load_dwordx4 a[60:63], v35, s[8:11], s83 offen offset:3072 sc1
  s_waitcnt lgkmcnt(8)
  v_mfma_f32_32x32x16_bf16 v[160:175], a[16:19], v[232:235], v[160:175]
  ds_read_b64_tr_b16 v[224:225], v100 offset:24576
  ds_read_b64_tr_b16 v[226:227], v100 offset:25600
  v_mfma_f32_32x32x16_bf16 v[176:191], a[16:19], v[236:239], v[176:191]
  ds_read_b64_tr_b16 v[228:229], v100 offset:24832
  ds_read_b64_tr_b16 v[230:231], v100 offset:25856
  s_add_u32 s83, s72, 4
  s_sub_u32 s68, s83, 10
  s_cmp_ge_u32 s83, 10
  s_cselect_b32 s83, s68, s83
  s_lshl_b32 s83, s83, 12
  s_add_u32 s83, s83, s71
  buffer_load_dwordx4 a[64:67], v35, s[8:11], s83 offen offset:0 sc1
  s_waitcnt lgkmcnt(8)
  s_waitcnt vmcnt(12)
  v_mfma_f32_32x32x16_bf16 v[128:143], a[20:23], v[240:243], v[128:143]
  ds_read_b64_tr_b16 v[232:233], v100 offset:25088
  ds_read_b64_tr_b16 v[234:235], v100 offset:26112
  v_mfma_f32_32x32x16_bf16 v[144:159], a[20:23], v[244:247], v[144:159]
  ds_read_b64_tr_b16 v[236:237], v100 offset:25344
  ds_read_b64_tr_b16 v[238:239], v100 offset:26368
  buffer_load_dwordx4 a[68:71], v35, s[8:11], s83 offen offset:1024 sc1
  s_waitcnt lgkmcnt(8)
  v_mfma_f32_32x32x16_bf16 v[160:175], a[20:23], v[248:251], v[160:175]
  ds_read_b64_tr_b16 v[240:241], v100 offset:28672
  ds_read_b64_tr_b16 v[242:243], v100 offset:29696
  v_mfma_f32_32x32x16_bf16 v[176:191], a[20:23], v[252:255], v[176:191]
  ds_read_b64_tr_b16 v[244:245], v100 offset:28928
  ds_read_b64_tr_b16 v[246:247], v100 offset:29952
  s_waitcnt lgkmcnt(8)
  s_waitcnt vmcnt(12)
  v_mfma_f32_32x32x16_bf16 v[128:143], a[24:27], v[224:227], v[128:143]
  ds_read_b64_tr_b16 v[248:249], v100 offset:29184
  ds_read_b64_tr_b16 v[250:251], v100 offset:30208
  buffer_load_dwordx4 a[72:75], v35, s[8:11], s83 offen offset:2048 sc1
  v_mfma_f32_32x32x16_bf16 v[144:159], a[24:27], v[228:231], v[144:159]
  ds_read_b64_tr_b16 v[252:253], v100 offset:29440
  ds_read_b64_tr_b16 v[254:255], v100 offset:30464
  s_waitcnt lgkmcnt(8)
  v_mfma_f32_32x32x16_bf16 v[160:175], a[24:27], v[232:235], v[160:175]
  ds_read_b64_tr_b16 v[224:225], v100 offset:32768
  ds_read_b64_tr_b16 v[226:227], v100 offset:33792
  buffer_load_dwordx4 a[76:79], v35, s[8:11], s83 offen offset:3072 sc1
  v_mfma_f32_32x32x16_bf16 v[176:191], a[24:27], v[236:239], v[176:191]
  ds_read_b64_tr_b16 v[228:229], v100 offset:33024
  ds_read_b64_tr_b16 v[230:231], v100 offset:34048
  s_waitcnt lgkmcnt(8)
  s_waitcnt vmcnt(13)
  v_mfma_f32_32x32x16_bf16 v[128:143], a[28:31], v[240:243], v[128:143]
  ds_read_b64_tr_b16 v[232:233], v100 offset:33280
  ds_read_b64_tr_b16 v[234:235], v100 offset:34304
  buffer_load_dwordx4 v[80:83], v4, s[12:15], s54 offen
  s_add_u32 s54, s54, 13824
  v_mfma_f32_32x32x16_bf16 v[144:159], a[28:31], v[244:247], v[144:159]
  ds_read_b64_tr_b16 v[236:237], v100 offset:33536
  ds_read_b64_tr_b16 v[238:239], v100 offset:34560
  s_waitcnt lgkmcnt(8)
  v_mfma_f32_32x32x16_bf16 v[160:175], a[28:31], v[248:251], v[160:175]
  ds_read_b64_tr_b16 v[240:241], v100 offset:36864
  ds_read_b64_tr_b16 v[242:243], v100 offset:37888
  buffer_load_dwordx4 v[80:83], v4, s[12:15], s54 offen
  s_add_u32 s54, s54, 13824
  v_mfma_f32_32x32x16_bf16 v[176:191], a[28:31], v[252:255], v[176:191]
  ds_read_b64_tr_b16 v[244:245], v100 offset:37120
  ds_read_b64_tr_b16 v[246:247], v100 offset:38144
  s_waitcnt lgkmcnt(8)
  s_waitcnt vmcnt(13)
  v_mfma_f32_32x32x16_bf16 v[128:143], a[32:35], v[224:227], v[128:143]
  ds_read_b64_tr_b16 v[248:249], v100 offset:37376
  ds_read_b64_tr_b16 v[250:251], v100 offset:38400
  v_mfma_f32_32x32x16_bf16 v[144:159], a[32:35], v[228:231], v[144:159]
  ds_read_b64_tr_b16 v[252:253], v100 offset:37632
  ds_read_b64_tr_b16 v[254:255], v100 offset:38656
  buffer_load_dwordx4 v[80:83], v4, s[12:15], s54 offen
  s_add_u32 s54, s54, 13824
  s_waitcnt lgkmcnt(8)
  v_mfma_f32_32x32x16_bf16 v[160:175], a[32:35], v[232:235], v[160:175]
  ds_read_b64_tr_b16 v[224:225], v100 offset:40960
  ds_read_b64_tr_b16 v[226:227], v100 offset:41984
  v_mfma_f32_32x32x16_bf16 v[176:191], a[32:35], v[236:239], v[176:191]
  ds_read_b64_tr_b16 v[228:229], v100 offset:41216
  ds_read_b64_tr_b16 v[230:231], v100 offset:42240
  buffer_load_dwordx4 v[80:83], v4, s[12:15], s54 offen
  s_add_u32 s54, s54, 13824
  s_waitcnt lgkmcnt(8)
  s_waitcnt vmcnt(14)
  v_mfma_f32_32x32x16_bf16 v[128:143], a[36:39], v[240:243], v[128:143]
  ds_read_b64_tr_b16 v[232:233], v100 offset:41472
  ds_read_b64_tr_b16 v[234:235], v100 offset:42496
  v_mfma_f32_32x32x16_bf16 v[144:159], a[36:39], v[244:247], v[144:159]
  ds_read_b64_tr_b16 v[236:237], v100 offset:41728
  ds_read_b64_tr_b16 v[238:239], v100 offset:42752
  buffer_load_dwordx4 v[80:83], v4, s[12:15], s54 offen
  s_add_u32 s54, s54, 13824
  s_waitcnt lgkmcnt(8)
  v_mfma_f32_32x32x16_bf16 v[160:175], a[36:39], v[248:251], v[160:175]
  ds_read_b64_tr_b16 v[240:241], v100 offset:45056
  ds_read_b64_tr_b16 v[242:243], v100 offset:46080
  v_mfma_f32_32x32x16_bf16 v[176:191], a[36:39], v[252:255], v[176:191]
  ds_read_b64_tr_b16 v[244:245], v100 offset:45312
  ds_read_b64_tr_b16 v[246:247], v100 offset:46336
  s_waitcnt lgkmcnt(8)
  s_waitcnt vmcnt(14)
  v_mfma_f32_32x32x16_bf16 v[128:143], a[40:43], v[224:227], v[128:143]
  ds_read_b64_tr_b16 v[248:249], v100 offset:45568
  ds_read_b64_tr_b16 v[250:251], v100 offset:46592
  s_add_u32 s83, s72, 5
  s_sub_u32 s68, s83, 10
  s_cmp_ge_u32 s83, 10
  s_cselect_b32 s83, s68, s83
  s_lshl_b32 s83, s83, 12
  s_add_u32 s83, s83, s71
  buffer_load_dwordx4 a[80:83], v35, s[8:11], s83 offen offset:0 sc1
  v_mfma_f32_32x32x16_bf16 v[144:159], a[40:43], v[228:231], v[144:159]
  ds_read_b64_tr_b16 v[252:253], v100 offset:45824
  ds_read_b64_tr_b16 v[254:255], v100 offset:46848
  s_waitcnt lgkmcnt(8)
  v_mfma_f32_32x32x16_bf16 v[160:175], a[40:43], v[232:235], v[160:175]
  ds_read_b64_tr_b16 v[224:225], v100 offset:49152
  ds_read_b64_tr_b16 v[226:227], v100 offset:50176
  buffer_load_dwordx4 a[84:87], v35, s[8:11], s83 offen offset:1024 sc1
  v_mfma_f32_32x32x16_bf16 v[176:191], a[40:43], v[236:239], v[176:191]
  ds_read_b64_tr_b16 v[228:229], v100 offset:49408
  ds_read_b64_tr_b16 v[230:231], v100 offset:50432
  s_waitcnt lgkmcnt(8)
  s_waitcnt vmcnt(15)
  v_mfma_f32_32x32x16_bf16 v[128:143], a[44:47], v[240:243], v[128:143]
  ds_read_b64_tr_b16 v[232:233], v100 offset:49664
  ds_read_b64_tr_b16 v[234:235], v100 offset:50688
  buffer_load_dwordx4 a[88:91], v35, s[8:11], s83 offen offset:2048 sc1
  v_mfma_f32_32x32x16_bf16 v[144:159], a[44:47], v[244:247], v[144:159]
  ds_read_b64_tr_b16 v[236:237], v100 offset:49920
  ds_read_b64_tr_b16 v[238:239], v100 offset:50944
  s_waitcnt lgkmcnt(8)
  v_mfma_f32_32x32x16_bf16 v[160:175], a[44:47], v[248:251], v[160:175]
  ds_read_b64_tr_b16 v[240:241], v100 offset:53248
  ds_read_b64_tr_b16 v[242:243], v100 offset:54272
  buffer_load_dwordx4 a[92:95], v35, s[8:11], s83 offen offset:3072 sc1
  v_mfma_f32_32x32x16_bf16 v[176:191], a[44:47], v[252:255], v[176:191]
  ds_read_b64_tr_b16 v[244:245], v100 offset:53504
  ds_read_b64_tr_b16 v[246:247], v100 offset:54528
  s_waitcnt lgkmcnt(8)
  s_waitcnt vmcnt(16)
  v_mfma_f32_32x32x16_bf16 v[128:143], a[48:51], v[224:227], v[128:143]
  ds_read_b64_tr_b16 v[248:249], v100 offset:53760
  ds_read_b64_tr_b16 v[250:251], v100 offset:54784
  v_mfma_f32_32x32x16_bf16 v[144:159], a[48:51], v[228:231], v[144:159]
  ds_read_b64_tr_b16 v[252:253], v100 offset:54016
  ds_read_b64_tr_b16 v[254:255], v100 offset:55040
  s_add_u32 s83, s72, 6
  s_sub_u32 s68, s83, 10
  s_cmp_ge_u32 s83, 10
  s_cselect_b32 s83, s68, s83
  s_lshl_b32 s83, s83, 12
  s_add_u32 s83, s83, s71
  buffer_load_dwordx4 a[96:99], v35, s[8:11], s83 offen offset:0 sc1
  s_waitcnt lgkmcnt(8)
  v_mfma_f32_32x32x16_bf16 v[160:175], a[48:51], v[232:235], v[160:175]
  ds_read_b64_tr_b16 v[224:225], v100 offset:57344
  ds_read_b64_tr_b16 v[226:227], v100 offset:58368
  v_mfma_f32_32x32x16_bf16 v[176:191], a[48:51], v[236:239], v[176:191]
  ds_read_b64_tr_b16 v[228:229], v100 offset:57600
  ds_read_b64_tr_b16 v[230:231], v100 offset:58624
  buffer_load_dwordx4 a[100:103], v35, s[8:11], s83 offen offset:1024 sc1
  s_waitcnt lgkmcnt(8)
  s_waitcnt vmcnt(17)
  v_mfma_f32_32x32x16_bf16 v[128:143], a[52:55], v[240:243], v[128:143]
  ds_read_b64_tr_b16 v[232:233], v100 offset:57856
  ds_read_b64_tr_b16 v[234:235], v100 offset:58880
  v_mfma_f32_32x32x16_bf16 v[144:159], a[52:55], v[244:247], v[144:159]
  ds_read_b64_tr_b16 v[236:237], v100 offset:58112
  ds_read_b64_tr_b16 v[238:239], v100 offset:59136
  buffer_load_dwordx4 a[104:107], v35, s[8:11], s83 offen offset:2048 sc1
  s_waitcnt lgkmcnt(8)
  v_mfma_f32_32x32x16_bf16 v[160:175], a[52:55], v[248:251], v[160:175]
  ds_read_b64_tr_b16 v[240:241], v100 offset:61440
  ds_read_b64_tr_b16 v[242:243], v100 offset:62464
  v_mfma_f32_32x32x16_bf16 v[176:191], a[52:55], v[252:255], v[176:191]
  ds_read_b64_tr_b16 v[244:245], v100 offset:61696
  ds_read_b64_tr_b16 v[246:247], v100 offset:62720
  s_waitcnt lgkmcnt(8)
  s_waitcnt vmcnt(17)
  v_mfma_f32_32x32x16_bf16 v[128:143], a[56:59], v[224:227], v[128:143]
  ds_read_b64_tr_b16 v[248:249], v100 offset:61952
  ds_read_b64_tr_b16 v[250:251], v100 offset:62976
  buffer_load_dwordx4 a[108:111], v35, s[8:11], s83 offen offset:3072 sc1
  v_mfma_f32_32x32x16_bf16 v[144:159], a[56:59], v[228:231], v[144:159]
  ds_read_b64_tr_b16 v[252:253], v100 offset:62208
  ds_read_b64_tr_b16 v[254:255], v100 offset:63232
  s_waitcnt lgkmcnt(8)
  v_mfma_f32_32x32x16_bf16 v[160:175], a[56:59], v[232:235], v[160:175]
  ds_read_b64_tr_b16 v[224:225], v101 offset:0
  ds_read_b64_tr_b16 v[226:227], v101 offset:1024
  s_add_u32 m0, s69, 132096
  s_add_u32 s45, s87, 0
  buffer_load_dwordx4 v64, s[28:31], s45 offen lds
  v_mfma_f32_32x32x16_bf16 v[176:191], a[56:59], v[236:239], v[176:191]
  ds_read_b64_tr_b16 v[228:229], v101 offset:256
  ds_read_b64_tr_b16 v[230:231], v101 offset:1280
  s_waitcnt lgkmcnt(8)
  s_waitcnt vmcnt(18)
  v_mfma_f32_32x32x16_bf16 v[128:143], a[60:63], v[240:243], v[128:143]
  ds_read_b64_tr_b16 v[232:233], v101 offset:512
  ds_read_b64_tr_b16 v[234:235], v101 offset:1536
  s_add_u32 m0, s69, 133120
  s_add_u32 s45, s87, 10240
  buffer_load_dwordx4 v64, s[28:31], s45 offen lds
  v_mfma_f32_32x32x16_bf16 v[144:159], a[60:63], v[244:247], v[144:159]
  ds_read_b64_tr_b16 v[236:237], v101 offset:768
  ds_read_b64_tr_b16 v[238:239], v101 offset:1792
  s_waitcnt lgkmcnt(8)
  v_mfma_f32_32x32x16_bf16 v[160:175], a[60:63], v[248:251], v[160:175]
  ds_read_b64_tr_b16 v[240:241], v101 offset:4096
  ds_read_b64_tr_b16 v[242:243], v101 offset:5120
  v_mfma_f32_32x32x16_bf16 v[176:191], a[60:63], v[252:255], v[176:191]
  ds_read_b64_tr_b16 v[244:245], v101 offset:4352
  ds_read_b64_tr_b16 v[246:247], v101 offset:5376
  s_add_u32 m0, s69, 134144
  s_add_u32 s45, s87, 20480
  buffer_load_dwordx4 v64, s[28:31], s45 offen lds
  s_waitcnt lgkmcnt(8)
  s_waitcnt vmcnt(19)
  v_mfma_f32_32x32x16_bf16 v[128:143], a[64:67], v[224:227], v[128:143]
  ds_read_b64_tr_b16 v[248:249], v101 offset:4608
  ds_read_b64_tr_b16 v[250:251], v101 offset:5632
  v_mfma_f32_32x32x16_bf16 v[144:159], a[64:67], v[228:231], v[144:159]
  ds_read_b64_tr_b16 v[252:253], v101 offset:4864
  ds_read_b64_tr_b16 v[254:255], v101 offset:5888
  s_add_u32 m0, s69, 135168
  s_add_u32 s45, s87, 30720
  buffer_load_dwordx4 v64, s[28:31], s45 offen lds
  s_waitcnt lgkmcnt(8)
  v_mfma_f32_32x32x16_bf16 v[160:175], a[64:67], v[232:235], v[160:175]
  s_barrier
  ds_read_b64_tr_b16 v[224:225], v101 offset:8192
  ds_read_b64_tr_b16 v[226:227], v101 offset:9216
  v_mfma_f32_32x32x16_bf16 v[176:191], a[64:67], v[236:239], v[176:191]
  ds_read_b64_tr_b16 v[228:229], v101 offset:8448
  ds_read_b64_tr_b16 v[230:231], v101 offset:9472
  s_add_u32 s83, s72, 7
  s_sub_u32 s68, s83, 10
  s_cmp_ge_u32 s83, 10
  s_cselect_b32 s83, s68, s83
  s_lshl_b32 s83, s83, 12
  s_add_u32 s83, s83, s71
  buffer_load_dwordx4 a[112:115], v35, s[8:11], s83 offen offset:0 sc1
  s_waitcnt lgkmcnt(8)
  s_waitcnt vmcnt(20)
  v_mfma_f32_32x32x16_bf16 v[128:143], a[68:71], v[240:243], v[128:143]
  ds_read_b64_tr_b16 v[232:233], v101 offset:8704
  ds_read_b64_tr_b16 v[234:235], v101 offset:9728
  v_mfma_f32_32x32x16_bf16 v[144:159], a[68:71], v[244:247], v[144:159]
  ds_read_b64_tr_b16 v[236:237], v101 offset:8960
  ds_read_b64_tr_b16 v[238:239], v101 offset:9984
  buffer_load_dwordx4 a[116:119], v35, s[8:11], s83 offen offset:1024 sc1
  s_waitcnt lgkmcnt(8)
  v_mfma_f32_32x32x16_bf16 v[160:175], a[68:71], v[248:251], v[160:175]
  ds_read_b64_tr_b16 v[240:241], v101 offset:12288
  ds_read_b64_tr_b16 v[242:243], v101 offset:13312
  v_mfma_f32_32x32x16_bf16 v[176:191], a[68:71], v[252:255], v[176:191]
  ds_read_b64_tr_b16 v[244:245], v101 offset:12544
  ds_read_b64_tr_b16 v[246:247], v101 offset:13568
  s_waitcnt lgkmcnt(8)
  s_waitcnt vmcnt(20)
  v_mfma_f32_32x32x16_bf16 v[128:143], a[72:75], v[224:227], v[128:143]
  ds_read_b64_tr_b16 v[248:249], v101 offset:12800
  ds_read_b64_tr_b16 v[250:251], v101 offset:13824
  buffer_load_dwordx4 a[120:123], v35, s[8:11], s83 offen offset:2048 sc1
  v_mfma_f32_32x32x16_bf16 v[144:159], a[72:75], v[228:231], v[144:159]
  ds_read_b64_tr_b16 v[252:253], v101 offset:13056
  ds_read_b64_tr_b16 v[254:255], v101 offset:14080
  s_waitcnt lgkmcnt(8)
  v_mfma_f32_32x32x16_bf16 v[160:175], a[72:75], v[232:235], v[160:175]
  ds_read_b64_tr_b16 v[224:225], v101 offset:16384
  ds_read_b64_tr_b16 v[226:227], v101 offset:17408
  buffer_load_dwordx4 a[124:127], v35, s[8:11], s83 offen offset:3072 sc1
  v_mfma_f32_32x32x16_bf16 v[176:191], a[72:75], v[236:239], v[176:191]
  ds_read_b64_tr_b16 v[228:229], v101 offset:16640
  ds_read_b64_tr_b16 v[230:231], v101 offset:17664
  s_waitcnt lgkmcnt(8)
  s_waitcnt vmcnt(21)
  v_mfma_f32_32x32x16_bf16 v[128:143], a[76:79], v[240:243], v[128:143]
  ds_read_b64_tr_b16 v[232:233], v101 offset:16896
  ds_read_b64_tr_b16 v[234:235], v101 offset:17920
  s_add_u32 s55, s72, 8
  s_sub_u32 s68, s55, 10
  s_cmp_ge_u32 s55, 10
  s_cselect_b32 s55, s68, s55
  s_mul_i32 s55, s55, 245760
  s_add_u32 m0, s69, 0
  s_add_u32 s55, s55, s65
  buffer_load_dwordx4 v104, s[16:19], s55 offen offset:0 lds
  v_mfma_f32_32x32x16_bf16 v[144:159], a[76:79], v[244:247], v[144:159]
  ds_read_b64_tr_b16 v[236:237], v101 offset:17152
  ds_read_b64_tr_b16 v[238:239], v101 offset:18176
  s_waitcnt lgkmcnt(8)
  v_mfma_f32_32x32x16_bf16 v[160:175], a[76:79], v[248:251], v[160:175]
  ds_read_b64_tr_b16 v[240:241], v101 offset:20480
  ds_read_b64_tr_b16 v[242:243], v101 offset:21504
  v_mfma_f32_32x32x16_bf16 v[176:191], a[76:79], v[252:255], v[176:191]
  ds_read_b64_tr_b16 v[244:245], v101 offset:20736
  ds_read_b64_tr_b16 v[246:247], v101 offset:21760
  buffer_load_dwordx4 v65, s[16:19], s55 offen offset:1024 lds
  s_waitcnt lgkmcnt(8)
  s_waitcnt vmcnt(17)
  v_mfma_f32_32x32x16_bf16 v[128:143], a[80:83], v[224:227], v[128:143]
  ds_read_b64_tr_b16 v[248:249], v101 offset:20992
  ds_read_b64_tr_b16 v[250:251], v101 offset:22016
  s_waitcnt vmcnt(6)
  ds_read_b64_tr_b16 v[192:193], v124 offset:0
  v_mfma_f32_32x32x16_bf16 v[144:159], a[80:83], v[228:231], v[144:159]
  ds_read_b64_tr_b16 v[252:253], v101 offset:21248
  ds_read_b64_tr_b16 v[254:255], v101 offset:22272
  buffer_load_dwordx4 v66, s[16:19], s55 offen offset:2048 lds
  ds_read_b64_tr_b16 v[194:195], v124 offset:512
  s_waitcnt lgkmcnt(10)
  v_mfma_f32_32x32x16_bf16 v[160:175], a[80:83], v[232:235], v[160:175]
  ds_read_b64_tr_b16 v[224:225], v101 offset:24576
  ds_read_b64_tr_b16 v[226:227], v101 offset:25600
  ds_read_b64_tr_b16 v[196:197], v124 offset:32
  ds_read_b64_tr_b16 v[198:199], v124 offset:544
  v_mfma_f32_32x32x16_bf16 v[176:191], a[80:83], v[236:239], v[176:191]
  ds_read_b64_tr_b16 v[228:229], v101 offset:24832
  ds_read_b64_tr_b16 v[230:231], v101 offset:25856
  buffer_load_dwordx4 v67, s[16:19], s55 offen offset:3072 lds
  ds_read_b64_tr_b16 v[200:201], v124 offset:64
  s_waitcnt lgkmcnt(13)
  v_mfma_f32_32x32x16_bf16 v[128:143], a[84:87], v[240:243], v[128:143]
  ds_read_b64_tr_b16 v[232:233], v101 offset:25088
  ds_read_b64_tr_b16 v[234:235], v101 offset:26112
  ds_read_b64_tr_b16 v[202:203], v124 offset:576
  ds_read_b64_tr_b16 v[204:205], v124 offset:96
  v_mfma_f32_32x32x16_bf16 v[144:159], a[84:87], v[244:247], v[144:159]
  ds_read_b64_tr_b16 v[236:237], v101 offset:25344
  ds_read_b64_tr_b16 v[238:239], v101 offset:26368
  ds_read_b64_tr_b16 v[206:207], v124 offset:608
  s_waitcnt lgkmcnt(15)
  v_mfma_f32_32x32x16_bf16 v[160:175], a[84:87], v[248:251], v[160:175]
  ds_read_b64_tr_b16 v[240:241], v101 offset:28672
  ds_read_b64_tr_b16 v[242:243], v101 offset:29696
  s_add_u32 s83, s72, 8
  s_sub_u32 s68, s83, 10
  s_cmp_ge_u32 s83, 10
  s_cselect_b32 s83, s68, s83
  s_lshl_b32 s83, s83, 12
  s_add_u32 s83, s83, s71
  buffer_load_dwordx4 a[128:131], v35, s[8:11], s83 offen offset:0 sc1
  s_lshl_b32 s46, s86, 2
  v_mfma_f32_32x32x16_bf16 v[176:191], a[84:87], v[252:255], v[176:191]
  ds_read_b64_tr_b16 v[244:245], v101 offset:28928
  ds_read_b64_tr_b16 v[246:247], v101 offset:29952
  s_add_u32 s46, s46, 0
  s_mul_i32 s47, s46, 13108
  s_waitcnt lgkmcnt(12)
  v_mfma_f32_32x32x16_bf16 v[128:143], a[88:91], v[224:227], v[128:143]
  ds_read_b64_tr_b16 v[248:249], v101 offset:29184
  ds_read_b64_tr_b16 v[250:251], v101 offset:30208
  buffer_load_dwordx4 a[132:135], v35, s[8:11], s83 offen offset:1024 sc1
  s_lshr_b32 s47, s47, 16
  v_mfma_f32_32x32x16_bf16 v[144:159], a[88:91], v[228:231], v[144:159]
  ds_read_b64_tr_b16 v[252:253], v101 offset:29440
  ds_read_b64_tr_b16 v[254:255], v101 offset:30464
  s_mul_i32 s47, s47, 365
  s_add_u32 s46, s46, s47
  s_waitcnt lgkmcnt(9)
  v_mfma_f32_32x32x16_bf16 v[160:175], a[88:91], v[232:235], v[160:175]
  ds_read_b64_tr_b16 v[224:225], v101 offset:32768
  ds_read_b64_tr_b16 v[226:227], v101 offset:33792
  buffer_load_dwordx4 a[136:139], v35, s[8:11], s83 offen offset:2048 sc1
  s_mul_i32 s47, s85, 5
  v_mfma_f32_32x32x16_bf16 v[176:191], a[88:91], v[236:239], v[176:191]
  ds_read_b64_tr_b16 v[228:229], v101 offset:33024
  ds_read_b64_tr_b16 v[230:231], v101 offset:34048
  s_add_u32 s47, s47, s46
  s_waitcnt lgkmcnt(8)
  v_mfma_f32_32x32x16_bf16 v[128:143], a[92:95], v[240:243], v[128:143]
  ds_read_b64_tr_b16 v[232:233], v101 offset:33280
  ds_read_b64_tr_b16 v[234:235], v101 offset:34304
  buffer_load_dwordx4 a[140:143], v35, s[8:11], s83 offen offset:3072 sc1
  s_lshl_b32 s47, s47, 10
  s_add_u32 s48, s47, 20250624
  v_mfma_f32_32x32x16_bf16 v[144:159], a[92:95], v[244:247], v[144:159]
  ds_read_b64_tr_b16 v[236:237], v101 offset:33536
  ds_read_b64_tr_b16 v[238:239], v101 offset:34560
  s_waitcnt lgkmcnt(8)
  v_mfma_f32_32x32x16_bf16 v[160:175], a[92:95], v[248:251], v[160:175]
  ds_read_b64_tr_b16 v[240:241], v101 offset:36864
  ds_read_b64_tr_b16 v[242:243], v101 offset:37888
  s_cmp_lt_u32 s84, 740
  s_cselect_b32 s48, s48, 1073741824
  s_lshl_b32 s46, s86, 2
  v_mfma_f32_32x32x16_bf16 v[176:191], a[92:95], v[252:255], v[176:191]
  ds_read_b64_tr_b16 v[244:245], v101 offset:37120
  ds_read_b64_tr_b16 v[246:247], v101 offset:38144
  s_add_u32 s55, s72, 9
  s_sub_u32 s68, s55, 10
  s_cmp_ge_u32 s55, 10
  s_cselect_b32 s55, s68, s55
  s_mul_i32 s55, s55, 245760
  s_add_u32 m0, s69, 16384
  s_add_u32 s55, s55, s65
  buffer_load_dwordx4 v104, s[16:19], s55 offen offset:0 lds
  s_add_u32 s46, s46, 1
  s_waitcnt lgkmcnt(8)
  v_mfma_f32_32x32x16_bf16 v[128:143], a[96:99], v[224:227], v[128:143]
  ds_read_b64_tr_b16 v[248:249], v101 offset:37376
  ds_read_b64_tr_b16 v[250:251], v101 offset:38400
  s_mul_i32 s47, s46, 13108
  v_mfma_f32_32x32x16_bf16 v[144:159], a[96:99], v[228:231], v[144:159]
  ds_read_b64_tr_b16 v[252:253], v101 offset:37632
  ds_read_b64_tr_b16 v[254:255], v101 offset:38656
  buffer_load_dwordx4 v65, s[16:19], s55 offen offset:1024 lds
  s_lshr_b32 s47, s47, 16
  s_mul_i32 s47, s47, 365
  s_waitcnt lgkmcnt(8)
  v_mfma_f32_32x32x16_bf16 v[160:175], a[96:99], v[232:235], v[160:175]
  ds_read_b64_tr_b16 v[224:225], v101 offset:40960
  ds_read_b64_tr_b16 v[226:227], v101 offset:41984
  s_add_u32 s46, s46, s47
  v_mfma_f32_32x32x16_bf16 v[176:191], a[96:99], v[236:239], v[176:191]
  ds_read_b64_tr_b16 v[228:229], v101 offset:41216
  ds_read_b64_tr_b16 v[230:231], v101 offset:42240
  buffer_load_dwordx4 v66, s[16:19], s55 offen offset:2048 lds
  s_mul_i32 s47, s85, 5
  s_add_u32 s47, s47, s46
  s_waitcnt lgkmcnt(8)
  v_mfma_f32_32x32x16_bf16 v[128:143], a[100:103], v[240:243], v[128:143]
  ds_read_b64_tr_b16 v[232:233], v101 offset:41472
  ds_read_b64_tr_b16 v[234:235], v101 offset:42496
  s_lshl_b32 s47, s47, 10
  v_mfma_f32_32x32x16_bf16 v[144:159], a[100:103], v[244:247], v[144:159]
  ds_read_b64_tr_b16 v[236:237], v101 offset:41728
  ds_read_b64_tr_b16 v[238:239], v101 offset:42752
  s_add_u32 s49, s47, 20250624
  s_waitcnt lgkmcnt(8)
  v_mfma_f32_32x32x16_bf16 v[160:175], a[100:103], v[248:251], v[160:175]
  ds_read_b64_tr_b16 v[240:241], v101 offset:45056
  ds_read_b64_tr_b16 v[242:243], v101 offset:46080
  buffer_load_dwordx4 v67, s[16:19], s55 offen offset:3072 lds
  s_cmp_lt_u32 s84, 740
  s_cselect_b32 s49, s49, 1073741824
  v_mfma_f32_32x32x16_bf16 v[176:191], a[100:103], v[252:255], v[176:191]
  ds_read_b64_tr_b16 v[244:245], v101 offset:45312
  ds_read_b64_tr_b16 v[246:247], v101 offset:46336
  s_lshl_b32 s46, s86, 2
  s_waitcnt lgkmcnt(8)
  v_mfma_f32_32x32x16_bf16 v[128:143], a[104:107], v[224:227], v[128:143]
  ds_read_b64_tr_b16 v[248:249], v101 offset:45568
  ds_read_b64_tr_b16 v[250:251], v101 offset:46592
  s_add_u32 s83, s72, 9
  s_sub_u32 s68, s83, 10
  s_cmp_ge_u32 s83, 10
  s_cselect_b32 s83, s68, s83
  s_lshl_b32 s83, s83, 12
  s_add_u32 s83, s83, s71
  buffer_load_dwordx4 a[144:147], v35, s[8:11], s83 offen offset:0 sc1
  s_add_u32 s46, s46, 2
  s_mul_i32 s47, s46, 13108
  v_mfma_f32_32x32x16_bf16 v[144:159], a[104:107], v[228:231], v[144:159]
  ds_read_b64_tr_b16 v[252:253], v101 offset:45824
  ds_read_b64_tr_b16 v[254:255], v101 offset:46848
  s_lshr_b32 s47, s47, 16
  s_waitcnt lgkmcnt(8)
  v_mfma_f32_32x32x16_bf16 v[160:175], a[104:107], v[232:235], v[160:175]
  ds_read_b64_tr_b16 v[224:225], v101 offset:49152
  ds_read_b64_tr_b16 v[226:227], v101 offset:50176
  buffer_load_dwordx4 a[148:151], v35, s[8:11], s83 offen offset:1024 sc1
  s_mul_i32 s47, s47, 365
  v_mfma_f32_32x32x16_bf16 v[176:191], a[104:107], v[236:239], v[176:191]
  ds_read_b64_tr_b16 v[228:229], v101 offset:49408
  ds_read_b64_tr_b16 v[230:231], v101 offset:50432
  s_add_u32 s46, s46, s47
  s_mul_i32 s47, s85, 5
  s_waitcnt lgkmcnt(8)
  v_mfma_f32_32x32x16_bf16 v[128:143], a[108:111], v[240:243], v[128:143]
  ds_read_b64_tr_b16 v[232:233], v101 offset:49664
  ds_read_b64_tr_b16 v[234:235], v101 offset:50688
  s_add_u32 s47, s47, s46
  v_mfma_f32_32x32x16_bf16 v[144:159], a[108:111], v[244:247], v[144:159]
  ds_read_b64_tr_b16 v[236:237], v101 offset:49920
  ds_read_b64_tr_b16 v[238:239], v101 offset:50944
  buffer_load_dwordx4 a[152:155], v35, s[8:11], s83 offen offset:2048 sc1
  s_lshl_b32 s47, s47, 10
  s_add_u32 s50, s47, 20250624
  s_waitcnt lgkmcnt(8)
  v_mfma_f32_32x32x16_bf16 v[160:175], a[108:111], v[248:251], v[160:175]
  ds_read_b64_tr_b16 v[240:241], v101 offset:53248
  ds_read_b64_tr_b16 v[242:243], v101 offset:54272
  v_mfma_f32_32x32x16_bf16 v[176:191], a[108:111], v[252:255], v[176:191]
  ds_read_b64_tr_b16 v[244:245], v101 offset:53504
  ds_read_b64_tr_b16 v[246:247], v101 offset:54528
  buffer_load_dwordx4 a[156:159], v35, s[8:11], s83 offen offset:3072 sc1
  s_cmp_lt_u32 s84, 740
  s_cselect_b32 s50, s50, 1073741824
  s_waitcnt lgkmcnt(8)
  s_waitcnt vmcnt(19)
  v_mfma_f32_32x32x16_bf16 v[128:143], a[112:115], v[224:227], v[128:143]
  ds_read_b64_tr_b16 v[248:249], v101 offset:53760
  ds_read_b64_tr_b16 v[250:251], v101 offset:54784
  s_lshl_b32 s46, s86, 2
  s_add_u32 s46, s46, 3
  v_mfma_f32_32x32x16_bf16 v[144:159], a[112:115], v[228:231], v[144:159]
  ds_read_b64_tr_b16 v[252:253], v101 offset:54016
  ds_read_b64_tr_b16 v[254:255], v101 offset:55040
  s_add_u32 s55, s97, 0
  s_sub_u32 s68, s55, 10
  s_cmp_ge_u32 s55, 10
  s_cselect_b32 s55, s68, s55
  s_mul_i32 s55, s55, 221184
  s_add_u32 m0, s69, 32768
  s_add_u32 s55, s55, s66
  buffer_load_dwordx4 v105, s[12:15], s55 offen offset:0 lds
  s_mul_i32 s47, s46, 13108
  s_waitcnt lgkmcnt(8)
  v_mfma_f32_32x32x16_bf16 v[160:175], a[112:115], v[232:235], v[160:175]
  ds_read_b64_tr_b16 v[224:225], v101 offset:57344
  ds_read_b64_tr_b16 v[226:227], v101 offset:58368
  s_lshr_b32 s47, s47, 16
  s_mul_i32 s47, s47, 365
  v_mfma_f32_32x32x16_bf16 v[176:191], a[112:115], v[236:239], v[176:191]
  ds_read_b64_tr_b16 v[228:229], v101 offset:57600
  ds_read_b64_tr_b16 v[230:231], v101 offset:58624
  buffer_load_dwordx4 v1, s[12:15], s55 offen offset:1024 lds
  s_add_u32 s46, s46, s47
  s_waitcnt lgkmcnt(8)
  s_waitcnt vmcnt(20)
  v_mfma_f32_32x32x16_bf16 v[128:143], a[116:119], v[240:243], v[128:143]
  ds_read_b64_tr_b16 v[232:233], v101 offset:57856
  ds_read_b64_tr_b16 v[234:235], v101 offset:58880
  s_mul_i32 s47, s85, 5
  v_mfma_f32_32x32x16_bf16 v[144:159], a[116:119], v[244:247], v[144:159]
  ds_read_b64_tr_b16 v[236:237], v101 offset:58112
  ds_read_b64_tr_b16 v[238:239], v101 offset:59136
  s_add_u32 s47, s47, s46
  s_lshl_b32 s47, s47, 10
  s_waitcnt lgkmcnt(8)
  v_mfma_f32_32x32x16_bf16 v[160:175], a[116:119], v[248:251], v[160:175]
  ds_read_b64_tr_b16 v[240:241], v101 offset:61440
  ds_read_b64_tr_b16 v[242:243], v101 offset:62464
  buffer_load_dwordx4 v2, s[12:15], s55 offen offset:2048 lds
  s_add_u32 s51, s47, 20250624
  v_mfma_f32_32x32x16_bf16 v[176:191], a[116:119], v[252:255], v[176:191]
  ds_read_b64_tr_b16 v[244:245], v101 offset:61696
  ds_read_b64_tr_b16 v[246:247], v101 offset:62720
  s_cmp_lt_u32 s84, 740
  s_cselect_b32 s51, s51, 1073741824
  s_waitcnt lgkmcnt(8)
  s_waitcnt vmcnt(20)
  v_mfma_f32_32x32x16_bf16 v[128:143], a[120:123], v[224:227], v[128:143]
  ds_read_b64_tr_b16 v[248:249], v101 offset:61952
  ds_read_b64_tr_b16 v[250:251], v101 offset:62976
  buffer_load_dwordx4 v3, s[12:15], s55 offen offset:3072 lds
  v_mfma_f32_32x32x16_bf16 v[144:159], a[120:123], v[228:231], v[144:159]
  ds_read_b64_tr_b16 v[252:253], v101 offset:62208
  ds_read_b64_tr_b16 v[254:255], v101 offset:63232
  s_waitcnt lgkmcnt(8)
  v_mfma_f32_32x32x16_bf16 v[160:175], a[120:123], v[232:235], v[160:175]
  s_waitcnt vmcnt(16)
  s_waitcnt vmcnt(8)
  s_barrier
  ds_read_b64_tr_b16 v[224:225], v100 offset:0
  ds_read_b64_tr_b16 v[226:227], v100 offset:1024
  s_add_u32 s55, s97, 2
  s_sub_u32 s68, s55, 10
  s_cmp_ge_u32 s55, 10
  s_cselect_b32 s55, s68, s55
  s_mul_i32 s55, s55, 221184
  s_add_u32 m0, s69, 49152
  s_add_u32 s55, s55, s66
  buffer_load_dwordx4 v105, s[12:15], s55 offen offset:0 lds
  v_mfma_f32_32x32x16_bf16 v[176:191], a[120:123], v[236:239], v[176:191]
  ds_read_b64_tr_b16 v[228:229], v100 offset:256
  ds_read_b64_tr_b16 v[230:231], v100 offset:1280
  s_waitcnt lgkmcnt(8)
  v_mfma_f32_32x32x16_bf16 v[128:143], a[124:127], v[240:243], v[128:143]
  ds_read_b64_tr_b16 v[232:233], v100 offset:512
  ds_read_b64_tr_b16 v[234:235], v100 offset:1536
  v_mfma_f32_32x32x16_bf16 v[144:159], a[124:127], v[244:247], v[144:159]
  ds_read_b64_tr_b16 v[236:237], v100 offset:768
  ds_read_b64_tr_b16 v[238:239], v100 offset:1792
  buffer_load_dwordx4 v1, s[12:15], s55 offen offset:1024 lds
  s_waitcnt lgkmcnt(8)
  v_mfma_f32_32x32x16_bf16 v[160:175], a[124:127], v[248:251], v[160:175]
  ds_read_b64_tr_b16 v[240:241], v100 offset:4096
  ds_read_b64_tr_b16 v[242:243], v100 offset:5120
  v_mfma_f32_32x32x16_bf16 v[176:191], a[124:127], v[252:255], v[176:191]
  ds_read_b64_tr_b16 v[244:245], v100 offset:4352
  ds_read_b64_tr_b16 v[246:247], v100 offset:5376
  buffer_load_dwordx4 v2, s[12:15], s55 offen offset:2048 lds
  s_waitcnt lgkmcnt(8)
  v_mfma_f32_32x32x16_bf16 v[128:143], a[128:131], v[224:227], v[128:143]
  ds_read_b64_tr_b16 v[248:249], v100 offset:4608
  ds_read_b64_tr_b16 v[250:251], v100 offset:5632
  v_mfma_f32_32x32x16_bf16 v[144:159], a[128:131], v[228:231], v[144:159]
  ds_read_b64_tr_b16 v[252:253], v100 offset:4864
  ds_read_b64_tr_b16 v[254:255], v100 offset:5888
  buffer_load_dwordx4 v3, s[12:15], s55 offen offset:3072 lds
  s_waitcnt lgkmcnt(8)
  v_mfma_f32_32x32x16_bf16 v[160:175], a[128:131], v[232:235], v[160:175]
  ds_read_b64_tr_b16 v[224:225], v100 offset:8192
  ds_read_b64_tr_b16 v[226:227], v100 offset:9216
  v_mfma_f32_32x32x16_bf16 v[176:191], a[128:131], v[236:239], v[176:191]
  ds_read_b64_tr_b16 v[228:229], v100 offset:8448
  ds_read_b64_tr_b16 v[230:231], v100 offset:9472
  s_waitcnt lgkmcnt(8)
  v_mfma_f32_32x32x16_bf16 v[128:143], a[132:135], v[240:243], v[128:143]
  ds_read_b64_tr_b16 v[232:233], v100 offset:8704
  ds_read_b64_tr_b16 v[234:235], v100 offset:9728
  buffer_store_dwordx4 v[192:195], v35, s[8:11], s48 offen sc1
  v_mfma_f32_32x32x16_bf16 v[144:159], a[132:135], v[244:247], v[144:159]
  ds_read_b64_tr_b16 v[236:237], v100 offset:8960
  ds_read_b64_tr_b16 v[238:239], v100 offset:9984
  buffer_store_dwordx4 v[196:199], v35, s[8:11], s49 offen sc1
  s_waitcnt lgkmcnt(8)
  v_mfma_f32_32x32x16_bf16 v[160:175], a[132:135], v[248:251], v[160:175]
  ds_read_b64_tr_b16 v[240:241], v100 offset:12288
  ds_read_b64_tr_b16 v[242:243], v100 offset:13312
  buffer_store_dwordx4 v[200:203], v35, s[8:11], s50 offen sc1
  v_mfma_f32_32x32x16_bf16 v[176:191], a[132:135], v[252:255], v[176:191]
  ds_read_b64_tr_b16 v[244:245], v100 offset:12544
  ds_read_b64_tr_b16 v[246:247], v100 offset:13568
  buffer_store_dwordx4 v[204:207], v35, s[8:11], s51 offen sc1
  s_waitcnt lgkmcnt(8)
  v_mfma_f32_32x32x16_bf16 v[128:143], a[136:139], v[224:227], v[128:143]
  ds_read_b64_tr_b16 v[248:249], v100 offset:12800
  ds_read_b64_tr_b16 v[250:251], v100 offset:13824
  s_add_u32 s55, s97, 4
  s_sub_u32 s68, s55, 10
  s_cmp_ge_u32 s55, 10
  s_cselect_b32 s55, s68, s55
  s_mul_i32 s55, s55, 221184
  s_add_u32 m0, s69, 65536
  s_add_u32 s55, s55, s66
  buffer_load_dwordx4 v105, s[12:15], s55 offen offset:0 lds
  v_mfma_f32_32x32x16_bf16 v[144:159], a[136:139], v[228:231], v[144:159]
  ds_read_b64_tr_b16 v[252:253], v100 offset:13056
  ds_read_b64_tr_b16 v[254:255], v100 offset:14080
  s_waitcnt lgkmcnt(8)
  v_mfma_f32_32x32x16_bf16 v[160:175], a[136:139], v[232:235], v[160:175]
  ds_read_b64_tr_b16 v[224:225], v100 offset:16384
  ds_read_b64_tr_b16 v[226:227], v100 offset:17408
  buffer_load_dwordx4 v1, s[12:15], s55 offen offset:1024 lds
  v_mfma_f32_32x32x16_bf16 v[176:191], a[136:139], v[236:239], v[176:191]
  ds_read_b64_tr_b16 v[228:229], v100 offset:16640
  ds_read_b64_tr_b16 v[230:231], v100 offset:17664
  s_waitcnt lgkmcnt(8)
  v_mfma_f32_32x32x16_bf16 v[128:143], a[140:143], v[240:243], v[128:143]
  ds_read_b64_tr_b16 v[232:233], v100 offset:16896
  ds_read_b64_tr_b16 v[234:235], v100 offset:17920
  buffer_load_dwordx4 v2, s[12:15], s55 offen offset:2048 lds
  v_mfma_f32_32x32x16_bf16 v[144:159], a[140:143], v[244:247], v[144:159]
  ds_read_b64_tr_b16 v[236:237], v100 offset:17152
  ds_read_b64_tr_b16 v[238:239], v100 offset:18176
  s_waitcnt lgkmcnt(8)
  v_mfma_f32_32x32x16_bf16 v[160:175], a[140:143], v[248:251], v[160:175]
  ds_read_b64_tr_b16 v[240:241], v100 offset:20480
  ds_read_b64_tr_b16 v[242:243], v100 offset:21504
  buffer_load_dwordx4 v3, s[12:15], s55 offen offset:3072 lds
  v_mfma_f32_32x32x16_bf16 v[176:191], a[140:143], v[252:255], v[176:191]
  ds_read_b64_tr_b16 v[244:245], v100 offset:20736
  ds_read_b64_tr_b16 v[246:247], v100 offset:21760
  s_waitcnt lgkmcnt(8)
  s_waitcnt vmcnt(19)
  v_mfma_f32_32x32x16_bf16 v[128:143], a[144:147], v[224:227], v[128:143]
  ds_read_b64_tr_b16 v[248:249], v100 offset:20992
  ds_read_b64_tr_b16 v[250:251], v100 offset:22016
  v_mfma_f32_32x32x16_bf16 v[144:159], a[144:147], v[228:231], v[144:159]
  ds_read_b64_tr_b16 v[252:253], v100 offset:21248
  ds_read_b64_tr_b16 v[254:255], v100 offset:22272
  s_add_u32 s55, s97, 6
  s_sub_u32 s68, s55, 10
  s_cmp_ge_u32 s55, 10
  s_cselect_b32 s55, s68, s55
  s_mul_i32 s55, s55, 221184
  s_add_u32 m0, s69, 81920
  s_add_u32 s55, s55, s66
  buffer_load_dwordx4 v105, s[12:15], s55 offen offset:0 lds
  s_waitcnt lgkmcnt(8)
  v_mfma_f32_32x32x16_bf16 v[160:175], a[144:147], v[232:235], v[160:175]
  ds_read_b64_tr_b16 v[224:225], v100 offset:24576
  ds_read_b64_tr_b16 v[226:227], v100 offset:25600
  v_mfma_f32_32x32x16_bf16 v[176:191], a[144:147], v[236:239], v[176:191]
  ds_read_b64_tr_b16 v[228:229], v100 offset:24832
  ds_read_b64_tr_b16 v[230:231], v100 offset:25856
  buffer_load_dwordx4 v1, s[12:15], s55 offen offset:1024 lds
  s_waitcnt lgkmcnt(8)
  s_waitcnt vmcnt(20)
  v_mfma_f32_32x32x16_bf16 v[128:143], a[148:151], v[240:243], v[128:143]
  ds_read_b64_tr_b16 v[232:233], v100 offset:25088
  ds_read_b64_tr_b16 v[234:235], v100 offset:26112
  v_mfma_f32_32x32x16_bf16 v[144:159], a[148:151], v[244:247], v[144:159]
  ds_read_b64_tr_b16 v[236:237], v100 offset:25344
  ds_read_b64_tr_b16 v[238:239], v100 offset:26368
  buffer_load_dwordx4 v2, s[12:15], s55 offen offset:2048 lds
  s_waitcnt lgkmcnt(8)
  v_mfma_f32_32x32x16_bf16 v[160:175], a[148:151], v[248:251], v[160:175]
  ds_read_b64_tr_b16 v[240:241], v100 offset:28672
  ds_read_b64_tr_b16 v[242:243], v100 offset:29696
  v_mfma_f32_32x32x16_bf16 v[176:191], a[148:151], v[252:255], v[176:191]
  ds_read_b64_tr_b16 v[244:245], v100 offset:28928
  ds_read_b64_tr_b16 v[246:247], v100 offset:29952
  s_waitcnt lgkmcnt(8)
  s_waitcnt vmcnt(20)
  v_mfma_f32_32x32x16_bf16 v[128:143], a[152:155], v[224:227], v[128:143]
  ds_read_b64_tr_b16 v[248:249], v100 offset:29184
  ds_read_b64_tr_b16 v[250:251], v100 offset:30208
  buffer_load_dwordx4 v3, s[12:15], s55 offen offset:3072 lds
  v_mfma_f32_32x32x16_bf16 v[144:159], a[152:155], v[228:231], v[144:159]
  ds_read_b64_tr_b16 v[252:253], v100 offset:29440
  ds_read_b64_tr_b16 v[254:255], v100 offset:30464
  s_waitcnt lgkmcnt(8)
  v_mfma_f32_32x32x16_bf16 v[160:175], a[152:155], v[232:235], v[160:175]
  s_waitcnt vmcnt(16)
  s_waitcnt vmcnt(12)
  s_barrier
  ds_read_b64_tr_b16 v[224:225], v102 offset:32768
  ds_read_b64_tr_b16 v[226:227], v102 offset:33280
  s_add_u32 s55, s97, 8
  s_sub_u32 s68, s55, 10
  s_cmp_ge_u32 s55, 10
  s_cselect_b32 s55, s68, s55
  s_mul_i32 s55, s55, 221184
  s_add_u32 m0, s69, 98304
  s_add_u32 s55, s55, s66
  buffer_load_dwordx4 v105, s[12:15], s55 offen offset:0 lds
  v_mfma_f32_32x32x16_bf16 v[176:191], a[152:155], v[236:239], v[176:191]
  ds_read_b64_tr_b16 v[228:229], v102 offset:34816
  ds_read_b64_tr_b16 v[230:231], v102 offset:35328
  s_waitcnt lgkmcnt(8)
  v_mfma_f32_32x32x16_bf16 v[128:143], a[156:159], v[240:243], v[128:143]
  ds_read_b64_tr_b16 v[232:233], v102 offset:36864
  ds_read_b64_tr_b16 v[234:235], v102 offset:37376
  buffer_load_dwordx4 v1, s[12:15], s55 offen offset:1024 lds
  v_mfma_f32_32x32x16_bf16 v[144:159], a[156:159], v[244:247], v[144:159]
  ds_read_b64_tr_b16 v[236:237], v102 offset:38912
  ds_read_b64_tr_b16 v[238:239], v102 offset:39424
  s_waitcnt lgkmcnt(8)
  v_mfma_f32_32x32x16_bf16 v[160:175], a[156:159], v[248:251], v[160:175]
  ds_read_b64_tr_b16 v[240:241], v102 offset:40960
  ds_read_b64_tr_b16 v[242:243], v102 offset:41472
  v_mfma_f32_32x32x16_bf16 v[176:191], a[156:159], v[252:255], v[176:191]
  ds_read_b64_tr_b16 v[244:245], v102 offset:43008
  ds_read_b64_tr_b16 v[246:247], v102 offset:43520
  buffer_load_dwordx4 v2, s[12:15], s55 offen offset:2048 lds
L_p1j:
  s_waitcnt lgkmcnt(8)
  v_mfma_f32_32x32x16_bf16 v[192:207], v[224:227], a[0:3], 0
  ds_read_b64_tr_b16 v[248:249], v102 offset:45056
  ds_read_b64_tr_b16 v[250:251], v102 offset:45568
  v_mfma_f32_32x32x16_bf16 v[192:207], v[228:231], a[4:7], v[192:207]
  ds_read_b64_tr_b16 v[252:253], v102 offset:47104
  ds_read_b64_tr_b16 v[254:255], v102 offset:47616
  buffer_load_dwordx4 v3, s[12:15], s55 offen offset:3072 lds
  s_waitcnt lgkmcnt(8)
  v_mfma_f32_32x32x16_bf16 v[192:207], v[232:235], a[8:11], v[192:207]
  ds_read_b64_tr_b16 v[224:225], v102 offset:49152
  ds_read_b64_tr_b16 v[226:227], v102 offset:49664
  v_mul_f32 v128, s70, v128
  v_mul_f32 v129, s70, v129
  v_mfma_f32_32x32x16_bf16 v[192:207], v[236:239], a[12:15], v[192:207]
  ds_read_b64_tr_b16 v[228:229], v102 offset:51200
  ds_read_b64_tr_b16 v[230:231], v102 offset:51712
  s_add_u32 s55, s97, 0
  s_sub_u32 s68, s55, 10
  s_cmp_ge_u32 s55, 10
  s_cselect_b32 s55, s68, s55
  s_mul_i32 s55, s55, 221184
  s_add_u32 m0, s69, 114688
  s_add_u32 s55, s55, s67
  buffer_load_dwordx4 v105, s[12:15], s55 offen offset:0 lds
  v_cvt_pk_bf16_f32 v128, v128, v129
  v_mul_f32 v130, s70, v130
  v_mul_f32 v131, s70, v131
  s_waitcnt lgkmcnt(8)
  v_mfma_f32_32x32x16_bf16 v[192:207], v[240:243], a[16:19], v[192:207]
  ds_read_b64_tr_b16 v[232:233], v102 offset:53248
  ds_read_b64_tr_b16 v[234:235], v102 offset:53760
  v_cvt_pk_bf16_f32 v129, v130, v131
  v_mul_f32 v132, s70, v132
  v_mul_f32 v133, s70, v133
  v_mfma_f32_32x32x16_bf16 v[192:207], v[244:247], a[20:23], v[192:207]
  ds_read_b64_tr_b16 v[236:237], v102 offset:55296
  ds_read_b64_tr_b16 v[238:239], v102 offset:55808
  v_cvt_pk_bf16_f32 v130, v132, v133
  v_mul_f32 v134, s70, v134
  s_waitcnt lgkmcnt(8)
  v_mfma_f32_32x32x16_bf16 v[192:207], v[248:251], a[24:27], v[192:207]
  ds_read_b64_tr_b16 v[240:241], v102 offset:57344
  ds_read_b64_tr_b16 v[242:243], v102 offset:57856
  buffer_load_dwordx4 v1, s[12:15], s55 offen offset:1024 lds
  v_mul_f32 v135, s70, v135
  v_cvt_pk_bf16_f32 v131, v134, v135
  v_mul_f32 v136, s70, v136
  v_mfma_f32_32x32x16_bf16 v[192:207], v[252:255], a[28:31], v[192:207]
  ds_read_b64_tr_b16 v[244:245], v102 offset:59392
  ds_read_b64_tr_b16 v[246:247], v102 offset:59904
  v_mul_f32 v137, s70, v137
  v_cvt_pk_bf16_f32 v136, v136, v137
  v_mul_f32 v138, s70, v138
  s_waitcnt lgkmcnt(8)
  v_mfma_f32_32x32x16_bf16 v[192:207], v[224:227], a[32:35], v[192:207]
  ds_read_b64_tr_b16 v[248:249], v102 offset:61440
  ds_read_b64_tr_b16 v[250:251], v102 offset:61952
  buffer_load_dwordx4 v2, s[12:15], s55 offen offset:2048 lds
  buffer_store_dwordx4 v[128:131], v106, s[8:11], s74 offen sc1
  v_mul_f32 v139, s70, v139
  v_cvt_pk_bf16_f32 v137, v138, v139
  v_mfma_f32_32x32x16_bf16 v[192:207], v[228:231], a[36:39], v[192:207]
  ds_read_b64_tr_b16 v[252:253], v102 offset:63488
  ds_read_b64_tr_b16 v[254:255], v102 offset:64000
  v_mul_f32 v140, s70, v140
  v_mul_f32 v141, s70, v141
  v_cvt_pk_bf16_f32 v138, v140, v141
  s_waitcnt lgkmcnt(8)
  v_mfma_f32_32x32x16_bf16 v[192:207], v[232:235], a[40:43], v[192:207]
  s_waitcnt vmcnt(12)
  s_waitcnt vmcnt(8)
  s_barrier
  s_lshl_b32 s56, s2, 3
  s_add_u32 s56, s56, 23363584
  buffer_store_dwordx2 v[38:39], v36, s[8:11], s56 offen sc1
  ds_read_b64_tr_b16 v[224:225], v103 offset:0
  ds_read_b64_tr_b16 v[226:227], v103 offset:512
  buffer_load_dwordx4 v3, s[12:15], s55 offen offset:3072 lds
  v_mul_f32 v142, s70, v142
  v_mul_f32 v143, s70, v143
  v_cvt_pk_bf16_f32 v139, v142, v143
  v_mfma_f32_32x32x16_bf16 v[192:207], v[236:239], a[44:47], v[192:207]
  ds_read_b64_tr_b16 v[228:229], v103 offset:2048
  ds_read_b64_tr_b16 v[230:231], v103 offset:2560
  v_mul_f32 v144, s70, v144
  v_mul_f32 v145, s70, v145
  s_waitcnt lgkmcnt(8)
  v_mfma_f32_32x32x16_bf16 v[192:207], v[240:243], a[48:51], v[192:207]
  ds_read_b64_tr_b16 v[232:233], v103 offset:4096
  ds_read_b64_tr_b16 v[234:235], v103 offset:4608
  s_add_u32 s55, s97, 2
  s_sub_u32 s68, s55, 10
  s_cmp_ge_u32 s55, 10
  s_cselect_b32 s55, s68, s55
  s_mul_i32 s55, s55, 221184
  s_add_u32 m0, s69, 0
  s_add_u32 s55, s55, s67
  buffer_load_dwordx4 v105, s[12:15], s55 offen offset:0 lds
  v_cvt_pk_bf16_f32 v144, v144, v145
  v_mul_f32 v146, s70, v146
  v_mul_f32 v147, s70, v147
  v_mfma_f32_32x32x16_bf16 v[192:207], v[244:247], a[52:55], v[192:207]
  ds_read_b64_tr_b16 v[236:237], v103 offset:6144
  ds_read_b64_tr_b16 v[238:239], v103 offset:6656
  buffer_store_dwordx4 v[136:139], v106, s[8:11], s75 offen sc1
  v_cvt_pk_bf16_f32 v145, v146, v147
  v_mul_f32 v148, s70, v148
  v_mul_f32 v149, s70, v149
  s_waitcnt lgkmcnt(8)
  v_mfma_f32_32x32x16_bf16 v[192:207], v[248:251], a[56:59], v[192:207]
  ds_read_b64_tr_b16 v[240:241], v103 offset:8192
  ds_read_b64_tr_b16 v[242:243], v103 offset:8704
  v_cvt_pk_bf16_f32 v146, v148, v149
  v_mul_f32 v150, s70, v150
  v_mfma_f32_32x32x16_bf16 v[192:207], v[252:255], a[60:63], v[192:207]
  ds_read_b64_tr_b16 v[244:245], v103 offset:10240
  ds_read_b64_tr_b16 v[246:247], v103 offset:10752
  buffer_load_dwordx4 v1, s[12:15], s55 offen offset:1024 lds
  v_mul_f32 v151, s70, v151
  v_cvt_pk_bf16_f32 v147, v150, v151
  v_mul_f32 v152, s70, v152
  s_waitcnt lgkmcnt(8)
  v_mfma_f32_32x32x16_bf16 v[192:207], v[224:227], a[64:67], v[192:207]
  ds_read_b64_tr_b16 v[248:249], v103 offset:12288
  ds_read_b64_tr_b16 v[250:251], v103 offset:12800
  v_mul_f32 v153, s70, v153
  v_cvt_pk_bf16_f32 v152, v152, v153
  v_mul_f32 v154, s70, v154
  v_mfma_f32_32x32x16_bf16 v[192:207], v[228:231], a[68:71], v[192:207]
  ds_read_b64_tr_b16 v[252:253], v103 offset:14336
  ds_read_b64_tr_b16 v[254:255], v103 offset:14848
  buffer_load_dwordx4 v2, s[12:15], s55 offen offset:2048 lds
  v_mul_f32 v155, s70, v155
  v_cvt_pk_bf16_f32 v153, v154, v155
  s_waitcnt lgkmcnt(8)
  v_mfma_f32_32x32x16_bf16 v[192:207], v[232:235], a[72:75], v[192:207]
  ds_read_b64_tr_b16 v[224:225], v103 offset:16384
  ds_read_b64_tr_b16 v[226:227], v103 offset:16896
  buffer_store_dwordx4 v[144:147], v106, s[8:11], s76 offen sc1
  v_mul_f32 v156, s70, v156
  v_mul_f32 v157, s70, v157
  v_cvt_pk_bf16_f32 v154, v156, v157
  v_mfma_f32_32x32x16_bf16 v[192:207], v[236:239], a[76:79], v[192:207]
  ds_read_b64_tr_b16 v[228:229], v103 offset:18432
  ds_read_b64_tr_b16 v[230:231], v103 offset:18944
  buffer_load_dwordx4 v3, s[12:15], s55 offen offset:3072 lds
  v_mul_f32 v158, s70, v158
  v_mul_f32 v159, s70, v159
  v_cvt_pk_bf16_f32 v155, v158, v159
  s_waitcnt lgkmcnt(8)
  v_mfma_f32_32x32x16_bf16 v[192:207], v[240:243], a[80:83], v[192:207]
  ds_read_b64_tr_b16 v[232:233], v103 offset:20480
  ds_read_b64_tr_b16 v[234:235], v103 offset:20992
  v_mul_f32 v160, s70, v160
  v_mul_f32 v161, s70, v161
  v_mfma_f32_32x32x16_bf16 v[192:207], v[244:247], a[84:87], v[192:207]
  ds_read_b64_tr_b16 v[236:237], v103 offset:22528
  ds_read_b64_tr_b16 v[238:239], v103 offset:23040
  v_cvt_pk_bf16_f32 v160, v160, v161
  v_mul_f32 v162, s70, v162
  v_mul_f32 v163, s70, v163
  s_waitcnt lgkmcnt(8)
  v_mfma_f32_32x32x16_bf16 v[192:207], v[248:251], a[88:91], v[192:207]
  ds_read_b64_tr_b16 v[240:241], v103 offset:24576
  ds_read_b64_tr_b16 v[242:243], v103 offset:25088
  v_cvt_pk_bf16_f32 v161, v162, v163
  v_mul_f32 v164, s70, v164
  v_mul_f32 v165, s70, v165
  v_mfma_f32_32x32x16_bf16 v[192:207], v[252:255], a[92:95], v[192:207]
  ds_read_b64_tr_b16 v[244:245], v103 offset:26624
  ds_read_b64_tr_b16 v[246:247], v103 offset:27136
  buffer_store_dwordx4 v[152:155], v106, s[8:11], s77 offen sc1
  v_cvt_pk_bf16_f32 v162, v164, v165
  v_mul_f32 v166, s70, v166
  s_waitcnt lgkmcnt(8)
  v_mfma_f32_32x32x16_bf16 v[192:207], v[224:227], a[96:99], v[192:207]
  ds_read_b64_tr_b16 v[248:249], v103 offset:28672
  ds_read_b64_tr_b16 v[250:251], v103 offset:29184
  s_add_u32 s55, s97, 4
  s_sub_u32 s68, s55, 10
  s_cmp_ge_u32 s55, 10
  s_cselect_b32 s55, s68, s55
  s_mul_i32 s55, s55, 221184
  s_add_u32 m0, s69, 16384
  s_add_u32 s55, s55, s67
  buffer_load_dwordx4 v105, s[12:15], s55 offen offset:0 lds
  v_mul_f32 v167, s70, v167
  v_cvt_pk_bf16_f32 v163, v166, v167
  v_mul_f32 v168, s70, v168
  v_mfma_f32_32x32x16_bf16 v[192:207], v[228:231], a[100:103], v[192:207]
  ds_read_b64_tr_b16 v[252:253], v103 offset:30720
  ds_read_b64_tr_b16 v[254:255], v103 offset:31232
  v_mul_f32 v169, s70, v169
  v_cvt_pk_bf16_f32 v168, v168, v169
  v_mul_f32 v170, s70, v170
  s_waitcnt lgkmcnt(8)
  v_mfma_f32_32x32x16_bf16 v[192:207], v[232:235], a[104:107], v[192:207]
  s_waitcnt vmcnt(14)
  s_barrier
  ds_read_b64_tr_b16 v[224:225], v103 offset:32768
  ds_read_b64_tr_b16 v[226:227], v103 offset:33280
  buffer_load_dwordx4 v1, s[12:15], s55 offen offset:1024 lds
  v_mul_f32 v171, s70, v171
  v_cvt_pk_bf16_f32 v169, v170, v171
  v_mfma_f32_32x32x16_bf16 v[192:207], v[236:239], a[108:111], v[192:207]
  ds_read_b64_tr_b16 v[228:229], v103 offset:34816
  ds_read_b64_tr_b16 v[230:231], v103 offset:35328
  v_mul_f32 v172, s70, v172
  v_mul_f32 v173, s70, v173
  v_cvt_pk_bf16_f32 v170, v172, v173
  s_waitcnt lgkmcnt(8)
  v_mfma_f32_32x32x16_bf16 v[192:207], v[240:243], a[112:115], v[192:207]
  ds_read_b64_tr_b16 v[232:233], v103 offset:36864
  ds_read_b64_tr_b16 v[234:235], v103 offset:37376
  buffer_load_dwordx4 v2, s[12:15], s55 offen offset:2048 lds
  buffer_store_dwordx4 v[160:163], v106, s[8:11], s78 offen sc1
  v_mul_f32 v174, s70, v174
  v_mul_f32 v175, s70, v175
  v_cvt_pk_bf16_f32 v171, v174, v175
  v_mfma_f32_32x32x16_bf16 v[192:207], v[244:247], a[116:119], v[192:207]
  ds_read_b64_tr_b16 v[236:237], v103 offset:38912
  ds_read_b64_tr_b16 v[238:239], v103 offset:39424
  v_mul_f32 v176, s70, v176
  v_mul_f32 v177, s70, v177
  s_waitcnt lgkmcnt(8)
  v_mfma_f32_32x32x16_bf16 v[192:207], v[248:251], a[120:123], v[192:207]
  ds_read_b64_tr_b16 v[240:241], v103 offset:40960
  ds_read_b64_tr_b16 v[242:243], v103 offset:41472
  buffer_load_dwordx4 v3, s[12:15], s55 offen offset:3072 lds
  v_cvt_pk_bf16_f32 v176, v176, v177
  v_mul_f32 v178, s70, v178
  v_mul_f32 v179, s70, v179
  v_mfma_f32_32x32x16_bf16 v[192:207], v[252:255], a[124:127], v[192:207]
  ds_read_b64_tr_b16 v[244:245], v103 offset:43008
  ds_read_b64_tr_b16 v[246:247], v103 offset:43520
  v_cvt_pk_bf16_f32 v177, v178, v179
  v_mul_f32 v180, s70, v180
  v_mul_f32 v181, s70, v181
  s_waitcnt lgkmcnt(8)
  v_mfma_f32_32x32x16_bf16 v[192:207], v[224:227], a[128:131], v[192:207]
  ds_read_b64_tr_b16 v[248:249], v103 offset:45056
  ds_read_b64_tr_b16 v[250:251], v103 offset:45568
  v_cvt_pk_bf16_f32 v178, v180, v181
  v_mul_f32 v182, s70, v182
  v_mfma_f32_32x32x16_bf16 v[192:207], v[228:231], a[132:135], v[192:207]
  ds_read_b64_tr_b16 v[252:253], v103 offset:47104
  ds_read_b64_tr_b16 v[254:255], v103 offset:47616
  buffer_store_dwordx4 v[168:171], v106, s[8:11], s79 offen sc1
  v_mul_f32 v183, s70, v183
  v_cvt_pk_bf16_f32 v179, v182, v183
  v_mul_f32 v184, s70, v184
  s_waitcnt lgkmcnt(8)
  v_mfma_f32_32x32x16_bf16 v[192:207], v[232:235], a[136:139], v[192:207]
  ds_read_b64_tr_b16 v[224:225], v102 offset:33024
  ds_read_b64_tr_b16 v[226:227], v102 offset:33536
  v_mul_f32 v185, s70, v185
  v_cvt_pk_bf16_f32 v184, v184, v185
  v_mul_f32 v186, s70, v186
  v_mfma_f32_32x32x16_bf16 v[192:207], v[236:239], a[140:143], v[192:207]
  ds_read_b64_tr_b16 v[228:229], v102 offset:35072
  ds_read_b64_tr_b16 v[230:231], v102 offset:35584
  v_mul_f32 v187, s70, v187
  v_cvt_pk_bf16_f32 v185, v186, v187
  s_waitcnt lgkmcnt(8)
  v_mfma_f32_32x32x16_bf16 v[192:207], v[240:243], a[144:147], v[192:207]
  ds_read_b64_tr_b16 v[232:233], v102 offset:37120
  ds_read_b64_tr_b16 v[234:235], v102 offset:37632
  v_mul_f32 v188, s70, v188
  v_mul_f32 v189, s70, v189
  v_cvt_pk_bf16_f32 v186, v188, v189
  v_mfma_f32_32x32x16_bf16 v[192:207], v[244:247], a[148:151], v[192:207]
  ds_read_b64_tr_b16 v[236:237], v102 offset:39168
  ds_read_b64_tr_b16 v[238:239], v102 offset:39680
  v_mul_f32 v190, s70, v190
  v_mul_f32 v191, s70, v191
  v_cvt_pk_bf16_f32 v187, v190, v191
  s_waitcnt lgkmcnt(8)
  v_mfma_f32_32x32x16_bf16 v[192:207], v[248:251], a[152:155], v[192:207]
  ds_read_b64_tr_b16 v[240:241], v102 offset:41216
  ds_read_b64_tr_b16 v[242:243], v102 offset:41728
  buffer_store_dwordx4 v[176:179], v106, s[8:11], s80 offen sc1
  v_mfma_f32_32x32x16_bf16 v[192:207], v[252:255], a[156:159], v[192:207]
  ds_read_b64_tr_b16 v[244:245], v102 offset:43264
  ds_read_b64_tr_b16 v[246:247], v102 offset:43776
  s_waitcnt lgkmcnt(8)
  v_mfma_f32_32x32x16_bf16 v[208:223], v[224:227], a[0:3], 0
  ds_read_b64_tr_b16 v[248:249], v102 offset:45312
  ds_read_b64_tr_b16 v[250:251], v102 offset:45824
  v_mfma_f32_32x32x16_bf16 v[208:223], v[228:231], a[4:7], v[208:223]
  ds_read_b64_tr_b16 v[252:253], v102 offset:47360
  ds_read_b64_tr_b16 v[254:255], v102 offset:47872
  s_waitcnt lgkmcnt(8)
  v_mfma_f32_32x32x16_bf16 v[208:223], v[232:235], a[8:11], v[208:223]
  ds_read_b64_tr_b16 v[224:225], v102 offset:49408
  ds_read_b64_tr_b16 v[226:227], v102 offset:49920
  ds_read_b128 v[64:67], v108 offset:0
  ds_read_b128 v[68:71], v108 offset:16
  ds_read_b128 v[72:75], v108 offset:64
  ds_read_b128 v[76:79], v108 offset:80
  v_mfma_f32_32x32x16_bf16 v[208:223], v[236:239], a[12:15], v[208:223]
  ds_read_b64_tr_b16 v[228:229], v102 offset:51456
  ds_read_b64_tr_b16 v[230:231], v102 offset:51968
  buffer_store_dwordx4 v[184:187], v106, s[8:11], s81 offen sc1
  s_waitcnt lgkmcnt(2)
  v_fma_f32 v192, v192, v107, v64
  v_fma_f32 v193, v193, v107, v65
  v_mfma_f32_32x32x16_bf16 v[208:223], v[240:243], a[16:19], v[208:223]
  ds_read_b64_tr_b16 v[232:233], v102 offset:53504
  ds_read_b64_tr_b16 v[234:235], v102 offset:54016
  v_fma_f32 v194, v194, v107, v66
  v_fma_f32 v195, v195, v107, v67
  v_mul_f32 v96, v192, v192
  v_mul_f32 v97, v193, v193
  v_mfma_f32_32x32x16_bf16 v[208:223], v[244:247], a[20:23], v[208:223]
  ds_read_b64_tr_b16 v[236:237], v102 offset:55552
  ds_read_b64_tr_b16 v[238:239], v102 offset:56064
  v_mul_f32 v98, v194, v194
  v_mul_f32 v99, v195, v195
  v_fma_f32 v96, v96, v109, v110
  v_fma_f32 v97, v97, v109, v110
  v_fma_f32 v98, v98, v109, v110
  v_mfma_f32_32x32x16_bf16 v[208:223], v[248:251], a[24:27], v[208:223]
  ds_read_b64_tr_b16 v[240:241], v102 offset:57600
  ds_read_b64_tr_b16 v[242:243], v102 offset:58112
  v_fma_f32 v99, v99, v109, v110
  v_mul_f32 v96, v96, v192
  v_mul_f32 v97, v97, v193
  v_mul_f32 v98, v98, v194
  v_mul_f32 v99, v99, v195
  v_mfma_f32_32x32x16_bf16 v[208:223], v[252:255], a[28:31], v[208:223]
  ds_read_b64_tr_b16 v[244:245], v102 offset:59648
  ds_read_b64_tr_b16 v[246:247], v102 offset:60160
  v_exp_f32 v96, v96
  v_exp_f32 v97, v97
  s_waitcnt lgkmcnt(8)
  v_mfma_f32_32x32x16_bf16 v[208:223], v[224:227], a[32:35], v[208:223]
  ds_read_b64_tr_b16 v[248:249], v102 offset:61696
  ds_read_b64_tr_b16 v[250:251], v102 offset:62208
  v_exp_f32 v98, v98
  v_exp_f32 v99, v99
  v_add_f32 v96, 1.0, v96
  v_mfma_f32_32x32x16_bf16 v[208:223], v[228:231], a[36:39], v[208:223]
  ds_read_b64_tr_b16 v[252:253], v102 offset:63744
  ds_read_b64_tr_b16 v[254:255], v102 offset:64256
  v_add_f32 v97, 1.0, v97
  v_add_f32 v98, 1.0, v98
  v_add_f32 v99, 1.0, v99
  v_rcp_f32 v96, v96
  s_waitcnt lgkmcnt(8)
  v_mfma_f32_32x32x16_bf16 v[208:223], v[232:235], a[40:43], v[208:223]
  ds_read_b64_tr_b16 v[224:225], v103 offset:256
  ds_read_b64_tr_b16 v[226:227], v103 offset:768
  v_rcp_f32 v97, v97
  v_rcp_f32 v98, v98
  v_mfma_f32_32x32x16_bf16 v[208:223], v[236:239], a[44:47], v[208:223]
  ds_read_b64_tr_b16 v[228:229], v103 offset:2304
  ds_read_b64_tr_b16 v[230:231], v103 offset:2816
  v_rcp_f32 v99, v99
  v_mul_f32 v96, v96, v192
  v_mul_f32 v97, v97, v193
  v_mul_f32 v98, v98, v194
  s_waitcnt lgkmcnt(8)
  v_mfma_f32_32x32x16_bf16 v[208:223], v[240:243], a[48:51], v[208:223]
  ds_read_b64_tr_b16 v[232:233], v103 offset:4352
  ds_read_b64_tr_b16 v[234:235], v103 offset:4864
  v_mul_f32 v99, v99, v195
  v_cvt_pk_bf16_f32 v88, v96, v97
  v_cvt_pk_bf16_f32 v89, v98, v99
  v_fma_f32 v196, v196, v107, v68
  v_fma_f32 v197, v197, v107, v69
  v_mfma_f32_32x32x16_bf16 v[208:223], v[244:247], a[52:55], v[208:223]
  ds_read_b64_tr_b16 v[236:237], v103 offset:6400
  ds_read_b64_tr_b16 v[238:239], v103 offset:6912
  v_fma_f32 v198, v198, v107, v70
  v_fma_f32 v199, v199, v107, v71
  v_mul_f32 v96, v196, v196
  v_mul_f32 v97, v197, v197
  s_waitcnt lgkmcnt(8)
  v_mfma_f32_32x32x16_bf16 v[208:223], v[248:251], a[56:59], v[208:223]
  ds_read_b64_tr_b16 v[240:241], v103 offset:8448
  ds_read_b64_tr_b16 v[242:243], v103 offset:8960
  v_mul_f32 v98, v198, v198
  v_mul_f32 v99, v199, v199
  v_fma_f32 v96, v96, v109, v110
  v_fma_f32 v97, v97, v109, v110
  v_fma_f32 v98, v98, v109, v110
  v_mfma_f32_32x32x16_bf16 v[208:223], v[252:255], a[60:63], v[208:223]
  ds_read_b64_tr_b16 v[244:245], v103 offset:10496
  ds_read_b64_tr_b16 v[246:247], v103 offset:11008
  v_fma_f32 v99, v99, v109, v110
  v_mul_f32 v96, v96, v196
  v_mul_f32 v97, v97, v197
  v_mul_f32 v98, v98, v198
  v_mul_f32 v99, v99, v199
  s_waitcnt lgkmcnt(8)
  v_mfma_f32_32x32x16_bf16 v[208:223], v[224:227], a[64:67], v[208:223]
  ds_read_b64_tr_b16 v[248:249], v103 offset:12544
  ds_read_b64_tr_b16 v[250:251], v103 offset:13056
  v_exp_f32 v96, v96
  v_exp_f32 v97, v97
  v_mfma_f32_32x32x16_bf16 v[208:223], v[228:231], a[68:71], v[208:223]
  ds_read_b64_tr_b16 v[252:253], v103 offset:14592
  ds_read_b64_tr_b16 v[254:255], v103 offset:15104
  v_exp_f32 v98, v98
  v_exp_f32 v99, v99
  v_add_f32 v96, 1.0, v96
  s_waitcnt lgkmcnt(8)
  v_mfma_f32_32x32x16_bf16 v[208:223], v[232:235], a[72:75], v[208:223]
  s_barrier
  ds_read_b64_tr_b16 v[224:225], v103 offset:16640
  ds_read_b64_tr_b16 v[226:227], v103 offset:17152
  v_add_f32 v97, 1.0, v97
  v_add_f32 v98, 1.0, v98
  v_add_f32 v99, 1.0, v99
  v_rcp_f32 v96, v96
  v_mfma_f32_32x32x16_bf16 v[208:223], v[236:239], a[76:79], v[208:223]
  ds_read_b64_tr_b16 v[228:229], v103 offset:18688
  ds_read_b64_tr_b16 v[230:231], v103 offset:19200
  v_rcp_f32 v97, v97
  v_rcp_f32 v98, v98
  s_waitcnt lgkmcnt(8)
  v_mfma_f32_32x32x16_bf16 v[208:223], v[240:243], a[80:83], v[208:223]
  ds_read_b64_tr_b16 v[232:233], v103 offset:20736
  ds_read_b64_tr_b16 v[234:235], v103 offset:21248
  v_rcp_f32 v99, v99
  v_mul_f32 v96, v96, v196
  v_mul_f32 v97, v97, v197
  v_mul_f32 v98, v98, v198
  v_mfma_f32_32x32x16_bf16 v[208:223], v[244:247], a[84:87], v[208:223]
  ds_read_b64_tr_b16 v[236:237], v103 offset:22784
  ds_read_b64_tr_b16 v[238:239], v103 offset:23296
  s_add_u32 s55, s97, 6
  s_sub_u32 s68, s55, 10
  s_cmp_ge_u32 s55, 10
  s_cselect_b32 s55, s68, s55
  s_mul_i32 s55, s55, 221184
  s_add_u32 m0, s69, 32768
  s_add_u32 s55, s55, s67
  buffer_load_dwordx4 v105, s[12:15], s55 offen offset:0 lds
  v_mul_f32 v99, v99, v199
  v_cvt_pk_bf16_f32 v90, v96, v97
  v_cvt_pk_bf16_f32 v91, v98, v99
  v_fma_f32 v200, v200, v107, v72
  v_fma_f32 v201, v201, v107, v73
  s_waitcnt lgkmcnt(8)
  v_mfma_f32_32x32x16_bf16 v[208:223], v[248:251], a[88:91], v[208:223]
  ds_read_b64_tr_b16 v[240:241], v103 offset:24832
  ds_read_b64_tr_b16 v[242:243], v103 offset:25344
  v_fma_f32 v202, v202, v107, v74
  v_fma_f32 v203, v203, v107, v75
  v_mul_f32 v96, v200, v200
  v_mul_f32 v97, v201, v201
  v_mfma_f32_32x32x16_bf16 v[208:223], v[252:255], a[92:95], v[208:223]
  ds_read_b64_tr_b16 v[244:245], v103 offset:26880
  ds_read_b64_tr_b16 v[246:247], v103 offset:27392
  buffer_load_dwordx4 v1, s[12:15], s55 offen offset:1024 lds
  v_mul_f32 v98, v202, v202
  v_mul_f32 v99, v203, v203
  v_fma_f32 v96, v96, v109, v110
  v_fma_f32 v97, v97, v109, v110
  v_fma_f32 v98, v98, v109, v110
  s_waitcnt lgkmcnt(8)
  v_mfma_f32_32x32x16_bf16 v[208:223], v[224:227], a[96:99], v[208:223]
  ds_read_b64_tr_b16 v[248:249], v103 offset:28928
  ds_read_b64_tr_b16 v[250:251], v103 offset:29440
  v_fma_f32 v99, v99, v109, v110
  v_mul_f32 v96, v96, v200
  v_mul_f32 v97, v97, v201
  v_mul_f32 v98, v98, v202
  v_mul_f32 v99, v99, v203
  v_mfma_f32_32x32x16_bf16 v[208:223], v[228:231], a[100:103], v[208:223]
  ds_read_b64_tr_b16 v[252:253], v103 offset:30976
  ds_read_b64_tr_b16 v[254:255], v103 offset:31488
  buffer_load_dwordx4 v2, s[12:15], s55 offen offset:2048 lds
  v_exp_f32 v96, v96
  v_exp_f32 v97, v97
  s_waitcnt lgkmcnt(8)
  v_mfma_f32_32x32x16_bf16 v[208:223], v[232:235], a[104:107], v[208:223]
  ds_read_b64_tr_b16 v[224:225], v103 offset:33024
  ds_read_b64_tr_b16 v[226:227], v103 offset:33536
  v_exp_f32 v98, v98
  v_exp_f32 v99, v99
  v_add_f32 v96, 1.0, v96
  v_mfma_f32_32x32x16_bf16 v[208:223], v[236:239], a[108:111], v[208:223]
  ds_read_b64_tr_b16 v[228:229], v103 offset:35072
  ds_read_b64_tr_b16 v[230:231], v103 offset:35584
  buffer_load_dwordx4 v3, s[12:15], s55 offen offset:3072 lds
  v_add_f32 v97, 1.0, v97
  v_add_f32 v98, 1.0, v98
  v_add_f32 v99, 1.0, v99
  v_rcp_f32 v96, v96
  s_waitcnt lgkmcnt(8)
  v_mfma_f32_32x32x16_bf16 v[208:223], v[240:243], a[112:115], v[208:223]
  ds_read_b64_tr_b16 v[232:233], v103 offset:37120
  ds_read_b64_tr_b16 v[234:235], v103 offset:37632
  v_rcp_f32 v97, v97
  v_rcp_f32 v98, v98
  v_mfma_f32_32x32x16_bf16 v[208:223], v[244:247], a[116:119], v[208:223]
  ds_read_b64_tr_b16 v[236:237], v103 offset:39168
  ds_read_b64_tr_b16 v[238:239], v103 offset:39680
  s_add_u32 s55, s97, 8
  s_sub_u32 s68, s55, 10
  s_cmp_ge_u32 s55, 10
  s_cselect_b32 s55, s68, s55
  s_mul_i32 s55, s55, 221184
  s_add_u32 m0, s69, 49152
  s_add_u32 s55, s55, s67
  buffer_load_dwordx4 v105, s[12:15], s55 offen offset:0 lds
  v_rcp_f32 v99, v99
  v_mul_f32 v96, v96, v200
  v_mul_f32 v97, v97, v201
  v_mul_f32 v98, v98, v202
  s_waitcnt lgkmcnt(8)
  v_mfma_f32_32x32x16_bf16 v[208:223], v[248:251], a[120:123], v[208:223]
  ds_read_b64_tr_b16 v[240:241], v103 offset:41216
  ds_read_b64_tr_b16 v[242:243], v103 offset:41728
  v_mul_f32 v99, v99, v203
  v_cvt_pk_bf16_f32 v92, v96, v97
  v_cvt_pk_bf16_f32 v93, v98, v99
  v_fma_f32 v204, v204, v107, v76
  v_fma_f32 v205, v205, v107, v77
  v_mfma_f32_32x32x16_bf16 v[208:223], v[252:255], a[124:127], v[208:223]
  ds_read_b64_tr_b16 v[244:245], v103 offset:43264
  ds_read_b64_tr_b16 v[246:247], v103 offset:43776
  buffer_load_dwordx4 v1, s[12:15], s55 offen offset:1024 lds
  v_fma_f32 v206, v206, v107, v78
  v_fma_f32 v207, v207, v107, v79
  v_mul_f32 v96, v204, v204
  v_mul_f32 v97, v205, v205
  s_waitcnt lgkmcnt(8)
  v_mfma_f32_32x32x16_bf16 v[208:223], v[224:227], a[128:131], v[208:223]
  ds_read_b64_tr_b16 v[248:249], v103 offset:45312
  ds_read_b64_tr_b16 v[250:251], v103 offset:45824
  v_mul_f32 v98, v206, v206
  v_mul_f32 v99, v207, v207
  v_fma_f32 v96, v96, v109, v110
  v_fma_f32 v97, v97, v109, v110
  v_fma_f32 v98, v98, v109, v110
  v_mfma_f32_32x32x16_bf16 v[208:223], v[228:231], a[132:135], v[208:223]
  ds_read_b64_tr_b16 v[252:253], v103 offset:47360
  ds_read_b64_tr_b16 v[254:255], v103 offset:47872
  buffer_load_dwordx4 v2, s[12:15], s55 offen offset:2048 lds
  v_fma_f32 v99, v99, v109, v110
  v_mul_f32 v96, v96, v204
  v_mul_f32 v97, v97, v205
  v_mul_f32 v98, v98, v206
  v_mul_f32 v99, v99, v207
  s_waitcnt lgkmcnt(8)
  v_mfma_f32_32x32x16_bf16 v[208:223], v[232:235], a[136:139], v[208:223]
  s_waitcnt vmcnt(22)
  s_waitcnt vmcnt(16)
  s_waitcnt vmcnt(10)
  s_waitcnt vmcnt(7)
  s_barrier
  s_lshl_b32 s56, s38, 3
  s_add_u32 s56, s56, 23396352
  buffer_store_dwordx2 v[38:39], v36, s[8:11], s56 offen sc1
  ds_read_b64_tr_b16 v[224:225], v103 offset:49152
  ds_read_b64_tr_b16 v[226:227], v103 offset:49664
  v_exp_f32 v96, v96
  v_exp_f32 v97, v97
  v_mfma_f32_32x32x16_bf16 v[208:223], v[236:239], a[140:143], v[208:223]
  ds_read_b64_tr_b16 v[228:229], v103 offset:51200
  ds_read_b64_tr_b16 v[230:231], v103 offset:51712
  buffer_load_dwordx4 v3, s[12:15], s55 offen offset:3072 lds
  v_exp_f32 v98, v98
  v_exp_f32 v99, v99
  v_add_f32 v96, 1.0, v96
  s_waitcnt lgkmcnt(8)
  v_mfma_f32_32x32x16_bf16 v[208:223], v[240:243], a[144:147], v[208:223]
  ds_read_b64_tr_b16 v[232:233], v103 offset:53248
  ds_read_b64_tr_b16 v[234:235], v103 offset:53760
  s_mov_b32 s82, 23363584
  buffer_load_dwordx4 v[132:135], v35, s[8:11], s82 offen offset:0 sc1
  buffer_load_dwordx4 v[140:143], v35, s[8:11], s82 offen offset:1024 sc1
  v_add_f32 v97, 1.0, v97
  v_add_f32 v98, 1.0, v98
  v_add_f32 v99, 1.0, v99
  v_rcp_f32 v96, v96
  v_mfma_f32_32x32x16_bf16 v[208:223], v[244:247], a[148:151], v[208:223]
  ds_read_b64_tr_b16 v[236:237], v103 offset:55296
  ds_read_b64_tr_b16 v[238:239], v103 offset:55808
  v_rcp_f32 v97, v97
  v_rcp_f32 v98, v98
  s_waitcnt lgkmcnt(8)
  v_mfma_f32_32x32x16_bf16 v[208:223], v[248:251], a[152:155], v[208:223]
  ds_read_b64_tr_b16 v[240:241], v103 offset:57344
  ds_read_b64_tr_b16 v[242:243], v103 offset:57856
  v_rcp_f32 v99, v99
  v_mul_f32 v96, v96, v204
  v_mul_f32 v97, v97, v205
  v_mul_f32 v98, v98, v206
  v_mfma_f32_32x32x16_bf16 v[208:223], v[252:255], a[156:159], v[208:223]
  ds_read_b64_tr_b16 v[244:245], v103 offset:59392
  ds_read_b64_tr_b16 v[246:247], v103 offset:59904
  v_mul_f32 v99, v99, v207
  v_cvt_pk_bf16_f32 v94, v96, v97
  v_cvt_pk_bf16_f32 v95, v98, v99
  buffer_store_dwordx4 v[88:91], v35, s[8:11], s61 offen offset:0 sc1
  buffer_store_dwordx4 v[92:95], v35, s[8:11], s61 offen offset:1024 sc1
  s_waitcnt lgkmcnt(8)
  v_mfma_f32_32x32x16_bf16 v[192:207], v[224:227], a[0:3], 0
  ds_read_b64_tr_b16 v[248:249], v103 offset:61440
  ds_read_b64_tr_b16 v[250:251], v103 offset:61952
  v_mfma_f32_32x32x16_bf16 v[192:207], v[228:231], a[4:7], v[192:207]
  ds_read_b64_tr_b16 v[252:253], v103 offset:63488
  ds_read_b64_tr_b16 v[254:255], v103 offset:64000
  s_waitcnt lgkmcnt(8)
  v_mfma_f32_32x32x16_bf16 v[192:207], v[232:235], a[8:11], v[192:207]
  ds_read_b64_tr_b16 v[224:225], v102 offset:0
  ds_read_b64_tr_b16 v[226:227], v102 offset:512
  ds_read_b128 v[64:67], v108 offset:128
  ds_read_b128 v[68:71], v108 offset:144
  ds_read_b128 v[72:75], v108 offset:192
  ds_read_b128 v[76:79], v108 offset:208
  v_mfma_f32_32x32x16_bf16 v[192:207], v[236:239], a[12:15], v[192:207]
  ds_read_b64_tr_b16 v[228:229], v102 offset:2048
  ds_read_b64_tr_b16 v[230:231], v102 offset:2560
  s_waitcnt lgkmcnt(2)
  v_fma_f32 v208, v208, v107, v64
  v_fma_f32 v209, v209, v107, v65
  v_mfma_f32_32x32x16_bf16 v[192:207], v[240:243], a[16:19], v[192:207]
  ds_read_b64_tr_b16 v[232:233], v102 offset:4096
  ds_read_b64_tr_b16 v[234:235], v102 offset:4608
  v_fma_f32 v210, v210, v107, v66
  v_fma_f32 v211, v211, v107, v67
  v_mul_f32 v96, v208, v208
  v_mul_f32 v97, v209, v209
  v_mfma_f32_32x32x16_bf16 v[192:207], v[244:247], a[20:23], v[192:207]
  ds_read_b64_tr_b16 v[236:237], v102 offset:6144
  ds_read_b64_tr_b16 v[238:239], v102 offset:6656
  v_mul_f32 v98, v210, v210
  v_mul_f32 v99, v211, v211
  v_fma_f32 v96, v96, v109, v110
  v_fma_f32 v97, v97, v109, v110
  v_fma_f32 v98, v98, v109, v110
  v_mfma_f32_32x32x16_bf16 v[192:207], v[248:251], a[24:27], v[192:207]
  ds_read_b64_tr_b16 v[240:241], v102 offset:8192
  ds_read_b64_tr_b16 v[242:243], v102 offset:8704
  v_fma_f32 v99, v99, v109, v110
  v_mul_f32 v96, v96, v208
  v_mul_f32 v97, v97, v209
  v_mul_f32 v98, v98, v210
  v_mul_f32 v99, v99, v211
  v_mfma_f32_32x32x16_bf16 v[192:207], v[252:255], a[28:31], v[192:207]
  ds_read_b64_tr_b16 v[244:245], v102 offset:10240
  ds_read_b64_tr_b16 v[246:247], v102 offset:10752
  v_exp_f32 v96, v96
  v_exp_f32 v97, v97
  s_waitcnt lgkmcnt(8)
  v_mfma_f32_32x32x16_bf16 v[192:207], v[224:227], a[32:35], v[192:207]
  ds_read_b64_tr_b16 v[248:249], v102 offset:12288
  ds_read_b64_tr_b16 v[250:251], v102 offset:12800
  v_exp_f32 v98, v98
  v_exp_f32 v99, v99
  v_add_f32 v96, 1.0, v96
  v_mfma_f32_32x32x16_bf16 v[192:207], v[228:231], a[36:39], v[192:207]
  ds_read_b64_tr_b16 v[252:253], v102 offset:14336
  ds_read_b64_tr_b16 v[254:255], v102 offset:14848
  v_add_f32 v97, 1.0, v97
  v_add_f32 v98, 1.0, v98
  v_add_f32 v99, 1.0, v99
  v_rcp_f32 v96, v96
  s_waitcnt lgkmcnt(8)
  v_mfma_f32_32x32x16_bf16 v[192:207], v[232:235], a[40:43], v[192:207]
  ds_read_b64_tr_b16 v[224:225], v102 offset:16384
  ds_read_b64_tr_b16 v[226:227], v102 offset:16896
  v_rcp_f32 v97, v97
  v_rcp_f32 v98, v98
  v_mfma_f32_32x32x16_bf16 v[192:207], v[236:239], a[44:47], v[192:207]
  ds_read_b64_tr_b16 v[228:229], v102 offset:18432
  ds_read_b64_tr_b16 v[230:231], v102 offset:18944
  v_rcp_f32 v99, v99
  v_mul_f32 v96, v96, v208
  v_mul_f32 v97, v97, v209
  v_mul_f32 v98, v98, v210
  s_waitcnt lgkmcnt(8)
  v_mfma_f32_32x32x16_bf16 v[192:207], v[240:243], a[48:51], v[192:207]
  ds_read_b64_tr_b16 v[232:233], v102 offset:20480
  ds_read_b64_tr_b16 v[234:235], v102 offset:20992
  s_waitcnt vmcnt(2)
  v_xor_b32 v132, v38, v132
  v_xor_b32 v133, v39, v133
  v_or_b32 v132, v132, v133
  v_xor_b32 v134, v38, v134
  v_xor_b32 v135, v39, v135
  v_or3_b32 v132, v132, v134, v135
  v_xor_b32 v140, v38, v140
  v_xor_b32 v141, v39, v141
  v_or3_b32 v132, v132, v140, v141
  v_xor_b32 v142, v38, v142
  v_xor_b32 v143, v39, v143
  v_or3_b32 v132, v132, v142, v143
  v_cmp_ne_u32 vcc, 0, v132
  s_nop 4
  s_cbranch_vccz L_pok1
  s_mov_b32 s57, 0
L_pspin1:
  s_sleep 1
  buffer_load_dwordx4 v[132:135], v35, s[8:11], s82 offen offset:0 sc1
  buffer_load_dwordx4 v[140:143], v35, s[8:11], s82 offen offset:1024 sc1
  s_add_u32 s57, s57, 1
  s_waitcnt vmcnt(0)
  v_xor_b32 v132, v38, v132
  v_xor_b32 v133, v39, v133
  v_or_b32 v132, v132, v133
  v_xor_b32 v134, v38, v134
  v_xor_b32 v135, v39, v135
  v_or3_b32 v132, v132, v134, v135
  v_xor_b32 v140, v38, v140
  v_xor_b32 v141, v39, v141
  v_or3_b32 v132, v132, v140, v141
  v_xor_b32 v142, v38, v142
  v_xor_b32 v143, v39, v143
  v_or3_b32 v132, v132, v142, v143
  v_cmp_ne_u32 vcc, 0, v132
  s_nop 4
  s_cmp_gt_u32 s57, 100000
  s_cbranch_scc1 L_pok1
  s_cbranch_vccnz L_pspin1
L_pok1:
  v_mul_f32 v99, v99, v211
  v_cvt_pk_bf16_f32 v88, v96, v97
  v_cvt_pk_bf16_f32 v89, v98, v99
  v_fma_f32 v212, v212, v107, v68
  v_fma_f32 v213, v213, v107, v69
  v_mfma_f32_32x32x16_bf16 v[192:207], v[244:247], a[52:55], v[192:207]
  ds_read_b64_tr_b16 v[236:237], v102 offset:22528
  ds_read_b64_tr_b16 v[238:239], v102 offset:23040
  s_add_u32 s90, s88, 0
  buffer_load_dwordx4 a[160:163], v35, s[8:11], s90 offen offset:0 sc1
  v_fma_f32 v214, v214, v107, v70
  v_fma_f32 v215, v215, v107, v71
  v_mul_f32 v96, v212, v212
  v_mul_f32 v97, v213, v213
  s_waitcnt lgkmcnt(8)
  v_mfma_f32_32x32x16_bf16 v[192:207], v[248:251], a[56:59], v[192:207]
  ds_read_b64_tr_b16 v[240:241], v102 offset:24576
  ds_read_b64_tr_b16 v[242:243], v102 offset:25088
  v_mul_f32 v98, v214, v214
  v_mul_f32 v99, v215, v215
  v_fma_f32 v96, v96, v109, v110
  v_fma_f32 v97, v97, v109, v110
  v_fma_f32 v98, v98, v109, v110
  v_mfma_f32_32x32x16_bf16 v[192:207], v[252:255], a[60:63], v[192:207]
  ds_read_b64_tr_b16 v[244:245], v102 offset:26624
  ds_read_b64_tr_b16 v[246:247], v102 offset:27136
  buffer_load_dwordx4 a[164:167], v35, s[8:11], s90 offen offset:1024 sc1
  v_fma_f32 v99, v99, v109, v110
  v_mul_f32 v96, v96, v212
  v_mul_f32 v97, v97, v213
  v_mul_f32 v98, v98, v214
  v_mul_f32 v99, v99, v215
  s_waitcnt lgkmcnt(8)
  v_mfma_f32_32x32x16_bf16 v[192:207], v[224:227], a[64:67], v[192:207]
  ds_read_b64_tr_b16 v[248:249], v102 offset:28672
  ds_read_b64_tr_b16 v[250:251], v102 offset:29184
  v_exp_f32 v96, v96
  v_exp_f32 v97, v97
  v_mfma_f32_32x32x16_bf16 v[192:207], v[228:231], a[68:71], v[192:207]
  ds_read_b64_tr_b16 v[252:253], v102 offset:30720
  ds_read_b64_tr_b16 v[254:255], v102 offset:31232
  buffer_load_dwordx4 a[168:171], v35, s[8:11], s90 offen offset:2048 sc1
  v_exp_f32 v98, v98
  v_exp_f32 v99, v99
  v_add_f32 v96, 1.0, v96
  s_waitcnt lgkmcnt(8)
  v_mfma_f32_32x32x16_bf16 v[192:207], v[232:235], a[72:75], v[192:207]
  s_barrier
  ds_read_b64_tr_b16 v[224:225], v102 offset:32768
  ds_read_b64_tr_b16 v[226:227], v102 offset:33280
  v_add_f32 v97, 1.0, v97
  v_add_f32 v98, 1.0, v98
  v_add_f32 v99, 1.0, v99
  v_rcp_f32 v96, v96
  v_mfma_f32_32x32x16_bf16 v[192:207], v[236:239], a[76:79], v[192:207]
  ds_read_b64_tr_b16 v[228:229], v102 offset:34816
  ds_read_b64_tr_b16 v[230:231], v102 offset:35328
  buffer_load_dwordx4 a[172:175], v35, s[8:11], s90 offen offset:3072 sc1
  v_rcp_f32 v97, v97
  v_rcp_f32 v98, v98
  s_waitcnt lgkmcnt(8)
  v_mfma_f32_32x32x16_bf16 v[192:207], v[240:243], a[80:83], v[192:207]
  ds_read_b64_tr_b16 v[232:233], v102 offset:36864
  ds_read_b64_tr_b16 v[234:235], v102 offset:37376
  v_rcp_f32 v99, v99
  v_mul_f32 v96, v96, v212
  v_mul_f32 v97, v97, v213
  v_mul_f32 v98, v98, v214
  v_mfma_f32_32x32x16_bf16 v[192:207], v[244:247], a[84:87], v[192:207]
  ds_read_b64_tr_b16 v[236:237], v102 offset:38912
  ds_read_b64_tr_b16 v[238:239], v102 offset:39424
  s_add_u32 s90, s88, 4096
  buffer_load_dwordx4 a[176:179], v35, s[8:11], s90 offen offset:0 sc1
  v_mul_f32 v99, v99, v215
  v_cvt_pk_bf16_f32 v90, v96, v97
  v_cvt_pk_bf16_f32 v91, v98, v99
  v_fma_f32 v216, v216, v107, v72
  v_fma_f32 v217, v217, v107, v73
  s_waitcnt lgkmcnt(8)
  v_mfma_f32_32x32x16_bf16 v[192:207], v[248:251], a[88:91], v[192:207]
  ds_read_b64_tr_b16 v[240:241], v102 offset:40960
  ds_read_b64_tr_b16 v[242:243], v102 offset:41472
  v_fma_f32 v218, v218, v107, v74
  v_fma_f32 v219, v219, v107, v75
  v_mul_f32 v96, v216, v216
  v_mul_f32 v97, v217, v217
  v_mfma_f32_32x32x16_bf16 v[192:207], v[252:255], a[92:95], v[192:207]
  ds_read_b64_tr_b16 v[244:245], v102 offset:43008
  ds_read_b64_tr_b16 v[246:247], v102 offset:43520
  buffer_load_dwordx4 a[180:183], v35, s[8:11], s90 offen offset:1024 sc1
  v_mul_f32 v98, v218, v218
  v_mul_f32 v99, v219, v219
  v_fma_f32 v96, v96, v109, v110
  v_fma_f32 v97, v97, v109, v110
  v_fma_f32 v98, v98, v109, v110
  s_waitcnt lgkmcnt(8)
  v_mfma_f32_32x32x16_bf16 v[192:207], v[224:227], a[96:99], v[192:207]
  ds_read_b64_tr_b16 v[248:249], v102 offset:45056
  ds_read_b64_tr_b16 v[250:251], v102 offset:45568
  v_fma_f32 v99, v99, v109, v110
  v_mul_f32 v96, v96, v216
  v_mul_f32 v97, v97, v217
  v_mul_f32 v98, v98, v218
  v_mul_f32 v99, v99, v219
  v_mfma_f32_32x32x16_bf16 v[192:207], v[228:231], a[100:103], v[192:207]
  ds_read_b64_tr_b16 v[252:253], v102 offset:47104
  ds_read_b64_tr_b16 v[254:255], v102 offset:47616
  buffer_load_dwordx4 a[184:187], v35, s[8:11], s90 offen offset:2048 sc1
  v_exp_f32 v96, v96
  v_exp_f32 v97, v97
  s_waitcnt lgkmcnt(8)
  v_mfma_f32_32x32x16_bf16 v[192:207], v[232:235], a[104:107], v[192:207]
  ds_read_b64_tr_b16 v[224:225], v102 offset:49152
  ds_read_b64_tr_b16 v[226:227], v102 offset:49664
  v_exp_f32 v98, v98
  v_exp_f32 v99, v99
  v_add_f32 v96, 1.0, v96
  v_mfma_f32_32x32x16_bf16 v[192:207], v[236:239], a[108:111], v[192:207]
  ds_read_b64_tr_b16 v[228:229], v102 offset:51200
  ds_read_b64_tr_b16 v[230:231], v102 offset:51712
  buffer_load_dwordx4 a[188:191], v35, s[8:11], s90 offen offset:3072 sc1
  v_add_f32 v97, 1.0, v97
  v_add_f32 v98, 1.0, v98
  v_add_f32 v99, 1.0, v99
  v_rcp_f32 v96, v96
  s_waitcnt lgkmcnt(8)
  v_mfma_f32_32x32x16_bf16 v[192:207], v[240:243], a[112:115], v[192:207]
  ds_read_b64_tr_b16 v[232:233], v102 offset:53248
  ds_read_b64_tr_b16 v[234:235], v102 offset:53760
  v_rcp_f32 v97, v97
  v_rcp_f32 v98, v98
  v_mfma_f32_32x32x16_bf16 v[192:207], v[244:247], a[116:119], v[192:207]
  ds_read_b64_tr_b16 v[236:237], v102 offset:55296
  ds_read_b64_tr_b16 v[238:239], v102 offset:55808
  s_add_u32 s90, s88, 8192
  buffer_load_dwordx4 a[192:195], v35, s[8:11], s90 offen offset:0 sc1
  v_rcp_f32 v99, v99
  v_mul_f32 v96, v96, v216
  v_mul_f32 v97, v97, v217
  v_mul_f32 v98, v98, v218
  s_waitcnt lgkmcnt(8)
  v_mfma_f32_32x32x16_bf16 v[192:207], v[248:251], a[120:123], v[192:207]
  ds_read_b64_tr_b16 v[240:241], v102 offset:57344
  ds_read_b64_tr_b16 v[242:243], v102 offset:57856
  v_mul_f32 v99, v99, v219
  v_cvt_pk_bf16_f32 v92, v96, v97
  v_cvt_pk_bf16_f32 v93, v98, v99
  v_fma_f32 v220, v220, v107, v76
  v_fma_f32 v221, v221, v107, v77
  v_mfma_f32_32x32x16_bf16 v[192:207], v[252:255], a[124:127], v[192:207]
  ds_read_b64_tr_b16 v[244:245], v102 offset:59392
  ds_read_b64_tr_b16 v[246:247], v102 offset:59904
  buffer_load_dwordx4 a[196:199], v35, s[8:11], s90 offen offset:1024 sc1
  v_fma_f32 v222, v222, v107, v78
  v_fma_f32 v223, v223, v107, v79
  v_mul_f32 v96, v220, v220
  v_mul_f32 v97, v221, v221
  s_waitcnt lgkmcnt(8)
  v_mfma_f32_32x32x16_bf16 v[192:207], v[224:227], a[128:131], v[192:207]
  ds_read_b64_tr_b16 v[248:249], v102 offset:61440
  ds_read_b64_tr_b16 v[250:251], v102 offset:61952
  v_mul_f32 v98, v222, v222
  v_mul_f32 v99, v223, v223
  v_fma_f32 v96, v96, v109, v110
  v_fma_f32 v97, v97, v109, v110
  v_fma_f32 v98, v98, v109, v110
  v_mfma_f32_32x32x16_bf16 v[192:207], v[228:231], a[132:135], v[192:207]
  ds_read_b64_tr_b16 v[252:253], v102 offset:63488
  ds_read_b64_tr_b16 v[254:255], v102 offset:64000
  buffer_load_dwordx4 a[200:203], v35, s[8:11], s90 offen offset:2048 sc1
  v_fma_f32 v99, v99, v109, v110
  v_mul_f32 v96, v96, v220
  v_mul_f32 v97, v97, v221
  v_mul_f32 v98, v98, v222
  v_mul_f32 v99, v99, v223
  s_waitcnt lgkmcnt(8)
  v_mfma_f32_32x32x16_bf16 v[192:207], v[232:235], a[136:139], v[192:207]
  ds_read_b64_tr_b16 v[224:225], v103 offset:49408
  ds_read_b64_tr_b16 v[226:227], v103 offset:49920
  v_exp_f32 v96, v96
  v_exp_f32 v97, v97
  v_mfma_f32_32x32x16_bf16 v[192:207], v[236:239], a[140:143], v[192:207]
  ds_read_b64_tr_b16 v[228:229], v103 offset:51456
  ds_read_b64_tr_b16 v[230:231], v103 offset:51968
  buffer_load_dwordx4 a[204:207], v35, s[8:11], s90 offen offset:3072 sc1
  v_exp_f32 v98, v98
  v_exp_f32 v99, v99
  v_add_f32 v96, 1.0, v96
  s_waitcnt lgkmcnt(8)
  v_mfma_f32_32x32x16_bf16 v[192:207], v[240:243], a[144:147], v[192:207]
  ds_read_b64_tr_b16 v[232:233], v103 offset:53504
  ds_read_b64_tr_b16 v[234:235], v103 offset:54016
  v_add_f32 v97, 1.0, v97
  v_add_f32 v98, 1.0, v98
  v_add_f32 v99, 1.0, v99
  v_rcp_f32 v96, v96
  v_mfma_f32_32x32x16_bf16 v[192:207], v[244:247], a[148:151], v[192:207]
  ds_read_b64_tr_b16 v[236:237], v103 offset:55552
  ds_read_b64_tr_b16 v[238:239], v103 offset:56064
  s_add_u32 s90, s88, 12288
  buffer_load_dwordx4 a[208:211], v35, s[8:11], s90 offen offset:0 sc1
  v_rcp_f32 v97, v97
  v_rcp_f32 v98, v98
  s_waitcnt lgkmcnt(8)
  v_mfma_f32_32x32x16_bf16 v[192:207], v[248:251], a[152:155], v[192:207]
  ds_read_b64_tr_b16 v[240:241], v103 offset:57600
  ds_read_b64_tr_b16 v[242:243], v103 offset:58112
  v_rcp_f32 v99, v99
  v_mul_f32 v96, v96, v220
  v_mul_f32 v97, v97, v221
  v_mul_f32 v98, v98, v222
  v_mfma_f32_32x32x16_bf16 v[192:207], v[252:255], a[156:159], v[192:207]
  ds_read_b64_tr_b16 v[244:245], v103 offset:59648
  ds_read_b64_tr_b16 v[246:247], v103 offset:60160
  buffer_load_dwordx4 a[212:215], v35, s[8:11], s90 offen offset:1024 sc1
  v_mul_f32 v99, v99, v223
  v_cvt_pk_bf16_f32 v94, v96, v97
  v_cvt_pk_bf16_f32 v95, v98, v99
  buffer_store_dwordx4 v[88:91], v35, s[8:11], s61 offen offset:2048 sc1
  buffer_store_dwordx4 v[92:95], v35, s[8:11], s61 offen offset:3072 sc1
  s_waitcnt lgkmcnt(8)
  v_mfma_f32_32x32x16_bf16 v[208:223], v[224:227], a[0:3], 0
  ds_read_b64_tr_b16 v[248:249], v103 offset:61696
  ds_read_b64_tr_b16 v[250:251], v103 offset:62208
  v_mfma_f32_32x32x16_bf16 v[208:223], v[228:231], a[4:7], v[208:223]
  ds_read_b64_tr_b16 v[252:253], v103 offset:63744
  ds_read_b64_tr_b16 v[254:255], v103 offset:64256
  buffer_load_dwordx4 a[216:219], v35, s[8:11], s90 offen offset:2048 sc1
  s_waitcnt lgkmcnt(8)
  v_mfma_f32_32x32x16_bf16 v[208:223], v[232:235], a[8:11], v[208:223]
  ds_read_b64_tr_b16 v[224:225], v102 offset:256
  ds_read_b64_tr_b16 v[226:227], v102 offset:768
  ds_read_b128 v[64:67], v108 offset:256
  ds_read_b128 v[68:71], v108 offset:272
  ds_read_b128 v[72:75], v108 offset:320
  ds_read_b128 v[76:79], v108 offset:336
  v_mfma_f32_32x32x16_bf16 v[208:223], v[236:239], a[12:15], v[208:223]
  ds_read_b64_tr_b16 v[228:229], v102 offset:2304
  ds_read_b64_tr_b16 v[230:231], v102 offset:2816
  buffer_load_dwordx4 a[220:223], v35, s[8:11], s90 offen offset:3072 sc1
  s_waitcnt lgkmcnt(2)
  v_fma_f32 v192, v192, v107, v64
  v_fma_f32 v193, v193, v107, v65
  v_mfma_f32_32x32x16_bf16 v[208:223], v[240:243], a[16:19], v[208:223]
  ds_read_b64_tr_b16 v[232:233], v102 offset:4352
  ds_read_b64_tr_b16 v[234:235], v102 offset:4864
  v_fma_f32 v194, v194, v107, v66
  v_fma_f32 v195, v195, v107, v67
  v_mul_f32 v96, v192, v192
  v_mul_f32 v97, v193, v193
  v_mfma_f32_32x32x16_bf16 v[208:223], v[244:247], a[20:23], v[208:223]
  ds_read_b64_tr_b16 v[236:237], v102 offset:6400
  ds_read_b64_tr_b16 v[238:239], v102 offset:6912
  s_add_u32 s90, s88, 16384
  buffer_load_dwordx4 a[224:227], v35, s[8:11], s90 offen offset:0 sc1
  v_mul_f32 v98, v194, v194
  v_mul_f32 v99, v195, v195
  v_fma_f32 v96, v96, v109, v110
  v_fma_f32 v97, v97, v109, v110
  v_fma_f32 v98, v98, v109, v110
  v_mfma_f32_32x32x16_bf16 v[208:223], v[248:251], a[24:27], v[208:223]
  ds_read_b64_tr_b16 v[240:241], v102 offset:8448
  ds_read_b64_tr_b16 v[242:243], v102 offset:8960
  v_fma_f32 v99, v99, v109, v110
  v_mul_f32 v96, v96, v192
  v_mul_f32 v97, v97, v193
  v_mul_f32 v98, v98, v194
  v_mul_f32 v99, v99, v195
  v_mfma_f32_32x32x16_bf16 v[208:223], v[252:255], a[28:31], v[208:223]
  ds_read_b64_tr_b16 v[244:245], v102 offset:10496
  ds_read_b64_tr_b16 v[246:247], v102 offset:11008
  buffer_load_dwordx4 a[228:231], v35, s[8:11], s90 offen offset:1024 sc1
  v_exp_f32 v96, v96
  v_exp_f32 v97, v97
  s_waitcnt lgkmcnt(8)
  v_mfma_f32_32x32x16_bf16 v[208:223], v[224:227], a[32:35], v[208:223]
  ds_read_b64_tr_b16 v[248:249], v102 offset:12544
  ds_read_b64_tr_b16 v[250:251], v102 offset:13056
  v_exp_f32 v98, v98
  v_exp_f32 v99, v99
  v_add_f32 v96, 1.0, v96
  v_mfma_f32_32x32x16_bf16 v[208:223], v[228:231], a[36:39], v[208:223]
  ds_read_b64_tr_b16 v[252:253], v102 offset:14592
  ds_read_b64_tr_b16 v[254:255], v102 offset:15104
  buffer_load_dwordx4 a[232:235], v35, s[8:11], s90 offen offset:2048 sc1
  v_add_f32 v97, 1.0, v97
  v_add_f32 v98, 1.0, v98
  v_add_f32 v99, 1.0, v99
  v_rcp_f32 v96, v96
  s_waitcnt lgkmcnt(8)
  v_mfma_f32_32x32x16_bf16 v[208:223], v[232:235], a[40:43], v[208:223]
  ds_read_b64_tr_b16 v[224:225], v102 offset:16640
  ds_read_b64_tr_b16 v[226:227], v102 offset:17152
  v_rcp_f32 v97, v97
  v_rcp_f32 v98, v98
  v_mfma_f32_32x32x16_bf16 v[208:223], v[236:239], a[44:47], v[208:223]
  ds_read_b64_tr_b16 v[228:229], v102 offset:18688
  ds_read_b64_tr_b16 v[230:231], v102 offset:19200
  buffer_load_dwordx4 a[236:239], v35, s[8:11], s90 offen offset:3072 sc1
  v_rcp_f32 v99, v99
  v_mul_f32 v96, v96, v192
  v_mul_f32 v97, v97, v193
  v_mul_f32 v98, v98, v194
  s_waitcnt lgkmcnt(8)
  v_mfma_f32_32x32x16_bf16 v[208:223], v[240:243], a[48:51], v[208:223]
  ds_read_b64_tr_b16 v[232:233], v102 offset:20736
  ds_read_b64_tr_b16 v[234:235], v102 offset:21248
  v_mul_f32 v99, v99, v195
  v_cvt_pk_bf16_f32 v88, v96, v97
  v_cvt_pk_bf16_f32 v89, v98, v99
  v_fma_f32 v196, v196, v107, v68
  v_fma_f32 v197, v197, v107, v69
  v_mfma_f32_32x32x16_bf16 v[208:223], v[244:247], a[52:55], v[208:223]
  ds_read_b64_tr_b16 v[236:237], v102 offset:22784
  ds_read_b64_tr_b16 v[238:239], v102 offset:23296
  s_add_u32 s90, s88, 20480
  buffer_load_dwordx4 a[240:243], v35, s[8:11], s90 offen offset:0 sc1
  v_fma_f32 v198, v198, v107, v70
  v_fma_f32 v199, v199, v107, v71
  v_mul_f32 v96, v196, v196
  v_mul_f32 v97, v197, v197
  s_waitcnt lgkmcnt(8)
  v_mfma_f32_32x32x16_bf16 v[208:223], v[248:251], a[56:59], v[208:223]
  ds_read_b64_tr_b16 v[240:241], v102 offset:24832
  ds_read_b64_tr_b16 v[242:243], v102 offset:25344
  s_mov_b32 s82, 23396352
  buffer_load_dwordx2 v[6:7], v111, s[8:11], s82 offen sc1
  v_mul_f32 v98, v198, v198
  v_mul_f32 v99, v199, v199
  v_fma_f32 v96, v96, v109, v110
  v_fma_f32 v97, v97, v109, v110
  v_fma_f32 v98, v98, v109, v110
  v_mfma_f32_32x32x16_bf16 v[208:223], v[252:255], a[60:63], v[208:223]
  ds_read_b64_tr_b16 v[244:245], v102 offset:26880
  ds_read_b64_tr_b16 v[246:247], v102 offset:27392
  buffer_load_dwordx4 a[244:247], v35, s[8:11], s90 offen offset:1024 sc1
  v_fma_f32 v99, v99, v109, v110
  v_mul_f32 v96, v96, v196
  v_mul_f32 v97, v97, v197
  v_mul_f32 v98, v98, v198
  v_mul_f32 v99, v99, v199
  s_waitcnt lgkmcnt(8)
  v_mfma_f32_32x32x16_bf16 v[208:223], v[224:227], a[64:67], v[208:223]
  ds_read_b64_tr_b16 v[248:249], v102 offset:28928
  ds_read_b64_tr_b16 v[250:251], v102 offset:29440
  v_exp_f32 v96, v96
  v_exp_f32 v97, v97
  v_mfma_f32_32x32x16_bf16 v[208:223], v[228:231], a[68:71], v[208:223]
  ds_read_b64_tr_b16 v[252:253], v102 offset:30976
  ds_read_b64_tr_b16 v[254:255], v102 offset:31488
  buffer_load_dwordx4 a[248:251], v35, s[8:11], s90 offen offset:2048 sc1
  v_exp_f32 v98, v98
  v_exp_f32 v99, v99
  v_add_f32 v96, 1.0, v96
  s_waitcnt lgkmcnt(8)
  v_mfma_f32_32x32x16_bf16 v[208:223], v[232:235], a[72:75], v[208:223]
  ds_read_b64_tr_b16 v[224:225], v102 offset:33024
  ds_read_b64_tr_b16 v[226:227], v102 offset:33536
  v_add_f32 v97, 1.0, v97
  v_add_f32 v98, 1.0, v98
  v_add_f32 v99, 1.0, v99
  v_rcp_f32 v96, v96
  v_mfma_f32_32x32x16_bf16 v[208:223], v[236:239], a[76:79], v[208:223]
  ds_read_b64_tr_b16 v[228:229], v102 offset:35072
  ds_read_b64_tr_b16 v[230:231], v102 offset:35584
  buffer_load_dwordx4 a[252:255], v35, s[8:11], s90 offen offset:3072 sc1
  v_rcp_f32 v97, v97
  v_rcp_f32 v98, v98
  s_waitcnt lgkmcnt(8)
  v_mfma_f32_32x32x16_bf16 v[208:223], v[240:243], a[80:83], v[208:223]
  ds_read_b64_tr_b16 v[232:233], v102 offset:37120
  ds_read_b64_tr_b16 v[234:235], v102 offset:37632
  v_rcp_f32 v99, v99
  v_mul_f32 v96, v96, v196
  v_mul_f32 v97, v97, v197
  v_mul_f32 v98, v98, v198
  v_mfma_f32_32x32x16_bf16 v[208:223], v[244:247], a[84:87], v[208:223]
  ds_read_b64_tr_b16 v[236:237], v102 offset:39168
  ds_read_b64_tr_b16 v[238:239], v102 offset:39680
  v_mul_f32 v99, v99, v199
  v_cvt_pk_bf16_f32 v90, v96, v97
  v_cvt_pk_bf16_f32 v91, v98, v99
  v_fma_f32 v200, v200, v107, v72
  v_fma_f32 v201, v201, v107, v73
  s_waitcnt lgkmcnt(8)
  v_mfma_f32_32x32x16_bf16 v[208:223], v[248:251], a[88:91], v[208:223]
  ds_read_b64_tr_b16 v[240:241], v102 offset:41216
  ds_read_b64_tr_b16 v[242:243], v102 offset:41728
  v_fma_f32 v202, v202, v107, v74
  v_fma_f32 v203, v203, v107, v75
  v_mul_f32 v96, v200, v200
  v_mul_f32 v97, v201, v201
  v_mfma_f32_32x32x16_bf16 v[208:223], v[252:255], a[92:95], v[208:223]
  ds_read_b64_tr_b16 v[244:245], v102 offset:43264
  ds_read_b64_tr_b16 v[246:247], v102 offset:43776
  v_mul_f32 v98, v202, v202
  v_mul_f32 v99, v203, v203
  v_fma_f32 v96, v96, v109, v110
  v_fma_f32 v97, v97, v109, v110
  v_fma_f32 v98, v98, v109, v110
  s_waitcnt lgkmcnt(8)
  v_mfma_f32_32x32x16_bf16 v[208:223], v[224:227], a[96:99], v[208:223]
  ds_read_b64_tr_b16 v[248:249], v102 offset:45312
  ds_read_b64_tr_b16 v[250:251], v102 offset:45824
  v_fma_f32 v99, v99, v109, v110
  v_mul_f32 v96, v96, v200
  v_mul_f32 v97, v97, v201
  v_mul_f32 v98, v98, v202
  v_mul_f32 v99, v99, v203
  v_mfma_f32_32x32x16_bf16 v[208:223], v[228:231], a[100:103], v[208:223]
  ds_read_b64_tr_b16 v[252:253], v102 offset:47360
  ds_read_b64_tr_b16 v[254:255], v102 offset:47872
  v_exp_f32 v96, v96
  v_exp_f32 v97, v97
  s_waitcnt lgkmcnt(8)
  v_mfma_f32_32x32x16_bf16 v[208:223], v[232:235], a[104:107], v[208:223]
  ds_read_b64_tr_b16 v[224:225], v102 offset:49408
  ds_read_b64_tr_b16 v[226:227], v102 offset:49920
  v_exp_f32 v98, v98
  v_exp_f32 v99, v99
  v_add_f32 v96, 1.0, v96
  v_mfma_f32_32x32x16_bf16 v[208:223], v[236:239], a[108:111], v[208:223]
  ds_read_b64_tr_b16 v[228:229], v102 offset:51456
  ds_read_b64_tr_b16 v[230:231], v102 offset:51968
  s_waitcnt vmcnt(3)
  v_xor_b32 v6, v38, v6
  v_xor_b32 v7, v39, v7
  v_or_b32 v6, v6, v7
  v_cmp_ne_u32 vcc, 0, v6
  s_nop 4
  s_cbranch_vccz L_pok2
  s_mov_b32 s57, 0
L_pspin2:
  s_sleep 1
  buffer_load_dwordx2 v[6:7], v111, s[8:11], s82 offen sc1
  s_add_u32 s57, s57, 1
  s_waitcnt vmcnt(0)
  v_xor_b32 v6, v38, v6
  v_xor_b32 v7, v39, v7
  v_or_b32 v6, v6, v7
  v_cmp_ne_u32 vcc, 0, v6
  s_nop 4
  s_cmp_gt_u32 s57, 100000
  s_cbranch_scc1 L_pok2
  s_cbranch_vccnz L_pspin2
L_pok2:
  v_add_f32 v97, 1.0, v97
  v_add_f32 v98, 1.0, v98
  v_add_f32 v99, 1.0, v99
  v_rcp_f32 v96, v96
  s_waitcnt lgkmcnt(8)
  v_mfma_f32_32x32x16_bf16 v[208:223], v[240:243], a[112:115], v[208:223]
  ds_read_b64_tr_b16 v[232:233], v102 offset:53504
  ds_read_b64_tr_b16 v[234:235], v102 offset:54016
  buffer_load_dwordx4 v[8:11], v29, s[8:11], s34 offen sc1
  v_rcp_f32 v97, v97
  v_rcp_f32 v98, v98
  v_mfma_f32_32x32x16_bf16 v[208:223], v[244:247], a[116:119], v[208:223]
  ds_read_b64_tr_b16 v[236:237], v102 offset:55552
  ds_read_b64_tr_b16 v[238:239], v102 offset:56064
  buffer_load_dwordx2 v[12:13], v30, s[8:11], s34 offen sc1
  v_rcp_f32 v99, v99
  v_mul_f32 v96, v96, v200
  v_mul_f32 v97, v97, v201
  v_mul_f32 v98, v98, v202
  s_waitcnt lgkmcnt(8)
  v_mfma_f32_32x32x16_bf16 v[208:223], v[248:251], a[120:123], v[208:223]
  ds_read_b64_tr_b16 v[240:241], v102 offset:57600
  ds_read_b64_tr_b16 v[242:243], v102 offset:58112
  s_add_u32 s34, s34, 81920
  buffer_load_dwordx4 v[16:19], v29, s[8:11], s34 offen sc1
  v_mul_f32 v99, v99, v203
  v_cvt_pk_bf16_f32 v92, v96, v97
  v_cvt_pk_bf16_f32 v93, v98, v99
  v_fma_f32 v204, v204, v107, v76
  v_fma_f32 v205, v205, v107, v77
  v_mfma_f32_32x32x16_bf16 v[208:223], v[252:255], a[124:127], v[208:223]
  ds_read_b64_tr_b16 v[244:245], v102 offset:59648
  ds_read_b64_tr_b16 v[246:247], v102 offset:60160
  buffer_load_dwordx2 v[20:21], v30, s[8:11], s34 offen sc1
  v_fma_f32 v206, v206, v107, v78
  v_fma_f32 v207, v207, v107, v79
  v_mul_f32 v96, v204, v204
  v_mul_f32 v97, v205, v205
  s_waitcnt lgkmcnt(8)
  v_mfma_f32_32x32x16_bf16 v[208:223], v[224:227], a[128:131], v[208:223]
  ds_read_b64_tr_b16 v[248:249], v102 offset:61696
  ds_read_b64_tr_b16 v[250:251], v102 offset:62208
  s_lshl_b32 s44, s3, 13
  s_add_u32 m0, s44, 65536
  s_add_u32 s45, s32, 0
  buffer_load_dwordx4 v35, s[8:11], s45 offen sc1 lds
  v_mul_f32 v98, v206, v206
  v_mul_f32 v99, v207, v207
  v_fma_f32 v96, v96, v109, v110
  v_fma_f32 v97, v97, v109, v110
  v_fma_f32 v98, v98, v109, v110
  v_mfma_f32_32x32x16_bf16 v[208:223], v[228:231], a[132:135], v[208:223]
  ds_read_b64_tr_b16 v[252:253], v102 offset:63744
  ds_read_b64_tr_b16 v[254:255], v102 offset:64256
  buffer_load_dwordx4 v35, s[8:11], s45 offen offset:1024 sc1 lds
  v_fma_f32 v99, v99, v109, v110
  v_mul_f32 v96, v96, v204
  v_mul_f32 v97, v97, v205
  v_mul_f32 v98, v98, v206
  v_mul_f32 v99, v99, v207
  s_waitcnt lgkmcnt(8)
  v_mfma_f32_32x32x16_bf16 v[208:223], v[232:235], a[136:139], v[208:223]
  s_lshl_b32 s44, s3, 13
  s_add_u32 m0, s44, 67584
  s_add_u32 s45, s32, 81920
  buffer_load_dwordx4 v35, s[8:11], s45 offen sc1 lds
  v_exp_f32 v96, v96
  v_exp_f32 v97, v97
  v_mfma_f32_32x32x16_bf16 v[208:223], v[236:239], a[140:143], v[208:223]
  buffer_load_dwordx4 v35, s[8:11], s45 offen offset:1024 sc1 lds
  v_exp_f32 v98, v98
  v_exp_f32 v99, v99
  v_add_f32 v96, 1.0, v96
  s_waitcnt lgkmcnt(4)
  v_mfma_f32_32x32x16_bf16 v[208:223], v[240:243], a[144:147], v[208:223]
  s_lshl_b32 s44, s3, 13
  s_add_u32 m0, s44, 69632
  s_add_u32 s45, s32, 163840
  buffer_load_dwordx4 v35, s[8:11], s45 offen sc1 lds
  v_add_f32 v97, 1.0, v97
  v_add_f32 v98, 1.0, v98
  v_add_f32 v99, 1.0, v99
  v_rcp_f32 v96, v96
  v_mfma_f32_32x32x16_bf16 v[208:223], v[244:247], a[148:151], v[208:223]
  buffer_load_dwordx4 v35, s[8:11], s45 offen offset:1024 sc1 lds
  v_rcp_f32 v97, v97
  v_rcp_f32 v98, v98
  s_waitcnt lgkmcnt(0)
  v_mfma_f32_32x32x16_bf16 v[208:223], v[248:251], a[152:155], v[208:223]
  s_lshl_b32 s44, s3, 13
  s_add_u32 m0, s44, 71680
  s_add_u32 s45, s32, 245760
  buffer_load_dwordx4 v35, s[8:11], s45 offen sc1 lds
  v_rcp_f32 v99, v99
  v_mul_f32 v96, v96, v204
  v_mul_f32 v97, v97, v205
  v_mul_f32 v98, v98, v206
  v_mfma_f32_32x32x16_bf16 v[208:223], v[252:255], a[156:159], v[208:223]
  buffer_load_dwordx4 v35, s[8:11], s45 offen offset:1024 sc1 lds
  v_mul_f32 v99, v99, v207
  v_cvt_pk_bf16_f32 v94, v96, v97
  v_cvt_pk_bf16_f32 v95, v98, v99
  buffer_store_dwordx4 v[88:91], v35, s[8:11], s60 offen offset:0 sc1
  buffer_store_dwordx4 v[92:95], v35, s[8:11], s60 offen offset:1024 sc1
  v_mov_b32 v135, 0x3f80
  v_mov_b32 v143, 0x3f80
  v_mov_b32 v200, 0xff7fffff
  v_mov_b32 v201, 0xff7fffff
  s_cmp_gt_u32 s36, 0
  s_cselect_b32 s84, 0x3f80f149, 1.0
  s_cmp_gt_u32 s36, 1
  s_cselect_b32 s85, 0x3f80f149, 1.0
  s_cmp_gt_u32 s36, 2
  s_cselect_b32 s86, 0x3f80f149, 1.0
  s_cmp_gt_u32 s36, 3
  s_cselect_b32 s87, 0x3f80f149, 1.0
  s_cmp_gt_u32 s36, 4
  s_cselect_b32 s52, 0x3f80f149, 1.0
  s_cmp_gt_u32 s36, 5
  s_cselect_b32 s53, 0x3f80f149, 1.0
  s_cmp_gt_u32 s36, 6
  s_cselect_b32 s54, 0x3f80f149, 1.0
  s_cmp_gt_u32 s36, 7
  s_cselect_b32 s55, 0x3f80f149, 1.0
  ds_read_b128 v[64:67], v108 offset:384
  ds_read_b128 v[68:71], v108 offset:400
  ds_read_b128 v[72:75], v108 offset:448
  ds_read_b128 v[76:79], v108 offset:464
  s_mul_i32 s44, s3, 5120
  s_add_u32 m0, s44, 139264
  s_nop 0
  buffer_load_dwordx4 v24, s[8:11], s33 offen offset:0 sc1 lds
  s_waitcnt lgkmcnt(0)
  v_fma_f32 v208, v208, v107, v64
  v_fma_f32 v209, v209, v107, v65
  v_fma_f32 v210, v210, v107, v66
  v_fma_f32 v211, v211, v107, v67
  v_mul_f32 v96, v208, v208
  buffer_load_dwordx4 v25, s[8:11], s33 offen offset:1024 sc1 lds
  v_mul_f32 v97, v209, v209
  v_mul_f32 v98, v210, v210
  v_mul_f32 v99, v211, v211
  v_fma_f32 v96, v96, v109, v110
  v_fma_f32 v97, v97, v109, v110
  v_fma_f32 v98, v98, v109, v110
  v_fma_f32 v99, v99, v109, v110
  buffer_load_dwordx4 v26, s[8:11], s33 offen offset:2048 sc1 lds
  v_mul_f32 v96, v96, v208
  v_mul_f32 v97, v97, v209
  v_mul_f32 v98, v98, v210
  v_mul_f32 v99, v99, v211
  v_exp_f32 v96, v96
  v_exp_f32 v97, v97
  v_exp_f32 v98, v98
  buffer_load_dwordx4 v27, s[8:11], s33 offen offset:3072 sc1 lds
  v_exp_f32 v99, v99
  v_add_f32 v96, 1.0, v96
  v_add_f32 v97, 1.0, v97
  v_add_f32 v98, 1.0, v98
  v_add_f32 v99, 1.0, v99
  v_rcp_f32 v96, v96
  v_rcp_f32 v97, v97
  s_add_u32 m0, s44, 143360
  s_nop 0
  buffer_load_dwordx4 v28, s[8:11], s33 offen offset:0 sc1 lds
  v_rcp_f32 v98, v98
  v_rcp_f32 v99, v99
  s_add_u32 s90, s88, 24576
  buffer_load_dwordx4 a[0:3], v35, s[8:11], s90 offen offset:0 sc1
  v_mul_f32 v96, v96, v208
  v_mul_f32 v97, v97, v209
  v_mul_f32 v98, v98, v210
  v_mul_f32 v99, v99, v211
  v_cvt_pk_bf16_f32 v88, v96, v97
  v_cvt_pk_bf16_f32 v89, v98, v99
  v_fma_f32 v212, v212, v107, v68
  v_fma_f32 v213, v213, v107, v69
  v_fma_f32 v214, v214, v107, v70
  v_fma_f32 v215, v215, v107, v71
  v_mul_f32 v96, v212, v212
  v_mul_f32 v97, v213, v213
  v_mul_f32 v98, v214, v214
  v_mul_f32 v99, v215, v215
  buffer_load_dwordx4 a[4:7], v35, s[8:11], s90 offen offset:1024 sc1
  v_fma_f32 v96, v96, v109, v110
  v_fma_f32 v97, v97, v109, v110
  v_fma_f32 v98, v98, v109, v110
  v_fma_f32 v99, v99, v109, v110
  v_mul_f32 v96, v96, v212
  v_mul_f32 v97, v97, v213
  v_mul_f32 v98, v98, v214
  v_mul_f32 v99, v99, v215
  v_exp_f32 v96, v96
  v_exp_f32 v97, v97
  v_exp_f32 v98, v98
  v_exp_f32 v99, v99
  v_add_f32 v96, 1.0, v96
  v_add_f32 v97, 1.0, v97
  buffer_load_dwordx4 a[8:11], v35, s[8:11], s90 offen offset:2048 sc1
  v_add_f32 v98, 1.0, v98
  v_add_f32 v99, 1.0, v99
  v_rcp_f32 v96, v96
  v_rcp_f32 v97, v97
  v_rcp_f32 v98, v98
  v_rcp_f32 v99, v99
  v_mul_f32 v96, v96, v212
  v_mul_f32 v97, v97, v213
  v_mul_f32 v98, v98, v214
  v_mul_f32 v99, v99, v215
  v_cvt_pk_bf16_f32 v90, v96, v97
  v_cvt_pk_bf16_f32 v91, v98, v99
  v_fma_f32 v216, v216, v107, v72
  v_fma_f32 v217, v217, v107, v73
  buffer_load_dwordx4 a[12:15], v35, s[8:11], s90 offen offset:3072 sc1
  v_fma_f32 v218, v218, v107, v74
  v_fma_f32 v219, v219, v107, v75
  v_mul_f32 v96, v216, v216
  v_mul_f32 v97, v217, v217
  v_mul_f32 v98, v218, v218
  v_mul_f32 v99, v219, v219
  v_fma_f32 v96, v96, v109, v110
  v_fma_f32 v97, v97, v109, v110
  v_fma_f32 v98, v98, v109, v110
  v_fma_f32 v99, v99, v109, v110
  v_mul_f32 v96, v96, v216
  v_mul_f32 v97, v97, v217
  v_mul_f32 v98, v98, v218
  v_mul_f32 v99, v99, v219
  s_add_u32 s90, s88, 28672
  buffer_load_dwordx4 a[16:19], v35, s[8:11], s90 offen offset:0 sc1
  v_exp_f32 v96, v96
  v_exp_f32 v97, v97
  v_exp_f32 v98, v98
  v_exp_f32 v99, v99
  v_add_f32 v96, 1.0, v96
  v_add_f32 v97, 1.0, v97
  v_add_f32 v98, 1.0, v98
  v_add_f32 v99, 1.0, v99
  v_rcp_f32 v96, v96
  v_rcp_f32 v97, v97
  v_rcp_f32 v98, v98
  v_rcp_f32 v99, v99
  v_mul_f32 v96, v96, v216
  v_mul_f32 v97, v97, v217
  buffer_load_dwordx4 a[20:23], v35, s[8:11], s90 offen offset:1024 sc1
  v_mul_f32 v98, v98, v218
  v_mul_f32 v99, v99, v219
  v_cvt_pk_bf16_f32 v92, v96, v97
  v_cvt_pk_bf16_f32 v93, v98, v99
  v_fma_f32 v220, v220, v107, v76
  v_fma_f32 v221, v221, v107, v77
  v_fma_f32 v222, v222, v107, v78
  v_fma_f32 v223, v223, v107, v79
  v_mul_f32 v96, v220, v220
  v_mul_f32 v97, v221, v221
  v_mul_f32 v98, v222, v222
  v_mul_f32 v99, v223, v223
  v_fma_f32 v96, v96, v109, v110
  v_fma_f32 v97, v97, v109, v110
  buffer_load_dwordx4 a[24:27], v35, s[8:11], s90 offen offset:2048 sc1
  v_fma_f32 v98, v98, v109, v110
  v_fma_f32 v99, v99, v109, v110
  v_mul_f32 v96, v96, v220
  v_mul_f32 v97, v97, v221
  v_mul_f32 v98, v98, v222
  v_mul_f32 v99, v99, v223
  v_exp_f32 v96, v96
  v_exp_f32 v97, v97
  v_exp_f32 v98, v98
  v_exp_f32 v99, v99
  v_add_f32 v96, 1.0, v96
  v_add_f32 v97, 1.0, v97
  v_add_f32 v98, 1.0, v98
  v_add_f32 v99, 1.0, v99
  buffer_load_dwordx4 a[28:31], v35, s[8:11], s90 offen offset:3072 sc1
  v_rcp_f32 v96, v96
  v_rcp_f32 v97, v97
  v_rcp_f32 v98, v98
  v_rcp_f32 v99, v99
  v_mul_f32 v96, v96, v220
  v_mul_f32 v97, v97, v221
  v_mul_f32 v98, v98, v222
  v_mul_f32 v99, v99, v223
  v_cvt_pk_bf16_f32 v94, v96, v97
  v_cvt_pk_bf16_f32 v95, v98, v99
  buffer_store_dwordx4 v[88:91], v35, s[8:11], s60 offen offset:2048 sc1
  buffer_store_dwordx4 v[92:95], v35, s[8:11], s60 offen offset:3072 sc1
  s_waitcnt vmcnt(10)
  s_barrier
  ds_read_b128 v[128:131], v31 offset:4096
  ds_read_b64 v[132:133], v32 offset:4096
  v_mov_b32 v134, s86
  ds_read_b128 v[136:139], v31 offset:6144
  ds_read_b64 v[140:141], v32 offset:6144
  v_mov_b32 v142, s87
  s_mov_b64 exec, s[58:59]
  ds_read_b128 v[40:43], v33 offset:2560
  ds_read_b128 v[44:47], v33 offset:3200
  s_mov_b64 exec, -1
  s_mov_b64 exec, s[58:59]
  ds_read_b128 v[48:51], v33 offset:3840
  ds_read_b128 v[52:55], v33 offset:4480
  s_mov_b64 exec, -1
  s_waitcnt lgkmcnt(6)
  v_mfma_f32_32x32x16_bf16 v[64:79], v[128:131], v[8:11], 0
  v_mfma_f32_32x32x16_bf16 v[64:79], v[132:135], v[12:15], v[64:79]
  s_mov_b64 exec, s[58:59]
  ds_read_b128 v[56:59], v33 offset:5120
  ds_read_b128 v[60:63], v33 offset:5760
  s_mov_b64 exec, -1
  v_mfma_f32_32x32x16_bf16 v[80:95], v[128:131], v[16:19], 0
  s_add_u32 s90, s88, 32768
  buffer_load_dwordx4 a[32:35], v35, s[8:11], s90 offen offset:0 sc1
  s_nop 4
  v_exp_f32 v64, v64
  v_exp_f32 v65, v65
  v_exp_f32 v66, v66
  v_exp_f32 v67, v67
  v_cvt_pk_bf16_f32 v144, v64, v65
  v_exp_f32 v68, v68
  v_exp_f32 v69, v69
  v_cvt_pk_bf16_f32 v145, v66, v67
  v_exp_f32 v70, v70
  v_exp_f32 v71, v71
  v_cvt_pk_bf16_f32 v146, v68, v69
  v_exp_f32 v72, v72
  v_mfma_f32_32x32x16_bf16 v[80:95], v[132:135], v[20:23], v[80:95]
  buffer_load_dwordx4 a[36:39], v35, s[8:11], s90 offen offset:1024 sc1
  ds_read_b128 v[128:131], v31 offset:8192
  ds_read_b64 v[132:133], v32 offset:8192
  v_mov_b32 v134, s52
  v_exp_f32 v73, v73
  v_cvt_pk_bf16_f32 v147, v70, v71
  v_exp_f32 v74, v74
  v_exp_f32 v75, v75
  v_cvt_pk_bf16_f32 v148, v72, v73
  v_exp_f32 v76, v76
  v_exp_f32 v77, v77
  v_cvt_pk_bf16_f32 v149, v74, v75
  v_exp_f32 v78, v78
  v_exp_f32 v79, v79
  v_cvt_pk_bf16_f32 v150, v76, v77
  v_cvt_pk_bf16_f32 v151, v78, v79
  buffer_load_dwordx4 a[40:43], v35, s[8:11], s90 offen offset:2048 sc1
  v_and_b32 v2, 31, v0
  v_lshrrev_b32 v3, 5, v0
  v_lshlrev_b32 v3, 2, v3
  v_sub_u32 v4, v2, v3
  v_cmp_le_i32 s[12:13], 0, v4
  v_cmp_le_i32 s[14:15], 1, v4
  s_waitcnt lgkmcnt(6)
  v_mfma_f32_32x32x16_bf16 v[160:175], v[40:43], v[144:147], 0
  buffer_load_dwordx4 a[44:47], v35, s[8:11], s90 offen offset:3072 sc1
  v_exp_f32 v80, v80
  v_exp_f32 v81, v81
  v_exp_f32 v82, v82
  v_exp_f32 v83, v83
  v_cvt_pk_bf16_f32 v152, v80, v81
  v_exp_f32 v84, v84
  v_mfma_f32_32x32x16_bf16 v[160:175], v[44:47], v[148:151], v[160:175]
  s_add_u32 s90, s88, 36864
  buffer_load_dwordx4 a[48:51], v35, s[8:11], s90 offen offset:0 sc1
  v_exp_f32 v85, v85
  v_cvt_pk_bf16_f32 v153, v82, v83
  v_exp_f32 v86, v86
  v_exp_f32 v87, v87
  v_cvt_pk_bf16_f32 v154, v84, v85
  v_exp_f32 v88, v88
  v_mfma_f32_32x32x16_bf16 v[96:111], v[136:139], v[8:11], 0
  buffer_load_dwordx4 a[52:55], v35, s[8:11], s90 offen offset:1024 sc1
  v_exp_f32 v89, v89
  v_cvt_pk_bf16_f32 v155, v86, v87
  v_exp_f32 v90, v90
  v_exp_f32 v91, v91
  v_cvt_pk_bf16_f32 v156, v88, v89
  v_exp_f32 v92, v92
  v_mfma_f32_32x32x16_bf16 v[96:111], v[140:143], v[12:15], v[96:111]
  buffer_load_dwordx4 a[56:59], v35, s[8:11], s90 offen offset:2048 sc1
  v_exp_f32 v93, v93
  v_cvt_pk_bf16_f32 v157, v90, v91
  v_exp_f32 v94, v94
  v_exp_f32 v95, v95
  v_cvt_pk_bf16_f32 v158, v92, v93
  v_cvt_pk_bf16_f32 v159, v94, v95
  v_cmp_le_i32 s[16:17], 2, v4
  v_cmp_le_i32 s[18:19], 3, v4
  v_cmp_le_i32 s[60:61], 8, v4
  v_cmp_le_i32 s[62:63], 9, v4
  v_cmp_le_i32 s[64:65], 10, v4
  v_cmp_le_i32 s[66:67], 11, v4
  v_mfma_f32_32x32x16_bf16 v[176:191], v[40:43], v[152:155], 0
  buffer_load_dwordx4 a[60:63], v35, s[8:11], s90 offen offset:3072 sc1
  v_exp_f32 v96, v96
  v_exp_f32 v97, v97
  v_exp_f32 v98, v98
  v_exp_f32 v99, v99
  v_cvt_pk_bf16_f32 v144, v96, v97
  v_exp_f32 v100, v100
  v_mfma_f32_32x32x16_bf16 v[176:191], v[44:47], v[156:159], v[176:191]
  s_add_u32 s90, s88, 40960
  buffer_load_dwordx4 a[64:67], v35, s[8:11], s90 offen offset:0 sc1
  v_exp_f32 v101, v101
  v_cvt_pk_bf16_f32 v145, v98, v99
  v_exp_f32 v102, v102
  v_exp_f32 v103, v103
  v_cvt_pk_bf16_f32 v146, v100, v101
  v_exp_f32 v104, v104
  v_mfma_f32_32x32x16_bf16 v[64:79], v[136:139], v[16:19], 0
  buffer_load_dwordx4 a[68:71], v35, s[8:11], s90 offen offset:1024 sc1
  v_exp_f32 v105, v105
  v_cvt_pk_bf16_f32 v147, v102, v103
  v_exp_f32 v106, v106
  v_exp_f32 v107, v107
  v_cvt_pk_bf16_f32 v148, v104, v105
  v_exp_f32 v108, v108
  v_mfma_f32_32x32x16_bf16 v[64:79], v[140:143], v[20:23], v[64:79]
  buffer_load_dwordx4 a[72:75], v35, s[8:11], s90 offen offset:2048 sc1
  s_mov_b64 exec, s[58:59]
  ds_read_b128 v[40:43], v33 offset:6400
  ds_read_b128 v[44:47], v33 offset:7040
  s_mov_b64 exec, -1
  ds_read_b128 v[136:139], v31 offset:10240
  ds_read_b64 v[140:141], v32 offset:10240
  v_mov_b32 v142, s53
  v_exp_f32 v109, v109
  v_cvt_pk_bf16_f32 v149, v106, v107
  v_exp_f32 v110, v110
  v_exp_f32 v111, v111
  v_cvt_pk_bf16_f32 v150, v108, v109
  v_cvt_pk_bf16_f32 v151, v110, v111
  v_cmp_le_i32 s[68:69], 16, v4
  v_cmp_le_i32 s[70:71], 17, v4
  v_cmp_le_i32 s[74:75], 18, v4
  v_cmp_le_i32 s[76:77], 19, v4
  v_cmp_le_i32 s[78:79], 24, v4
  v_cmp_le_i32 s[80:81], 25, v4
  s_waitcnt lgkmcnt(8)
  v_mfma_f32_32x32x16_bf16 v[160:175], v[48:51], v[144:147], v[160:175]
  buffer_load_dwordx4 a[76:79], v35, s[8:11], s90 offen offset:3072 sc1
  v_exp_f32 v64, v64
  v_exp_f32 v65, v65
  v_exp_f32 v66, v66
  v_exp_f32 v67, v67
  v_cvt_pk_bf16_f32 v152, v64, v65
  v_exp_f32 v68, v68
  v_mfma_f32_32x32x16_bf16 v[160:175], v[52:55], v[148:151], v[160:175]
  s_add_u32 s90, s88, 45056
  buffer_load_dwordx4 a[80:83], v35, s[8:11], s90 offen offset:0 sc1
  v_exp_f32 v69, v69
  v_cvt_pk_bf16_f32 v153, v66, v67
  v_exp_f32 v70, v70
  v_exp_f32 v71, v71
  v_cvt_pk_bf16_f32 v154, v68, v69
  v_exp_f32 v72, v72
  s_waitcnt lgkmcnt(4)
  v_mfma_f32_32x32x16_bf16 v[80:95], v[128:131], v[8:11], 0
  buffer_load_dwordx4 a[84:87], v35, s[8:11], s90 offen offset:1024 sc1
  v_exp_f32 v73, v73
  v_cvt_pk_bf16_f32 v155, v70, v71
  v_exp_f32 v74, v74
  v_exp_f32 v75, v75
  v_cvt_pk_bf16_f32 v156, v72, v73
  v_exp_f32 v76, v76
  v_mfma_f32_32x32x16_bf16 v[80:95], v[132:135], v[12:15], v[80:95]
  v_cmp_le_i32 s[28:29], 26, v4
  v_cmp_le_i32 s[30:31], 27, v4
  v_mov_b32 v5, 0xffff
  v_mov_b32 v1, 0xffff0000
  v_cndmask_b32 v2, 0, v5, s[12:13]
  v_cndmask_b32 v3, 0, v1, s[14:15]
  v_exp_f32 v77, v77
  v_cvt_pk_bf16_f32 v157, v74, v75
  v_exp_f32 v78, v78
  v_exp_f32 v79, v79
  v_cvt_pk_bf16_f32 v158, v76, v77
  v_cvt_pk_bf16_f32 v159, v78, v79
  s_waitcnt vmcnt(14)
  s_barrier
  s_lshl_b32 s56, s38, 3
  s_add_u32 s56, s56, 23429120
  buffer_store_dwordx2 v[38:39], v36, s[8:11], s56 offen sc1
  v_mfma_f32_32x32x16_bf16 v[176:191], v[48:51], v[152:155], v[176:191]
  buffer_load_dwordx4 a[88:91], v35, s[8:11], s90 offen offset:2048 sc1
  v_exp_f32 v80, v80
  v_exp_f32 v81, v81
  v_exp_f32 v82, v82
  v_exp_f32 v83, v83
  v_cvt_pk_bf16_f32 v144, v80, v81
  v_exp_f32 v84, v84
  v_mfma_f32_32x32x16_bf16 v[176:191], v[52:55], v[156:159], v[176:191]
  buffer_load_dwordx4 a[92:95], v35, s[8:11], s90 offen offset:3072 sc1
  v_exp_f32 v85, v85
  v_cvt_pk_bf16_f32 v145, v82, v83
  v_exp_f32 v86, v86
  v_exp_f32 v87, v87
  v_cvt_pk_bf16_f32 v146, v84, v85
  v_exp_f32 v88, v88
  v_mfma_f32_32x32x16_bf16 v[96:111], v[128:131], v[16:19], 0
  s_add_u32 s90, s88, 49152
  buffer_load_dwordx4 a[96:99], v35, s[8:11], s90 offen offset:0 sc1
  v_exp_f32 v89, v89
  v_cvt_pk_bf16_f32 v147, v86, v87
  v_exp_f32 v90, v90
  v_exp_f32 v91, v91
  v_cvt_pk_bf16_f32 v148, v88, v89
  v_exp_f32 v92, v92
  v_mfma_f32_32x32x16_bf16 v[96:111], v[132:135], v[20:23], v[96:111]
  v_or_b32 v192, v2, v3
  v_cndmask_b32 v2, 0, v5, s[16:17]
  v_cndmask_b32 v3, 0, v1, s[18:19]
  v_or_b32 v193, v2, v3
  v_cndmask_b32 v2, 0, v5, s[60:61]
  v_cndmask_b32 v3, 0, v1, s[62:63]
  s_mov_b64 exec, s[58:59]
  ds_read_b128 v[48:51], v33 offset:7680
  ds_read_b128 v[52:55], v33 offset:8320
  s_mov_b64 exec, -1
  ds_read_b128 v[128:131], v31 offset:12288
  ds_read_b64 v[132:133], v32 offset:12288
  v_mov_b32 v134, s54
  v_exp_f32 v93, v93
  v_cvt_pk_bf16_f32 v149, v90, v91
  v_exp_f32 v94, v94
  v_exp_f32 v95, v95
  v_cvt_pk_bf16_f32 v150, v92, v93
  v_cvt_pk_bf16_f32 v151, v94, v95
  v_mfma_f32_32x32x16_bf16 v[160:175], v[56:59], v[144:147], v[160:175]
  buffer_load_dwordx4 a[100:103], v35, s[8:11], s90 offen offset:1024 sc1
  v_exp_f32 v96, v96
  v_exp_f32 v97, v97
  v_exp_f32 v98, v98
  v_exp_f32 v99, v99
  v_cvt_pk_bf16_f32 v152, v96, v97
  v_exp_f32 v100, v100
  v_mfma_f32_32x32x16_bf16 v[160:175], v[60:63], v[148:151], v[160:175]
  buffer_load_dwordx4 a[104:107], v35, s[8:11], s90 offen offset:2048 sc1
  v_exp_f32 v101, v101
  v_cvt_pk_bf16_f32 v153, v98, v99
  v_exp_f32 v102, v102
  v_exp_f32 v103, v103
  v_cvt_pk_bf16_f32 v154, v100, v101
  v_exp_f32 v104, v104
  s_waitcnt lgkmcnt(4)
  v_mfma_f32_32x32x16_bf16 v[64:79], v[136:139], v[8:11], 0
  buffer_load_dwordx4 a[108:111], v35, s[8:11], s90 offen offset:3072 sc1
  v_exp_f32 v105, v105
  v_cvt_pk_bf16_f32 v155, v102, v103
  v_exp_f32 v106, v106
  v_exp_f32 v107, v107
  v_cvt_pk_bf16_f32 v156, v104, v105
  v_exp_f32 v108, v108
  v_mfma_f32_32x32x16_bf16 v[64:79], v[140:143], v[12:15], v[64:79]
  s_add_u32 s90, s88, 53248
  buffer_load_dwordx4 a[112:115], v35, s[8:11], s90 offen offset:0 sc1
  v_exp_f32 v109, v109
  v_cvt_pk_bf16_f32 v157, v106, v107
  v_exp_f32 v110, v110
  v_exp_f32 v111, v111
  v_cvt_pk_bf16_f32 v158, v108, v109
  v_cvt_pk_bf16_f32 v159, v110, v111
  v_or_b32 v194, v2, v3
  v_cndmask_b32 v2, 0, v5, s[64:65]
  v_cndmask_b32 v3, 0, v1, s[66:67]
  v_or_b32 v195, v2, v3
  v_cndmask_b32 v2, 0, v5, s[68:69]
  v_cndmask_b32 v3, 0, v1, s[70:71]
  v_mfma_f32_32x32x16_bf16 v[176:191], v[56:59], v[152:155], v[176:191]
  buffer_load_dwordx4 a[116:119], v35, s[8:11], s90 offen offset:1024 sc1
  v_exp_f32 v64, v64
  v_exp_f32 v65, v65
  v_exp_f32 v66, v66
  v_exp_f32 v67, v67
  v_cvt_pk_bf16_f32 v144, v64, v65
  v_exp_f32 v68, v68
  v_mfma_f32_32x32x16_bf16 v[176:191], v[60:63], v[156:159], v[176:191]
  buffer_load_dwordx4 a[120:123], v35, s[8:11], s90 offen offset:2048 sc1
  v_exp_f32 v69, v69
  v_cvt_pk_bf16_f32 v145, v66, v67
  v_exp_f32 v70, v70
  v_exp_f32 v71, v71
  v_cvt_pk_bf16_f32 v146, v68, v69
  v_exp_f32 v72, v72
  v_mfma_f32_32x32x16_bf16 v[80:95], v[136:139], v[16:19], 0
  buffer_load_dwordx4 a[124:127], v35, s[8:11], s90 offen offset:3072 sc1
  v_exp_f32 v73, v73
  v_cvt_pk_bf16_f32 v147, v70, v71
  v_exp_f32 v74, v74
  v_exp_f32 v75, v75
  v_cvt_pk_bf16_f32 v148, v72, v73
  v_exp_f32 v76, v76
  v_mfma_f32_32x32x16_bf16 v[80:95], v[140:143], v[20:23], v[80:95]
  s_add_u32 s90, s88, 57344
  buffer_load_dwordx4 a[128:131], v35, s[8:11], s90 offen offset:0 sc1
  s_mov_b64 exec, s[58:59]
  ds_read_b128 v[56:59], v33 offset:8960
  ds_read_b128 v[60:63], v33 offset:9600
  s_mov_b64 exec, -1
  ds_read_b128 v[136:139], v31 offset:14336
  ds_read_b64 v[140:141], v32 offset:14336
  v_mov_b32 v142, s55
  v_exp_f32 v77, v77
  v_cvt_pk_bf16_f32 v149, v74, v75
  v_exp_f32 v78, v78
  v_exp_f32 v79, v79
  v_cvt_pk_bf16_f32 v150, v76, v77
  v_cvt_pk_bf16_f32 v151, v78, v79
  v_or_b32 v196, v2, v3
  v_cndmask_b32 v2, 0, v5, s[74:75]
  v_cndmask_b32 v3, 0, v1, s[76:77]
  v_or_b32 v197, v2, v3
  v_cndmask_b32 v2, 0, v5, s[78:79]
  v_cndmask_b32 v3, 0, v1, s[80:81]
  v_mfma_f32_32x32x16_bf16 v[160:175], v[40:43], v[144:147], v[160:175]
  buffer_load_dwordx4 a[132:135], v35, s[8:11], s90 offen offset:1024 sc1
  v_exp_f32 v80, v80
  v_exp_f32 v81, v81
  v_exp_f32 v82, v82
  v_exp_f32 v83, v83
  v_cvt_pk_bf16_f32 v152, v80, v81
  v_exp_f32 v84, v84
  v_mfma_f32_32x32x16_bf16 v[160:175], v[44:47], v[148:151], v[160:175]
  buffer_load_dwordx4 a[136:139], v35, s[8:11], s90 offen offset:2048 sc1
  v_exp_f32 v85, v85
  v_cvt_pk_bf16_f32 v153, v82, v83
  v_exp_f32 v86, v86
  v_exp_f32 v87, v87
  v_cvt_pk_bf16_f32 v154, v84, v85
  v_exp_f32 v88, v88
  s_waitcnt lgkmcnt(4)
  v_mfma_f32_32x32x16_bf16 v[96:111], v[128:131], v[8:11], 0
  buffer_load_dwordx4 a[140:143], v35, s[8:11], s90 offen offset:3072 sc1
  v_exp_f32 v89, v89
  v_cvt_pk_bf16_f32 v155, v86, v87
  v_exp_f32 v90, v90
  v_exp_f32 v91, v91
  v_cvt_pk_bf16_f32 v156, v88, v89
  v_exp_f32 v92, v92
  v_mfma_f32_32x32x16_bf16 v[96:111], v[132:135], v[12:15], v[96:111]
  s_add_u32 s90, s88, 61440
  buffer_load_dwordx4 a[144:147], v35, s[8:11], s90 offen offset:0 sc1
  v_exp_f32 v93, v93
  v_cvt_pk_bf16_f32 v157, v90, v91
  v_exp_f32 v94, v94
  v_exp_f32 v95, v95
  v_cvt_pk_bf16_f32 v158, v92, v93
  v_cvt_pk_bf16_f32 v159, v94, v95
  v_or_b32 v198, v2, v3
  v_cndmask_b32 v2, 0, v5, s[28:29]
  v_cndmask_b32 v3, 0, v1, s[30:31]
  v_or_b32 v199, v2, v3
  v_mfma_f32_32x32x16_bf16 v[176:191], v[40:43], v[152:155], v[176:191]
  buffer_load_dwordx4 a[148:151], v35, s[8:11], s90 offen offset:1024 sc1
  v_exp_f32 v96, v96
  v_exp_f32 v97, v97
  v_exp_f32 v98, v98
  v_exp_f32 v99, v99
  v_cvt_pk_bf16_f32 v144, v96, v97
  v_exp_f32 v100, v100
  v_mfma_f32_32x32x16_bf16 v[176:191], v[44:47], v[156:159], v[176:191]
  buffer_load_dwordx4 a[152:155], v35, s[8:11], s90 offen offset:2048 sc1
  v_exp_f32 v101, v101
  v_cvt_pk_bf16_f32 v145, v98, v99
  v_exp_f32 v102, v102
  v_exp_f32 v103, v103
  v_cvt_pk_bf16_f32 v146, v100, v101
  v_exp_f32 v104, v104
  v_mfma_f32_32x32x16_bf16 v[64:79], v[128:131], v[16:19], 0
  v_add_u32 v1, 0, v0
  v_mul_u32_u24 v2, 6554, v1
  v_lshrrev_b32 v2, 16, v2
  v_mul_u32_u24 v3, 1120, v2
  v_lshl_add_u32 v1, v1, 4, v3
  s_lshl_b32 s46, s96, 6
  s_lshl_b32 s47, s3, 4
  s_add_u32 s46, s46, s47
  s_mul_i32 s46, s46, 1280
  s_add_u32 s46, s46, s43
  s_mul_i32 s47, s3, 2560
  s_cmp_lt_u32 s3, 3
  s_cselect_b32 s47, s47, 28672
  s_add_u32 s47, s47, 131072
  s_add_u32 m0, s47, 0
  s_nop 0
  buffer_load_dwordx4 v1, s[4:7], s46 offen lds
  v_exp_f32 v105, v105
  v_cvt_pk_bf16_f32 v147, v102, v103
  v_exp_f32 v106, v106
  v_exp_f32 v107, v107
  v_cvt_pk_bf16_f32 v148, v104, v105
  v_exp_f32 v108, v108
  v_mfma_f32_32x32x16_bf16 v[64:79], v[132:135], v[20:23], v[64:79]
  s_mov_b64 exec, s[58:59]
  ds_read_b128 v[40:43], v33 offset:0
  ds_read_b128 v[44:47], v33 offset:640
  s_mov_b64 exec, -1
  ds_read_b128 v[128:131], v31 offset:0
  ds_read_b64 v[132:133], v32 offset:0
  v_mov_b32 v134, s84
  v_exp_f32 v109, v109
  v_cvt_pk_bf16_f32 v149, v106, v107
  v_exp_f32 v110, v110
  v_exp_f32 v111, v111
  v_cvt_pk_bf16_f32 v150, v108, v109
  v_cvt_pk_bf16_f32 v151, v110, v111
  v_mfma_f32_32x32x16_bf16 v[160:175], v[48:51], v[144:147], v[160:175]
  buffer_load_dwordx4 a[156:159], v35, s[8:11], s90 offen offset:3072 sc1
  v_exp_f32 v64, v64
  v_exp_f32 v65, v65
  v_exp_f32 v66, v66
  v_exp_f32 v67, v67
  v_cvt_pk_bf16_f32 v152, v64, v65
  v_exp_f32 v68, v68
  v_mfma_f32_32x32x16_bf16 v[160:175], v[52:55], v[148:151], v[160:175]
  s_add_u32 s90, s88, 65536
  s_lshl_b32 s97, s3, 14
  s_lshl_b32 s94, s3, 13
  s_add_u32 m0, s97, 4096
  s_nop 0
  buffer_load_dwordx4 v35, s[8:11], s90 offen offset:0 sc1 lds
  v_exp_f32 v69, v69
  v_cvt_pk_bf16_f32 v153, v66, v67
  v_exp_f32 v70, v70
  v_exp_f32 v71, v71
  v_cvt_pk_bf16_f32 v154, v68, v69
  v_exp_f32 v72, v72
  s_waitcnt lgkmcnt(4)
  v_mfma_f32_32x32x16_bf16 v[80:95], v[136:139], v[8:11], 0
  s_add_u32 s90, s88, 65536
  s_cmp_lt_u32 s3, 2
  s_cselect_b32 s90, s90, 1073741824
  buffer_load_dwordx4 v35, s[8:11], s90 offen offset:1024 sc1 lds
  v_exp_f32 v73, v73
  v_cvt_pk_bf16_f32 v155, v70, v71
  v_exp_f32 v74, v74
  v_exp_f32 v75, v75
  v_cvt_pk_bf16_f32 v156, v72, v73
  v_exp_f32 v76, v76
  v_mfma_f32_32x32x16_bf16 v[80:95], v[140:143], v[12:15], v[80:95]
  v_add_u32 v1, 64, v0
  v_mul_u32_u24 v2, 6554, v1
  v_lshrrev_b32 v2, 16, v2
  v_mul_u32_u24 v3, 1120, v2
  v_lshl_add_u32 v1, v1, 4, v3
  s_add_u32 m0, s47, 1024
  s_nop 0
  buffer_load_dwordx4 v1, s[4:7], s46 offen lds
  v_exp_f32 v77, v77
  v_cvt_pk_bf16_f32 v157, v74, v75
  v_exp_f32 v78, v78
  v_exp_f32 v79, v79
  v_cvt_pk_bf16_f32 v158, v76, v77
  v_cvt_pk_bf16_f32 v159, v78, v79
  v_mfma_f32_32x32x16_bf16 v[176:191], v[48:51], v[152:155], v[176:191]
  s_add_u32 m0, s97, 4096
  s_nop 0
  buffer_load_dwordx4 v35, s[8:11], s90 offen offset:2048 sc1 lds
  v_exp_f32 v80, v80
  v_exp_f32 v81, v81
  v_exp_f32 v82, v82
  v_exp_f32 v83, v83
  v_cvt_pk_bf16_f32 v144, v80, v81
  v_exp_f32 v84, v84
  v_mfma_f32_32x32x16_bf16 v[176:191], v[52:55], v[156:159], v[176:191]
  buffer_load_dwordx4 v35, s[8:11], s90 offen offset:3072 sc1 lds
  v_exp_f32 v85, v85
  v_cvt_pk_bf16_f32 v145, v82, v83
  v_exp_f32 v86, v86
  v_exp_f32 v87, v87
  v_cvt_pk_bf16_f32 v146, v84, v85
  v_exp_f32 v88, v88
  v_mfma_f32_32x32x16_bf16 v[96:111], v[136:139], v[16:19], 0
  s_add_u32 s90, s88, 69632
  s_cmp_lt_u32 s3, 2
  s_cselect_b32 s90, s90, 1073741824
  s_add_u32 m0, s97, 8192
  s_nop 0
  buffer_load_dwordx4 v35, s[8:11], s90 offen offset:0 sc1 lds
  v_exp_f32 v89, v89
  v_cvt_pk_bf16_f32 v147, v86, v87
  v_exp_f32 v90, v90
  v_exp_f32 v91, v91
  v_cvt_pk_bf16_f32 v148, v88, v89
  v_exp_f32 v92, v92
  v_mfma_f32_32x32x16_bf16 v[96:111], v[140:143], v[20:23], v[96:111]
  v_add_u32 v1, 128, v0
  v_mul_u32_u24 v2, 6554, v1
  v_lshrrev_b32 v2, 16, v2
  v_mul_u32_u24 v3, 1120, v2
  v_lshl_add_u32 v1, v1, 4, v3
  s_add_u32 m0, s47, 2048
  s_mov_b32 exec_hi, 0
  buffer_load_dwordx4 v1, s[4:7], s46 offen lds
  s_mov_b32 exec_hi, -1
  v_and_b32 v1, 15, v0
  v_mul_u32_u24 v1, 160, v1
  v_add_u32 v1, v1, v123
  v_add_u32 v126, s47, v1
  s_mov_b64 exec, s[58:59]
  ds_read_b128 v[48:51], v33 offset:10240
  ds_read_b128 v[52:55], v33 offset:10880
  s_mov_b64 exec, -1
  ds_read_b128 v[136:139], v31 offset:16384
  ds_read_b64 v[140:141], v32 offset:16384
  v_mov_b32 v142, 1.0
  v_exp_f32 v93, v93
  v_cvt_pk_bf16_f32 v149, v90, v91
  v_exp_f32 v94, v94
  v_exp_f32 v95, v95
  v_cvt_pk_bf16_f32 v150, v92, v93
  v_cvt_pk_bf16_f32 v151, v94, v95
  v_mfma_f32_32x32x16_bf16 v[160:175], v[56:59], v[144:147], v[160:175]
  s_add_u32 m0, s97, 8192
  s_nop 0
  buffer_load_dwordx4 v35, s[8:11], s90 offen offset:1024 sc1 lds
  v_exp_f32 v96, v96
  v_exp_f32 v97, v97
  v_exp_f32 v98, v98
  v_exp_f32 v99, v99
  v_mfma_f32_32x32x16_bf16 v[160:175], v[60:63], v[148:151], v[160:175]
  s_add_u32 s90, s89, 0
  s_add_u32 m0, s97, 10240
  s_nop 0
  buffer_load_dwordx4 v35, s[8:11], s90 offen offset:0 sc1 lds
  v_cvt_pk_bf16_f32 v152, v96, v97
  v_exp_f32 v100, v100
  v_exp_f32 v101, v101
  v_cvt_pk_bf16_f32 v153, v98, v99
  s_waitcnt lgkmcnt(4)
  v_mfma_f32_32x32x16_bf16 v[64:79], v[128:131], v[8:11], 0
  buffer_load_dwordx4 v35, s[8:11], s90 offen offset:1024 sc1 lds
  v_exp_f32 v102, v102
  v_exp_f32 v103, v103
  v_cvt_pk_bf16_f32 v154, v100, v101
  v_exp_f32 v104, v104
  v_mfma_f32_32x32x16_bf16 v[64:79], v[132:135], v[12:15], v[64:79]
  s_mov_b32 s82, 23429120
  buffer_load_dwordx2 v[6:7], v120, s[8:11], s82 offen sc1
  v_exp_f32 v105, v105
  v_cvt_pk_bf16_f32 v155, v102, v103
  v_exp_f32 v106, v106
  v_exp_f32 v107, v107
  s_waitcnt lgkmcnt(0)
  v_mfma_f32_32x32x16_bf16 v[80:95], v[136:139], v[8:11], 0
  v_cvt_pk_bf16_f32 v156, v104, v105
  v_exp_f32 v108, v108
  v_exp_f32 v109, v109
  v_cvt_pk_bf16_f32 v157, v106, v107
  v_mfma_f32_32x32x16_bf16 v[80:95], v[140:143], v[12:15], v[80:95]
  ds_read_b128 v[128:131], v31 offset:2048
  ds_read_b64 v[132:133], v32 offset:2048
  v_mov_b32 v134, s85
  v_exp_f32 v110, v110
  v_exp_f32 v111, v111
  v_cvt_pk_bf16_f32 v158, v108, v109
  v_cvt_pk_bf16_f32 v159, v110, v111
  v_mfma_f32_32x32x16_bf16 v[176:191], v[56:59], v[152:155], v[176:191]
  buffer_load_dwordx4 v35, s[8:11], s90 offen offset:2048 sc1 lds
  s_nop 2
  v_cndmask_b32 v80, v64, v80, s[12:13]
  v_cndmask_b32 v81, v65, v81, s[14:15]
  v_cndmask_b32 v82, v66, v82, s[16:17]
  v_cndmask_b32 v83, v67, v83, s[18:19]
  v_cndmask_b32 v84, v68, v84, s[60:61]
  v_cndmask_b32 v85, v69, v85, s[62:63]
  v_cndmask_b32 v86, v70, v86, s[64:65]
  v_cndmask_b32 v87, v71, v87, s[66:67]
  v_cndmask_b32 v88, v72, v88, s[68:69]
  v_cndmask_b32 v89, v73, v89, s[70:71]
  v_cndmask_b32 v90, v74, v90, s[74:75]
  v_cndmask_b32 v91, v75, v91, s[76:77]
  v_cndmask_b32 v92, v76, v92, s[78:79]
  v_cndmask_b32 v93, v77, v93, s[80:81]
  v_cndmask_b32 v94, v78, v94, s[28:29]
  v_cndmask_b32 v95, v79, v95, s[30:31]
  v_exp_f32 v80, v80
  v_mfma_f32_32x32x16_bf16 v[176:191], v[60:63], v[156:159], v[176:191]
  buffer_load_dwordx4 v35, s[8:11], s90 offen offset:3072 sc1 lds
  v_exp_f32 v81, v81
  v_exp_f32 v82, v82
  v_exp_f32 v83, v83
  v_cvt_pk_bf16_f32 v144, v80, v81
  v_exp_f32 v84, v84
  v_exp_f32 v85, v85
  v_cvt_pk_bf16_f32 v145, v82, v83
  v_exp_f32 v86, v86
  v_exp_f32 v87, v87
  v_cvt_pk_bf16_f32 v146, v84, v85
  v_exp_f32 v88, v88
  v_mfma_f32_32x32x16_bf16 v[96:111], v[136:139], v[16:19], 0
  s_add_u32 s90, s89, 4096
  s_add_u32 m0, s97, 14336
  s_nop 0
  buffer_load_dwordx4 v35, s[8:11], s90 offen offset:0 sc1 lds
  v_exp_f32 v89, v89
  v_cvt_pk_bf16_f32 v147, v86, v87
  v_exp_f32 v90, v90
  v_exp_f32 v91, v91
  v_cvt_pk_bf16_f32 v148, v88, v89
  v_exp_f32 v92, v92
  v_exp_f32 v93, v93
  v_cvt_pk_bf16_f32 v149, v90, v91
  v_exp_f32 v94, v94
  v_exp_f32 v95, v95
  v_mfma_f32_32x32x16_bf16 v[96:111], v[140:143], v[20:23], v[96:111]
  buffer_load_dwordx4 v35, s[8:11], s90 offen offset:1024 sc1 lds
  s_mov_b64 exec, s[58:59]
  ds_read_b128 v[56:59], v33 offset:1280
  ds_read_b128 v[60:63], v33 offset:1920
  s_mov_b64 exec, -1
  ds_read_b128 v[136:139], v31 offset:18432
  ds_read_b64 v[140:141], v32 offset:18432
  v_mov_b32 v142, 1.0
  v_cvt_pk_bf16_f32 v150, v92, v93
  v_cvt_pk_bf16_f32 v151, v94, v95
  v_bfi_b32 v64, v192, 0, v144
  v_and_b32 v72, v192, v144
  v_bfi_b32 v65, v193, 0, v145
  v_and_b32 v73, v193, v145
  v_bfi_b32 v66, v194, 0, v146
  v_and_b32 v74, v194, v146
  v_bfi_b32 v67, v195, 0, v147
  v_and_b32 v75, v195, v147
  v_bfi_b32 v68, v196, 0, v148
  v_and_b32 v76, v196, v148
  v_bfi_b32 v69, v197, 0, v149
  v_and_b32 v77, v197, v149
  v_bfi_b32 v70, v198, 0, v150
  v_and_b32 v78, v198, v150
  v_bfi_b32 v71, v199, 0, v151
  v_and_b32 v79, v199, v151
  v_mfma_f32_32x32x16_bf16 v[160:175], v[40:43], v[64:67], v[160:175]
  s_waitcnt vmcnt(4)
  v_xor_b32 v6, v38, v6
  v_xor_b32 v7, v39, v7
  v_or_b32 v6, v6, v7
  v_cmp_ne_u32 vcc, 0, v6
  s_nop 4
  s_cbranch_vccz L_pok3
  s_mov_b32 s57, 0
L_pspin3:
  s_sleep 1
  buffer_load_dwordx2 v[6:7], v120, s[8:11], s82 offen sc1
  s_add_u32 s57, s57, 1
  s_waitcnt vmcnt(0)
  v_xor_b32 v6, v38, v6
  v_xor_b32 v7, v39, v7
  v_or_b32 v6, v6, v7
  v_cmp_ne_u32 vcc, 0, v6
  s_nop 4
  s_cmp_gt_u32 s57, 100000
  s_cbranch_scc1 L_pok3
  s_cbranch_vccnz L_pspin3
L_pok3:
  v_exp_f32 v96, v96
  v_exp_f32 v97, v97
  v_exp_f32 v98, v98
  v_exp_f32 v99, v99
  v_mfma_f32_32x32x16_bf16 v[160:175], v[44:47], v[68:71], v[160:175]
  s_add_u32 s95, s39, 0
  buffer_load_dwordx4 v[204:207], v112, s[8:11], s95 offen sc1
  v_cvt_pk_bf16_f32 v152, v96, v97
  v_exp_f32 v100, v100
  v_exp_f32 v101, v101
  v_cvt_pk_bf16_f32 v153, v98, v99
  v_mfma_f32_32x32x16_bf16 v[160:175], v[48:51], v[72:75], v[160:175]
  buffer_load_dwordx4 v[208:211], v113, s[8:11], s95 offen sc1
  v_exp_f32 v102, v102
  v_exp_f32 v103, v103
  v_cvt_pk_bf16_f32 v154, v100, v101
  v_exp_f32 v104, v104
  v_mfma_f32_32x32x16_bf16 v[160:175], v[52:55], v[76:79], v[160:175]
  buffer_load_dwordx4 v[212:215], v114, s[8:11], s95 offen sc1
  v_exp_f32 v105, v105
  v_cvt_pk_bf16_f32 v155, v102, v103
  v_exp_f32 v106, v106
  v_exp_f32 v107, v107
  s_waitcnt lgkmcnt(4)
  v_mfma_f32_32x32x16_bf16 v[64:79], v[128:131], v[8:11], 0
  buffer_load_dwordx4 v[216:219], v115, s[8:11], s95 offen sc1
  v_cvt_pk_bf16_f32 v156, v104, v105
  v_exp_f32 v108, v108
  v_exp_f32 v109, v109
  v_cvt_pk_bf16_f32 v157, v106, v107
  v_mfma_f32_32x32x16_bf16 v[64:79], v[132:135], v[12:15], v[64:79]
  s_mov_b64 exec, s[58:59]
  ds_read_b128 v[40:43], v33 offset:11520
  ds_read_b128 v[44:47], v33 offset:12160
  s_mov_b64 exec, -1
  v_exp_f32 v110, v110
  v_exp_f32 v111, v111
  v_cvt_pk_bf16_f32 v158, v108, v109
  v_cvt_pk_bf16_f32 v159, v110, v111
  v_mfma_f32_32x32x16_bf16 v[176:191], v[48:51], v[152:155], v[176:191]
  s_add_u32 s95, s39, 2048
  buffer_load_dwordx4 v[220:223], v112, s[8:11], s95 offen sc1
  s_nop 0
  v_exp_f32 v64, v64
  v_exp_f32 v65, v65
  v_exp_f32 v66, v66
  v_exp_f32 v67, v67
  v_mfma_f32_32x32x16_bf16 v[176:191], v[52:55], v[156:159], v[176:191]
  buffer_load_dwordx4 v[224:227], v113, s[8:11], s95 offen sc1
  v_cvt_pk_bf16_f32 v144, v64, v65
  v_exp_f32 v68, v68
  v_exp_f32 v69, v69
  v_cvt_pk_bf16_f32 v145, v66, v67
  v_mfma_f32_32x32x16_bf16 v[80:95], v[128:131], v[16:19], 0
  buffer_load_dwordx4 v[228:231], v114, s[8:11], s95 offen sc1
  v_exp_f32 v70, v70
  v_exp_f32 v71, v71
  v_cvt_pk_bf16_f32 v146, v68, v69
  v_exp_f32 v72, v72
  v_mfma_f32_32x32x16_bf16 v[80:95], v[132:135], v[20:23], v[80:95]
  buffer_load_dwordx4 v[232:235], v115, s[8:11], s95 offen sc1
  v_exp_f32 v73, v73
  v_cvt_pk_bf16_f32 v147, v70, v71
  v_exp_f32 v74, v74
  v_exp_f32 v75, v75
  s_waitcnt lgkmcnt(2)
  v_mfma_f32_32x32x16_bf16 v[96:111], v[136:139], v[16:19], 0
  v_cvt_pk_bf16_f32 v148, v72, v73
  v_exp_f32 v76, v76
  v_exp_f32 v77, v77
  v_cvt_pk_bf16_f32 v149, v74, v75
  v_mfma_f32_32x32x16_bf16 v[96:111], v[140:143], v[20:23], v[96:111]
  v_exp_f32 v78, v78
  v_exp_f32 v79, v79
  v_cvt_pk_bf16_f32 v150, v76, v77
  v_cvt_pk_bf16_f32 v151, v78, v79
  v_mfma_f32_32x32x16_bf16 v[160:175], v[56:59], v[144:147], v[160:175]
  s_add_u32 s95, s39, 4096
  buffer_load_dwordx4 v[236:239], v112, s[8:11], s95 offen sc1
  s_nop 4
  v_cndmask_b32 v96, v80, v96, s[12:13]
  v_cndmask_b32 v97, v81, v97, s[14:15]
  v_cndmask_b32 v98, v82, v98, s[16:17]
  v_cndmask_b32 v99, v83, v99, s[18:19]
  v_cndmask_b32 v100, v84, v100, s[60:61]
  v_cndmask_b32 v101, v85, v101, s[62:63]
  v_cndmask_b32 v102, v86, v102, s[64:65]
  v_cndmask_b32 v103, v87, v103, s[66:67]
  v_cndmask_b32 v104, v88, v104, s[68:69]
  v_cndmask_b32 v105, v89, v105, s[70:71]
  v_cndmask_b32 v106, v90, v106, s[74:75]
  v_cndmask_b32 v107, v91, v107, s[76:77]
  v_cndmask_b32 v108, v92, v108, s[78:79]
  v_cndmask_b32 v109, v93, v109, s[80:81]
  v_cndmask_b32 v110, v94, v110, s[28:29]
  v_cndmask_b32 v111, v95, v111, s[30:31]
  v_exp_f32 v96, v96
  v_exp_f32 v97, v97
  v_exp_f32 v98, v98
  v_exp_f32 v99, v99
  v_cvt_pk_bf16_f32 v152, v96, v97
  v_exp_f32 v100, v100
  v_exp_f32 v101, v101
  v_cvt_pk_bf16_f32 v153, v98, v99
  v_exp_f32 v102, v102
  v_exp_f32 v103, v103
  v_cvt_pk_bf16_f32 v154, v100, v101
  v_exp_f32 v104, v104
  v_mfma_f32_32x32x16_bf16 v[160:175], v[60:63], v[148:151], v[160:175]
  buffer_load_dwordx4 v[240:243], v113, s[8:11], s95 offen sc1
  v_exp_f32 v105, v105
  v_cvt_pk_bf16_f32 v155, v102, v103
  v_exp_f32 v106, v106
  v_exp_f32 v107, v107
  v_cvt_pk_bf16_f32 v156, v104, v105
  v_exp_f32 v108, v108
  v_exp_f32 v109, v109
  v_cvt_pk_bf16_f32 v157, v106, v107
  v_exp_f32 v110, v110
  v_exp_f32 v111, v111
  v_cvt_pk_bf16_f32 v158, v108, v109
  v_cvt_pk_bf16_f32 v159, v110, v111
  v_bfi_b32 v80, v192, 0, v152
  v_and_b32 v88, v192, v152
  v_bfi_b32 v81, v193, 0, v153
  v_and_b32 v89, v193, v153
  v_bfi_b32 v82, v194, 0, v154
  v_and_b32 v90, v194, v154
  v_bfi_b32 v83, v195, 0, v155
  v_and_b32 v91, v195, v155
  v_bfi_b32 v84, v196, 0, v156
  v_and_b32 v92, v196, v156
  v_bfi_b32 v85, v197, 0, v157
  v_and_b32 v93, v197, v157
  v_bfi_b32 v86, v198, 0, v158
  v_and_b32 v94, v198, v158
  v_bfi_b32 v87, v199, 0, v159
  v_and_b32 v95, v199, v159
  buffer_load_dwordx4 v[244:247], v114, s[8:11], s95 offen sc1
  buffer_load_dwordx4 v[248:251], v115, s[8:11], s95 offen sc1
  v_mfma_f32_32x32x16_bf16 v[176:191], v[56:59], v[80:83], v[176:191]
  v_mfma_f32_32x32x16_bf16 v[176:191], v[60:63], v[84:87], v[176:191]
  s_waitcnt lgkmcnt(0)
  v_mfma_f32_32x32x16_bf16 v[176:191], v[40:43], v[88:91], v[176:191]
  v_mfma_f32_32x32x16_bf16 v[176:191], v[44:47], v[92:95], v[176:191]
  v_mov_b32 v202, v168
  v_mov_b32 v200, v168
  s_nop 1
  v_permlane32_swap_b32 v202, v200
  s_nop 6
  v_mov_b32 v202, v184
  v_mov_b32 v201, v184
  s_nop 1
  v_permlane32_swap_b32 v202, v201
  v_min_f32 v203, v200, v201
  s_mov_b32 s44, 0x4e800000
  s_mov_b32 s45, 0x2b800000
  v_add_f32 v144, v200, v201
  v_cmp_nge_f32 s[48:49], s44, v144
  v_cmp_nle_f32 vcc, s45, v203
  s_nop 4
  s_or_b64 vcc, vcc, s[48:49]
  s_cbranch_vccnz L_fb
L_norm:
  s_add_u32 s45, s35, 40960
  v_rcp_f32 v200, v200
  v_rcp_f32 v201, v201
  v_mul_f32 v160, v160, v200
  v_mul_f32 v161, v161, v200
  v_mul_f32 v162, v162, v200
  v_mul_f32 v163, v163, v200
  v_mul_f32 v164, v164, v200
  v_mul_f32 v165, v165, v200
  v_mul_f32 v166, v166, v200
  v_mul_f32 v167, v167, v200
  v_mul_f32 v168, v168, v200
  v_mul_f32 v169, v169, v200
  v_mul_f32 v170, v170, v200
  v_mul_f32 v171, v171, v200
  v_cvt_pk_bf16_f32 v144, v160, v161
  v_cvt_pk_bf16_f32 v145, v162, v163
  v_cvt_pk_bf16_f32 v146, v164, v165
  v_cvt_pk_bf16_f32 v147, v166, v167
  v_cvt_pk_bf16_f32 v148, v168, v169
  v_cvt_pk_bf16_f32 v149, v170, v171
  buffer_store_dwordx4 v[144:147], v29, s[8:11], s35 offen sc1
  buffer_store_dwordx2 v[148:149], v30, s[8:11], s35 offen sc1
  v_mul_f32 v176, v176, v201
  v_mul_f32 v177, v177, v201
  v_mul_f32 v178, v178, v201
  v_mul_f32 v179, v179, v201
  v_mul_f32 v180, v180, v201
  v_mul_f32 v181, v181, v201
  v_mul_f32 v182, v182, v201
  v_mul_f32 v183, v183, v201
  v_mul_f32 v184, v184, v201
  v_mul_f32 v185, v185, v201
  v_mul_f32 v186, v186, v201
  v_mul_f32 v187, v187, v201
  v_cvt_pk_bf16_f32 v152, v176, v177
  v_cvt_pk_bf16_f32 v153, v178, v179
  v_cvt_pk_bf16_f32 v154, v180, v181
  v_cvt_pk_bf16_f32 v155, v182, v183
  v_cvt_pk_bf16_f32 v156, v184, v185
  v_cvt_pk_bf16_f32 v157, v186, v187
  buffer_store_dwordx4 v[152:155], v29, s[8:11], s45 offen sc1
  buffer_store_dwordx2 v[156:157], v30, s[8:11], s45 offen sc1
  s_lshl_b32 s44, s3, 14
  v_add_u32 v1, s44, v35
  s_lshl_b32 s44, s3, 13
  s_add_u32 s44, s44, 94208
  v_add_u32 v2, s44, v35
  v_add_u32 v3, 162304, v123
  s_waitcnt vmcnt(12)
  v_mfma_f32_16x16x32_bf16 v[64:67], a[160:163], v[204:207], 0
  v_mfma_f32_16x16x32_bf16 v[84:87], a[160:163], v[208:211], 0
  ds_read_b64 v[8:9], v126 offset:0
  ds_read_b64 v[18:19], v3 offset:0
  v_mfma_f32_16x16x32_bf16 v[104:107], a[160:163], v[212:215], 0
  v_mfma_f32_16x16x32_bf16 v[140:143], a[160:163], v[216:219], 0
  ds_read_b64 v[10:11], v126 offset:32
  ds_read_b64 v[20:21], v3 offset:32
  v_mfma_f32_16x16x32_bf16 v[68:71], a[164:167], v[204:207], 0
  v_mfma_f32_16x16x32_bf16 v[88:91], a[164:167], v[208:211], 0
  ds_read_b64 v[12:13], v126 offset:64
  ds_read_b64 v[22:23], v3 offset:64
  v_mfma_f32_16x16x32_bf16 v[108:111], a[164:167], v[212:215], 0
  v_mfma_f32_16x16x32_bf16 v[144:147], a[164:167], v[216:219], 0
  v_mfma_f32_16x16x32_bf16 v[72:75], a[168:171], v[204:207], 0
  v_mfma_f32_16x16x32_bf16 v[92:95], a[168:171], v[208:211], 0
  v_mfma_f32_16x16x32_bf16 v[128:131], a[168:171], v[212:215], 0
  v_mfma_f32_16x16x32_bf16 v[148:151], a[168:171], v[216:219], 0
  v_mfma_f32_16x16x32_bf16 v[76:79], a[172:175], v[204:207], 0
  v_mfma_f32_16x16x32_bf16 v[96:99], a[172:175], v[208:211], 0
  v_mfma_f32_16x16x32_bf16 v[132:135], a[172:175], v[212:215], 0
  v_mfma_f32_16x16x32_bf16 v[152:155], a[172:175], v[216:219], 0
  v_mfma_f32_16x16x32_bf16 v[80:83], a[176:179], v[204:207], 0
  v_mfma_f32_16x16x32_bf16 v[100:103], a[176:179], v[208:211], 0
  v_mfma_f32_16x16x32_bf16 v[136:139], a[176:179], v[212:215], 0
  v_mfma_f32_16x16x32_bf16 v[156:159], a[176:179], v[216:219], 0
  s_waitcnt vmcnt(8)
  v_mfma_f32_16x16x32_bf16 v[64:67], a[180:183], v[220:223], v[64:67]
  v_mfma_f32_16x16x32_bf16 v[84:87], a[180:183], v[224:227], v[84:87]
  s_add_u32 s95, s39, 6144
  buffer_load_dwordx4 v[252:255], v112, s[8:11], s95 offen sc1
  v_mfma_f32_16x16x32_bf16 v[104:107], a[180:183], v[228:231], v[104:107]
  v_mfma_f32_16x16x32_bf16 v[140:143], a[180:183], v[232:235], v[140:143]
  buffer_load_dwordx4 v[192:195], v113, s[8:11], s95 offen sc1
  v_mfma_f32_16x16x32_bf16 v[68:71], a[184:187], v[220:223], v[68:71]
  v_mfma_f32_16x16x32_bf16 v[88:91], a[184:187], v[224:227], v[88:91]
  buffer_load_dwordx4 v[196:199], v114, s[8:11], s95 offen sc1
  v_mfma_f32_16x16x32_bf16 v[108:111], a[184:187], v[228:231], v[108:111]
  v_mfma_f32_16x16x32_bf16 v[144:147], a[184:187], v[232:235], v[144:147]
  buffer_load_dwordx4 v[200:203], v115, s[8:11], s95 offen sc1
  v_mfma_f32_16x16x32_bf16 v[72:75], a[188:191], v[220:223], v[72:75]
  v_mfma_f32_16x16x32_bf16 v[92:95], a[188:191], v[224:227], v[92:95]
  ds_read_b64 v[14:15], v126 offset:96
  ds_read_b64 v[24:25], v3 offset:96
  v_mfma_f32_16x16x32_bf16 v[128:131], a[188:191], v[228:231], v[128:131]
  v_mfma_f32_16x16x32_bf16 v[148:151], a[188:191], v[232:235], v[148:151]
  ds_read_b64 v[16:17], v126 offset:128
  ds_read_b64 v[26:27], v3 offset:128
  v_mfma_f32_16x16x32_bf16 v[76:79], a[192:195], v[220:223], v[76:79]
  v_mfma_f32_16x16x32_bf16 v[96:99], a[192:195], v[224:227], v[96:99]
  v_mfma_f32_16x16x32_bf16 v[132:135], a[192:195], v[228:231], v[132:135]
  v_mfma_f32_16x16x32_bf16 v[152:155], a[192:195], v[232:235], v[152:155]
  v_mfma_f32_16x16x32_bf16 v[80:83], a[196:199], v[220:223], v[80:83]
  v_mfma_f32_16x16x32_bf16 v[100:103], a[196:199], v[224:227], v[100:103]
  v_mfma_f32_16x16x32_bf16 v[136:139], a[196:199], v[228:231], v[136:139]
  v_mfma_f32_16x16x32_bf16 v[156:159], a[196:199], v[232:235], v[156:159]
  s_waitcnt vmcnt(8)
  v_mfma_f32_16x16x32_bf16 v[64:67], a[200:203], v[236:239], v[64:67]
  v_mfma_f32_16x16x32_bf16 v[84:87], a[200:203], v[240:243], v[84:87]
  s_add_u32 s95, s39, 8192
  buffer_load_dwordx4 v[204:207], v112, s[8:11], s95 offen sc1
  v_mfma_f32_16x16x32_bf16 v[104:107], a[200:203], v[244:247], v[104:107]
  v_mfma_f32_16x16x32_bf16 v[140:143], a[200:203], v[248:251], v[140:143]
  buffer_load_dwordx4 v[208:211], v113, s[8:11], s95 offen sc1
  v_mfma_f32_16x16x32_bf16 v[68:71], a[204:207], v[236:239], v[68:71]
  v_mfma_f32_16x16x32_bf16 v[88:91], a[204:207], v[240:243], v[88:91]
  buffer_load_dwordx4 v[212:215], v114, s[8:11], s95 offen sc1
  v_mfma_f32_16x16x32_bf16 v[108:111], a[204:207], v[244:247], v[108:111]
  v_mfma_f32_16x16x32_bf16 v[144:147], a[204:207], v[248:251], v[144:147]
  buffer_load_dwordx4 v[216:219], v115, s[8:11], s95 offen sc1
  v_mfma_f32_16x16x32_bf16 v[72:75], a[208:211], v[236:239], v[72:75]
  v_mfma_f32_16x16x32_bf16 v[92:95], a[208:211], v[240:243], v[92:95]
  v_mfma_f32_16x16x32_bf16 v[128:131], a[208:211], v[244:247], v[128:131]
  v_mfma_f32_16x16x32_bf16 v[148:151], a[208:211], v[248:251], v[148:151]
  v_mfma_f32_16x16x32_bf16 v[76:79], a[212:215], v[236:239], v[76:79]
  v_mfma_f32_16x16x32_bf16 v[96:99], a[212:215], v[240:243], v[96:99]
  v_mfma_f32_16x16x32_bf16 v[132:135], a[212:215], v[244:247], v[132:135]
  v_mfma_f32_16x16x32_bf16 v[152:155], a[212:215], v[248:251], v[152:155]
  v_mfma_f32_16x16x32_bf16 v[80:83], a[216:219], v[236:239], v[80:83]
  v_mfma_f32_16x16x32_bf16 v[100:103], a[216:219], v[240:243], v[100:103]
  v_mfma_f32_16x16x32_bf16 v[136:139], a[216:219], v[244:247], v[136:139]
  v_mfma_f32_16x16x32_bf16 v[156:159], a[216:219], v[248:251], v[156:159]
  s_waitcnt vmcnt(8)
  s_waitcnt lgkmcnt(0)
  s_barrier
  s_lshl_b32 s56, s37, 3
  s_add_u32 s56, s56, 23461888
  buffer_store_dwordx2 v[38:39], v36, s[8:11], s56 offen sc1
  s_waitcnt vmcnt(5)
  v_mfma_f32_16x16x32_bf16 v[64:67], a[220:223], v[252:255], v[64:67]
  v_mfma_f32_16x16x32_bf16 v[84:87], a[220:223], v[192:195], v[84:87]
  s_add_u32 s95, s39, 10240
  buffer_load_dwordx4 v[220:223], v112, s[8:11], s95 offen sc1
  v_mfma_f32_16x16x32_bf16 v[104:107], a[220:223], v[196:199], v[104:107]
  v_mfma_f32_16x16x32_bf16 v[140:143], a[220:223], v[200:203], v[140:143]
  buffer_load_dwordx4 v[224:227], v113, s[8:11], s95 offen sc1
  v_mfma_f32_16x16x32_bf16 v[68:71], a[224:227], v[252:255], v[68:71]
  v_mfma_f32_16x16x32_bf16 v[88:91], a[224:227], v[192:195], v[88:91]
  buffer_load_dwordx4 v[228:231], v114, s[8:11], s95 offen sc1
  v_mfma_f32_16x16x32_bf16 v[108:111], a[224:227], v[196:199], v[108:111]
  v_mfma_f32_16x16x32_bf16 v[144:147], a[224:227], v[200:203], v[144:147]
  buffer_load_dwordx4 v[232:235], v115, s[8:11], s95 offen sc1
  v_mfma_f32_16x16x32_bf16 v[72:75], a[228:231], v[252:255], v[72:75]
  v_mfma_f32_16x16x32_bf16 v[92:95], a[228:231], v[192:195], v[92:95]
  buffer_load_dwordx4 a[160:163], v35, s[8:11], s90 offen offset:2048 sc1
  v_mfma_f32_16x16x32_bf16 v[128:131], a[228:231], v[196:199], v[128:131]
  v_mfma_f32_16x16x32_bf16 v[148:151], a[228:231], v[200:203], v[148:151]
  buffer_load_dwordx4 a[164:167], v35, s[8:11], s90 offen offset:3072 sc1
  v_mfma_f32_16x16x32_bf16 v[76:79], a[232:235], v[252:255], v[76:79]
  v_mfma_f32_16x16x32_bf16 v[96:99], a[232:235], v[192:195], v[96:99]
  v_mfma_f32_16x16x32_bf16 v[132:135], a[232:235], v[196:199], v[132:135]
  v_mfma_f32_16x16x32_bf16 v[152:155], a[232:235], v[200:203], v[152:155]
  v_mfma_f32_16x16x32_bf16 v[80:83], a[236:239], v[252:255], v[80:83]
  v_mfma_f32_16x16x32_bf16 v[100:103], a[236:239], v[192:195], v[100:103]
  v_mfma_f32_16x16x32_bf16 v[136:139], a[236:239], v[196:199], v[136:139]
  v_mfma_f32_16x16x32_bf16 v[156:159], a[236:239], v[200:203], v[156:159]
  s_waitcnt vmcnt(7)
  v_mfma_f32_16x16x32_bf16 v[64:67], a[240:243], v[204:207], v[64:67]
  v_mfma_f32_16x16x32_bf16 v[84:87], a[240:243], v[208:211], v[84:87]
  s_add_u32 s95, s39, 12288
  buffer_load_dwordx4 v[236:239], v112, s[8:11], s95 offen sc1
  v_mfma_f32_16x16x32_bf16 v[104:107], a[240:243], v[212:215], v[104:107]
  v_mfma_f32_16x16x32_bf16 v[140:143], a[240:243], v[216:219], v[140:143]
  buffer_load_dwordx4 v[240:243], v113, s[8:11], s95 offen sc1
  v_mfma_f32_16x16x32_bf16 v[68:71], a[244:247], v[204:207], v[68:71]
  v_mfma_f32_16x16x32_bf16 v[88:91], a[244:247], v[208:211], v[88:91]
  buffer_load_dwordx4 v[244:247], v114, s[8:11], s95 offen sc1
  v_mfma_f32_16x16x32_bf16 v[108:111], a[244:247], v[212:215], v[108:111]
  v_mfma_f32_16x16x32_bf16 v[144:147], a[244:247], v[216:219], v[144:147]
  buffer_load_dwordx4 v[248:251], v115, s[8:11], s95 offen sc1
  v_mfma_f32_16x16x32_bf16 v[72:75], a[248:251], v[204:207], v[72:75]
  v_mfma_f32_16x16x32_bf16 v[92:95], a[248:251], v[208:211], v[92:95]
  s_add_u32 s90, s89, 8192
  buffer_load_dwordx4 a[168:171], v35, s[8:11], s90 offen offset:0 sc1
  v_mfma_f32_16x16x32_bf16 v[128:131], a[248:251], v[212:215], v[128:131]
  v_mfma_f32_16x16x32_bf16 v[148:151], a[248:251], v[216:219], v[148:151]
  v_mfma_f32_16x16x32_bf16 v[76:79], a[252:255], v[204:207], v[76:79]
  v_mfma_f32_16x16x32_bf16 v[96:99], a[252:255], v[208:211], v[96:99]
  v_mfma_f32_16x16x32_bf16 v[132:135], a[252:255], v[212:215], v[132:135]
  v_mfma_f32_16x16x32_bf16 v[152:155], a[252:255], v[216:219], v[152:155]
  v_mfma_f32_16x16x32_bf16 v[80:83], a[0:3], v[204:207], v[80:83]
  v_mfma_f32_16x16x32_bf16 v[100:103], a[0:3], v[208:211], v[100:103]
  v_mfma_f32_16x16x32_bf16 v[136:139], a[0:3], v[212:215], v[136:139]
  v_mfma_f32_16x16x32_bf16 v[156:159], a[0:3], v[216:219], v[156:159]
  s_waitcnt vmcnt(7)
  v_mfma_f32_16x16x32_bf16 v[64:67], a[4:7], v[220:223], v[64:67]
  v_mfma_f32_16x16x32_bf16 v[84:87], a[4:7], v[224:227], v[84:87]
  s_add_u32 s95, s39, 14336
  buffer_load_dwordx4 v[252:255], v112, s[8:11], s95 offen sc1
  v_mfma_f32_16x16x32_bf16 v[104:107], a[4:7], v[228:231], v[104:107]
  v_mfma_f32_16x16x32_bf16 v[140:143], a[4:7], v[232:235], v[140:143]
  buffer_load_dwordx4 v[192:195], v113, s[8:11], s95 offen sc1
  v_mfma_f32_16x16x32_bf16 v[68:71], a[8:11], v[220:223], v[68:71]
  v_mfma_f32_16x16x32_bf16 v[88:91], a[8:11], v[224:227], v[88:91]
  buffer_load_dwordx4 v[196:199], v114, s[8:11], s95 offen sc1
  v_mfma_f32_16x16x32_bf16 v[108:111], a[8:11], v[228:231], v[108:111]
  v_mfma_f32_16x16x32_bf16 v[144:147], a[8:11], v[232:235], v[144:147]
  buffer_load_dwordx4 v[200:203], v115, s[8:11], s95 offen sc1
  v_mfma_f32_16x16x32_bf16 v[72:75], a[12:15], v[220:223], v[72:75]
  v_mfma_f32_16x16x32_bf16 v[92:95], a[12:15], v[224:227], v[92:95]
  buffer_load_dwordx4 a[172:175], v35, s[8:11], s90 offen offset:1024 sc1
  v_mfma_f32_16x16x32_bf16 v[128:131], a[12:15], v[228:231], v[128:131]
  v_mfma_f32_16x16x32_bf16 v[148:151], a[12:15], v[232:235], v[148:151]
  buffer_load_dwordx4 a[176:179], v35, s[8:11], s90 offen offset:2048 sc1
  v_mfma_f32_16x16x32_bf16 v[76:79], a[16:19], v[220:223], v[76:79]
  v_mfma_f32_16x16x32_bf16 v[96:99], a[16:19], v[224:227], v[96:99]
  v_mfma_f32_16x16x32_bf16 v[132:135], a[16:19], v[228:231], v[132:135]
  v_mfma_f32_16x16x32_bf16 v[152:155], a[16:19], v[232:235], v[152:155]
  v_mfma_f32_16x16x32_bf16 v[80:83], a[20:23], v[220:223], v[80:83]
  v_mfma_f32_16x16x32_bf16 v[100:103], a[20:23], v[224:227], v[100:103]
  v_mfma_f32_16x16x32_bf16 v[136:139], a[20:23], v[228:231], v[136:139]
  v_mfma_f32_16x16x32_bf16 v[156:159], a[20:23], v[232:235], v[156:159]
  s_waitcnt vmcnt(7)
  v_mfma_f32_16x16x32_bf16 v[64:67], a[24:27], v[236:239], v[64:67]
  v_mfma_f32_16x16x32_bf16 v[84:87], a[24:27], v[240:243], v[84:87]
  s_add_u32 s95, s39, 16384
  buffer_load_dwordx4 v[204:207], v112, s[8:11], s95 offen sc1
  v_mfma_f32_16x16x32_bf16 v[104:107], a[24:27], v[244:247], v[104:107]
  v_mfma_f32_16x16x32_bf16 v[140:143], a[24:27], v[248:251], v[140:143]
  buffer_load_dwordx4 v[208:211], v113, s[8:11], s95 offen sc1
  v_mfma_f32_16x16x32_bf16 v[68:71], a[28:31], v[236:239], v[68:71]
  v_mfma_f32_16x16x32_bf16 v[88:91], a[28:31], v[240:243], v[88:91]
  buffer_load_dwordx4 v[212:215], v114, s[8:11], s95 offen sc1
  v_mfma_f32_16x16x32_bf16 v[108:111], a[28:31], v[244:247], v[108:111]
  v_mfma_f32_16x16x32_bf16 v[144:147], a[28:31], v[248:251], v[144:147]
  buffer_load_dwordx4 v[216:219], v115, s[8:11], s95 offen sc1
  v_mfma_f32_16x16x32_bf16 v[72:75], a[32:35], v[236:239], v[72:75]
  v_mfma_f32_16x16x32_bf16 v[92:95], a[32:35], v[240:243], v[92:95]
  buffer_load_dwordx4 a[180:183], v35, s[8:11], s90 offen offset:3072 sc1
  v_mfma_f32_16x16x32_bf16 v[128:131], a[32:35], v[244:247], v[128:131]
  v_mfma_f32_16x16x32_bf16 v[148:151], a[32:35], v[248:251], v[148:151]
  v_mfma_f32_16x16x32_bf16 v[76:79], a[36:39], v[236:239], v[76:79]
  v_mfma_f32_16x16x32_bf16 v[96:99], a[36:39], v[240:243], v[96:99]
  v_mfma_f32_16x16x32_bf16 v[132:135], a[36:39], v[244:247], v[132:135]
  v_mfma_f32_16x16x32_bf16 v[152:155], a[36:39], v[248:251], v[152:155]
  v_mfma_f32_16x16x32_bf16 v[80:83], a[40:43], v[236:239], v[80:83]
  v_mfma_f32_16x16x32_bf16 v[100:103], a[40:43], v[240:243], v[100:103]
  v_mfma_f32_16x16x32_bf16 v[136:139], a[40:43], v[244:247], v[136:139]
  v_mfma_f32_16x16x32_bf16 v[156:159], a[40:43], v[248:251], v[156:159]
  s_waitcnt vmcnt(7)
  v_mfma_f32_16x16x32_bf16 v[64:67], a[44:47], v[252:255], v[64:67]
  v_mfma_f32_16x16x32_bf16 v[84:87], a[44:47], v[192:195], v[84:87]
  s_add_u32 s95, s39, 18432
  buffer_load_dwordx4 v[220:223], v112, s[8:11], s95 offen sc1
  v_mfma_f32_16x16x32_bf16 v[104:107], a[44:47], v[196:199], v[104:107]
  v_mfma_f32_16x16x32_bf16 v[140:143], a[44:47], v[200:203], v[140:143]
  buffer_load_dwordx4 v[224:227], v113, s[8:11], s95 offen sc1
  v_mfma_f32_16x16x32_bf16 v[68:71], a[48:51], v[252:255], v[68:71]
  v_mfma_f32_16x16x32_bf16 v[88:91], a[48:51], v[192:195], v[88:91]
  buffer_load_dwordx4 v[228:231], v114, s[8:11], s95 offen sc1
  v_mfma_f32_16x16x32_bf16 v[108:111], a[48:51], v[196:199], v[108:111]
  v_mfma_f32_16x16x32_bf16 v[144:147], a[48:51], v[200:203], v[144:147]
  buffer_load_dwordx4 v[232:235], v115, s[8:11], s95 offen sc1
  v_mfma_f32_16x16x32_bf16 v[72:75], a[52:55], v[252:255], v[72:75]
  v_mfma_f32_16x16x32_bf16 v[92:95], a[52:55], v[192:195], v[92:95]
  s_add_u32 s90, s89, 12288
  buffer_load_dwordx4 a[184:187], v35, s[8:11], s90 offen offset:0 sc1
  v_mfma_f32_16x16x32_bf16 v[128:131], a[52:55], v[196:199], v[128:131]
  v_mfma_f32_16x16x32_bf16 v[148:151], a[52:55], v[200:203], v[148:151]
  buffer_load_dwordx4 a[188:191], v35, s[8:11], s90 offen offset:1024 sc1
  v_mfma_f32_16x16x32_bf16 v[76:79], a[56:59], v[252:255], v[76:79]
  v_mfma_f32_16x16x32_bf16 v[96:99], a[56:59], v[192:195], v[96:99]
  v_mfma_f32_16x16x32_bf16 v[132:135], a[56:59], v[196:199], v[132:135]
  v_mfma_f32_16x16x32_bf16 v[152:155], a[56:59], v[200:203], v[152:155]
  v_mfma_f32_16x16x32_bf16 v[80:83], a[60:63], v[252:255], v[80:83]
  v_mfma_f32_16x16x32_bf16 v[100:103], a[60:63], v[192:195], v[100:103]
  v_mfma_f32_16x16x32_bf16 v[136:139], a[60:63], v[196:199], v[136:139]
  v_mfma_f32_16x16x32_bf16 v[156:159], a[60:63], v[200:203], v[156:159]
  s_waitcnt vmcnt(7)
  v_mfma_f32_16x16x32_bf16 v[64:67], a[64:67], v[204:207], v[64:67]
  v_mfma_f32_16x16x32_bf16 v[84:87], a[64:67], v[208:211], v[84:87]
  s_add_u32 s95, s39, 20480
  buffer_load_dwordx4 v[236:239], v112, s[8:11], s95 offen sc1
  v_mfma_f32_16x16x32_bf16 v[104:107], a[64:67], v[212:215], v[104:107]
  v_mfma_f32_16x16x32_bf16 v[140:143], a[64:67], v[216:219], v[140:143]
  buffer_load_dwordx4 v[240:243], v113, s[8:11], s95 offen sc1
  v_mfma_f32_16x16x32_bf16 v[68:71], a[68:71], v[204:207], v[68:71]
  v_mfma_f32_16x16x32_bf16 v[88:91], a[68:71], v[208:211], v[88:91]
  buffer_load_dwordx4 v[244:247], v114, s[8:11], s95 offen sc1
  v_mfma_f32_16x16x32_bf16 v[108:111], a[68:71], v[212:215], v[108:111]
  v_mfma_f32_16x16x32_bf16 v[144:147], a[68:71], v[216:219], v[144:147]
  buffer_load_dwordx4 v[248:251], v115, s[8:11], s95 offen sc1
  v_mfma_f32_16x16x32_bf16 v[72:75], a[72:75], v[204:207], v[72:75]
  v_mfma_f32_16x16x32_bf16 v[92:95], a[72:75], v[208:211], v[92:95]
  buffer_load_dwordx4 a[192:195], v35, s[8:11], s90 offen offset:2048 sc1
  v_mfma_f32_16x16x32_bf16 v[128:131], a[72:75], v[212:215], v[128:131]
  v_mfma_f32_16x16x32_bf16 v[148:151], a[72:75], v[216:219], v[148:151]
  v_mfma_f32_16x16x32_bf16 v[76:79], a[76:79], v[204:207], v[76:79]
  v_mfma_f32_16x16x32_bf16 v[96:99], a[76:79], v[208:211], v[96:99]
  v_mfma_f32_16x16x32_bf16 v[132:135], a[76:79], v[212:215], v[132:135]
  v_mfma_f32_16x16x32_bf16 v[152:155], a[76:79], v[216:219], v[152:155]
  v_mfma_f32_16x16x32_bf16 v[80:83], a[80:83], v[204:207], v[80:83]
  v_mfma_f32_16x16x32_bf16 v[100:103], a[80:83], v[208:211], v[100:103]
  v_mfma_f32_16x16x32_bf16 v[136:139], a[80:83], v[212:215], v[136:139]
  v_mfma_f32_16x16x32_bf16 v[156:159], a[80:83], v[216:219], v[156:159]
  s_waitcnt vmcnt(7)
  v_mfma_f32_16x16x32_bf16 v[64:67], a[84:87], v[220:223], v[64:67]
  v_mfma_f32_16x16x32_bf16 v[84:87], a[84:87], v[224:227], v[84:87]
  s_add_u32 s95, s39, 22528
  buffer_load_dwordx4 v[252:255], v112, s[8:11], s95 offen sc1
  v_mfma_f32_16x16x32_bf16 v[104:107], a[84:87], v[228:231], v[104:107]
  v_mfma_f32_16x16x32_bf16 v[140:143], a[84:87], v[232:235], v[140:143]
  buffer_load_dwordx4 v[192:195], v113, s[8:11], s95 offen sc1
  v_mfma_f32_16x16x32_bf16 v[68:71], a[88:91], v[220:223], v[68:71]
  v_mfma_f32_16x16x32_bf16 v[88:91], a[88:91], v[224:227], v[88:91]
  buffer_load_dwordx4 v[196:199], v114, s[8:11], s95 offen sc1
  v_mfma_f32_16x16x32_bf16 v[108:111], a[88:91], v[228:231], v[108:111]
  v_mfma_f32_16x16x32_bf16 v[144:147], a[88:91], v[232:235], v[144:147]
  buffer_load_dwordx4 v[200:203], v115, s[8:11], s95 offen sc1
  v_mfma_f32_16x16x32_bf16 v[72:75], a[92:95], v[220:223], v[72:75]
  v_mfma_f32_16x16x32_bf16 v[92:95], a[92:95], v[224:227], v[92:95]
  buffer_load_dwordx4 a[196:199], v35, s[8:11], s90 offen offset:3072 sc1
  v_mfma_f32_16x16x32_bf16 v[128:131], a[92:95], v[228:231], v[128:131]
  v_mfma_f32_16x16x32_bf16 v[148:151], a[92:95], v[232:235], v[148:151]
  s_add_u32 s90, s89, 16384
  buffer_load_dwordx4 a[200:203], v35, s[8:11], s90 offen offset:0 sc1
  v_mfma_f32_16x16x32_bf16 v[76:79], a[96:99], v[220:223], v[76:79]
  v_mfma_f32_16x16x32_bf16 v[96:99], a[96:99], v[224:227], v[96:99]
  s_mov_b32 s82, 23461888
  buffer_load_dwordx2 v[6:7], v121, s[8:11], s82 offen sc1
  v_mfma_f32_16x16x32_bf16 v[132:135], a[96:99], v[228:231], v[132:135]
  v_mfma_f32_16x16x32_bf16 v[152:155], a[96:99], v[232:235], v[152:155]
  v_mfma_f32_16x16x32_bf16 v[80:83], a[100:103], v[220:223], v[80:83]
  v_mfma_f32_16x16x32_bf16 v[100:103], a[100:103], v[224:227], v[100:103]
  v_mfma_f32_16x16x32_bf16 v[136:139], a[100:103], v[228:231], v[136:139]
  v_mfma_f32_16x16x32_bf16 v[156:159], a[100:103], v[232:235], v[156:159]
  s_waitcnt vmcnt(8)
  v_mfma_f32_16x16x32_bf16 v[64:67], a[104:107], v[236:239], v[64:67]
  v_mfma_f32_16x16x32_bf16 v[84:87], a[104:107], v[240:243], v[84:87]
  s_add_u32 s95, s39, 24576
  buffer_load_dwordx4 v[204:207], v112, s[8:11], s95 offen sc1
  v_mfma_f32_16x16x32_bf16 v[104:107], a[104:107], v[244:247], v[104:107]
  v_mfma_f32_16x16x32_bf16 v[140:143], a[104:107], v[248:251], v[140:143]
  buffer_load_dwordx4 v[208:211], v113, s[8:11], s95 offen sc1
  v_mfma_f32_16x16x32_bf16 v[68:71], a[108:111], v[236:239], v[68:71]
  v_mfma_f32_16x16x32_bf16 v[88:91], a[108:111], v[240:243], v[88:91]
  buffer_load_dwordx4 v[212:215], v114, s[8:11], s95 offen sc1
  v_mfma_f32_16x16x32_bf16 v[108:111], a[108:111], v[244:247], v[108:111]
  v_mfma_f32_16x16x32_bf16 v[144:147], a[108:111], v[248:251], v[144:147]
  buffer_load_dwordx4 v[216:219], v115, s[8:11], s95 offen sc1
  v_mfma_f32_16x16x32_bf16 v[72:75], a[112:115], v[236:239], v[72:75]
  v_mfma_f32_16x16x32_bf16 v[92:95], a[112:115], v[240:243], v[92:95]
  buffer_load_dwordx4 a[204:207], v35, s[8:11], s90 offen offset:1024 sc1
  v_mfma_f32_16x16x32_bf16 v[128:131], a[112:115], v[244:247], v[128:131]
  v_mfma_f32_16x16x32_bf16 v[148:151], a[112:115], v[248:251], v[148:151]
  v_mfma_f32_16x16x32_bf16 v[76:79], a[116:119], v[236:239], v[76:79]
  v_mfma_f32_16x16x32_bf16 v[96:99], a[116:119], v[240:243], v[96:99]
  v_mfma_f32_16x16x32_bf16 v[132:135], a[116:119], v[244:247], v[132:135]
  v_mfma_f32_16x16x32_bf16 v[152:155], a[116:119], v[248:251], v[152:155]
  v_mfma_f32_16x16x32_bf16 v[80:83], a[120:123], v[236:239], v[80:83]
  v_mfma_f32_16x16x32_bf16 v[100:103], a[120:123], v[240:243], v[100:103]
  v_mfma_f32_16x16x32_bf16 v[136:139], a[120:123], v[244:247], v[136:139]
  v_mfma_f32_16x16x32_bf16 v[156:159], a[120:123], v[248:251], v[156:159]
  s_waitcnt vmcnt(8)
  v_mfma_f32_16x16x32_bf16 v[64:67], a[124:127], v[252:255], v[64:67]
  v_mfma_f32_16x16x32_bf16 v[84:87], a[124:127], v[192:195], v[84:87]
  s_add_u32 s95, s39, 26624
  s_cmp_lt_u32 s3, 2
  s_cselect_b32 s95, s95, 1073741824
  buffer_load_dwordx4 v[220:223], v112, s[8:11], s95 offen sc1
  v_mfma_f32_16x16x32_bf16 v[104:107], a[124:127], v[196:199], v[104:107]
  v_mfma_f32_16x16x32_bf16 v[140:143], a[124:127], v[200:203], v[140:143]
  buffer_load_dwordx4 v[224:227], v113, s[8:11], s95 offen sc1
  v_mfma_f32_16x16x32_bf16 v[68:71], a[128:131], v[252:255], v[68:71]
  v_mfma_f32_16x16x32_bf16 v[88:91], a[128:131], v[192:195], v[88:91]
  buffer_load_dwordx4 v[228:231], v114, s[8:11], s95 offen sc1
  v_mfma_f32_16x16x32_bf16 v[108:111], a[128:131], v[196:199], v[108:111]
  v_mfma_f32_16x16x32_bf16 v[144:147], a[128:131], v[200:203], v[144:147]
  buffer_load_dwordx4 v[232:235], v115, s[8:11], s95 offen sc1
  v_mfma_f32_16x16x32_bf16 v[72:75], a[132:135], v[252:255], v[72:75]
  v_mfma_f32_16x16x32_bf16 v[92:95], a[132:135], v[192:195], v[92:95]
  buffer_load_dwordx4 a[208:211], v35, s[8:11], s90 offen offset:2048 sc1
  v_mfma_f32_16x16x32_bf16 v[128:131], a[132:135], v[196:199], v[128:131]
  v_mfma_f32_16x16x32_bf16 v[148:151], a[132:135], v[200:203], v[148:151]
  buffer_load_dwordx4 a[212:215], v35, s[8:11], s90 offen offset:3072 sc1
  v_mfma_f32_16x16x32_bf16 v[76:79], a[136:139], v[252:255], v[76:79]
  v_mfma_f32_16x16x32_bf16 v[96:99], a[136:139], v[192:195], v[96:99]
  v_mfma_f32_16x16x32_bf16 v[132:135], a[136:139], v[196:199], v[132:135]
  v_mfma_f32_16x16x32_bf16 v[152:155], a[136:139], v[200:203], v[152:155]
  v_mfma_f32_16x16x32_bf16 v[80:83], a[140:143], v[252:255], v[80:83]
  v_mfma_f32_16x16x32_bf16 v[100:103], a[140:143], v[192:195], v[100:103]
  v_mfma_f32_16x16x32_bf16 v[136:139], a[140:143], v[196:199], v[136:139]
  v_mfma_f32_16x16x32_bf16 v[156:159], a[140:143], v[200:203], v[156:159]
  s_waitcnt vmcnt(11)
  v_xor_b32 v6, v38, v6
  v_xor_b32 v7, v39, v7
  v_or_b32 v6, v6, v7
  v_cmp_ne_u32 vcc, 0, v6
  s_nop 4
  s_cbranch_vccz L_pok4
  s_mov_b32 s57, 0
L_pspin4:
  s_sleep 1
  buffer_load_dwordx2 v[6:7], v121, s[8:11], s82 offen sc1
  s_add_u32 s57, s57, 1
  s_waitcnt vmcnt(0)
  v_xor_b32 v6, v38, v6
  v_xor_b32 v7, v39, v7
  v_or_b32 v6, v6, v7
  v_cmp_ne_u32 vcc, 0, v6
  s_nop 4
  s_cmp_gt_u32 s57, 100000
  s_cbranch_scc1 L_pok4
  s_cbranch_vccnz L_pspin4
L_pok4:
  s_waitcnt vmcnt(7)
  v_mfma_f32_16x16x32_bf16 v[64:67], a[144:147], v[204:207], v[64:67]
  v_mfma_f32_16x16x32_bf16 v[84:87], a[144:147], v[208:211], v[84:87]
  s_add_u32 s95, s42, 0
  buffer_load_dwordx4 v[236:239], v116, s[8:11], s95 offen sc1
  v_mfma_f32_16x16x32_bf16 v[104:107], a[144:147], v[212:215], v[104:107]
  v_mfma_f32_16x16x32_bf16 v[140:143], a[144:147], v[216:219], v[140:143]
  buffer_load_dwordx4 v[240:243], v117, s[8:11], s95 offen sc1
  ds_read_b128 v[160:163], v1 offset:4096
  v_mfma_f32_16x16x32_bf16 v[68:71], a[148:151], v[204:207], v[68:71]
  v_mfma_f32_16x16x32_bf16 v[88:91], a[148:151], v[208:211], v[88:91]
  buffer_load_dwordx4 v[244:247], v118, s[8:11], s95 offen sc1
  v_mfma_f32_16x16x32_bf16 v[108:111], a[148:151], v[212:215], v[108:111]
  v_mfma_f32_16x16x32_bf16 v[144:147], a[148:151], v[216:219], v[144:147]
  buffer_load_dwordx4 v[248:251], v119, s[8:11], s95 offen sc1
  ds_read_b128 v[164:167], v1 offset:5120
  v_mfma_f32_16x16x32_bf16 v[72:75], a[152:155], v[204:207], v[72:75]
  v_mfma_f32_16x16x32_bf16 v[92:95], a[152:155], v[208:211], v[92:95]
  s_add_u32 s90, s89, 20480
  buffer_load_dwordx4 a[216:219], v35, s[8:11], s90 offen offset:0 sc1
  v_mfma_f32_16x16x32_bf16 v[128:131], a[152:155], v[212:215], v[128:131]
  v_mfma_f32_16x16x32_bf16 v[148:151], a[152:155], v[216:219], v[148:151]
  ds_read_b128 v[168:171], v1 offset:6144
  v_mfma_f32_16x16x32_bf16 v[76:79], a[156:159], v[204:207], v[76:79]
  v_mfma_f32_16x16x32_bf16 v[96:99], a[156:159], v[208:211], v[96:99]
  v_mfma_f32_16x16x32_bf16 v[132:135], a[156:159], v[212:215], v[132:135]
  v_mfma_f32_16x16x32_bf16 v[152:155], a[156:159], v[216:219], v[152:155]
  ds_read_b128 v[172:175], v1 offset:7168
  s_waitcnt lgkmcnt(3)
  v_mfma_f32_16x16x32_bf16 v[80:83], v[160:163], v[204:207], v[80:83]
  v_mfma_f32_16x16x32_bf16 v[100:103], v[160:163], v[208:211], v[100:103]
  v_mfma_f32_16x16x32_bf16 v[136:139], v[160:163], v[212:215], v[136:139]
  v_mfma_f32_16x16x32_bf16 v[156:159], v[160:163], v[216:219], v[156:159]
  s_waitcnt vmcnt(7)
  ds_read_b128 v[176:179], v1 offset:8192
  s_waitcnt lgkmcnt(3)
  v_mfma_f32_16x16x32_bf16 v[64:67], v[164:167], v[220:223], v[64:67]
  v_mfma_f32_16x16x32_bf16 v[84:87], v[164:167], v[224:227], v[84:87]
  s_add_u32 s95, s42, 2048
  buffer_load_dwordx4 v[252:255], v116, s[8:11], s95 offen sc1
  v_mfma_f32_16x16x32_bf16 v[104:107], v[164:167], v[228:231], v[104:107]
  v_mfma_f32_16x16x32_bf16 v[140:143], v[164:167], v[232:235], v[140:143]
  buffer_load_dwordx4 v[192:195], v117, s[8:11], s95 offen sc1
  ds_read_b128 v[180:183], v1 offset:9216
  s_waitcnt lgkmcnt(3)
  v_mfma_f32_16x16x32_bf16 v[68:71], v[168:171], v[220:223], v[68:71]
  v_mfma_f32_16x16x32_bf16 v[88:91], v[168:171], v[224:227], v[88:91]
  buffer_load_dwordx4 v[196:199], v118, s[8:11], s95 offen sc1
  v_mfma_f32_16x16x32_bf16 v[108:111], v[168:171], v[228:231], v[108:111]
  v_mfma_f32_16x16x32_bf16 v[144:147], v[168:171], v[232:235], v[144:147]
  buffer_load_dwordx4 v[200:203], v119, s[8:11], s95 offen sc1
  ds_read_b128 v[184:187], v1 offset:10240
  s_waitcnt lgkmcnt(3)
  v_mfma_f32_16x16x32_bf16 v[72:75], v[172:175], v[220:223], v[72:75]
  v_mfma_f32_16x16x32_bf16 v[92:95], v[172:175], v[224:227], v[92:95]
  buffer_load_dwordx4 a[220:223], v35, s[8:11], s90 offen offset:1024 sc1
  v_mfma_f32_16x16x32_bf16 v[128:131], v[172:175], v[228:231], v[128:131]
  v_mfma_f32_16x16x32_bf16 v[148:151], v[172:175], v[232:235], v[148:151]
  buffer_load_dwordx4 a[224:227], v35, s[8:11], s90 offen offset:2048 sc1
  ds_read_b128 v[188:191], v1 offset:11264
  s_waitcnt lgkmcnt(3)
  v_mfma_f32_16x16x32_bf16 v[76:79], v[176:179], v[220:223], v[76:79]
  v_mfma_f32_16x16x32_bf16 v[96:99], v[176:179], v[224:227], v[96:99]
  v_mfma_f32_16x16x32_bf16 v[132:135], v[176:179], v[228:231], v[132:135]
  v_mfma_f32_16x16x32_bf16 v[152:155], v[176:179], v[232:235], v[152:155]
  ds_read_b128 v[160:163], v1 offset:12288
  s_waitcnt lgkmcnt(3)
  v_mfma_f32_16x16x32_bf16 v[80:83], v[180:183], v[220:223], v[80:83]
  v_mfma_f32_16x16x32_bf16 v[100:103], v[180:183], v[224:227], v[100:103]
  v_mfma_f32_16x16x32_bf16 v[136:139], v[180:183], v[228:231], v[136:139]
  v_mfma_f32_16x16x32_bf16 v[156:159], v[180:183], v[232:235], v[156:159]
  s_waitcnt vmcnt(7)
  ds_read_b128 v[164:167], v1 offset:13312
  s_waitcnt lgkmcnt(3)
  v_mfma_f32_16x16x32_bf16 v[64:67], v[184:187], v[236:239], v[64:67]
  v_mfma_f32_16x16x32_bf16 v[84:87], v[184:187], v[240:243], v[84:87]
  s_add_u32 s95, s42, 4096
  buffer_load_dwordx4 v[204:207], v116, s[8:11], s95 offen sc1
  v_mfma_f32_16x16x32_bf16 v[104:107], v[184:187], v[244:247], v[104:107]
  v_mfma_f32_16x16x32_bf16 v[140:143], v[184:187], v[248:251], v[140:143]
  buffer_load_dwordx4 v[208:211], v117, s[8:11], s95 offen sc1
  ds_read_b128 v[168:171], v1 offset:14336
  s_waitcnt lgkmcnt(3)
  v_mfma_f32_16x16x32_bf16 v[68:71], v[188:191], v[236:239], v[68:71]
  v_mfma_f32_16x16x32_bf16 v[88:91], v[188:191], v[240:243], v[88:91]
  buffer_load_dwordx4 v[212:215], v118, s[8:11], s95 offen sc1
  v_mfma_f32_16x16x32_bf16 v[108:111], v[188:191], v[244:247], v[108:111]
  v_mfma_f32_16x16x32_bf16 v[144:147], v[188:191], v[248:251], v[144:147]
  buffer_load_dwordx4 v[216:219], v119, s[8:11], s95 offen sc1
  ds_read_b128 v[172:175], v1 offset:15360
  s_waitcnt lgkmcnt(3)
  v_mfma_f32_16x16x32_bf16 v[72:75], v[160:163], v[236:239], v[72:75]
  v_mfma_f32_16x16x32_bf16 v[92:95], v[160:163], v[240:243], v[92:95]
  buffer_load_dwordx4 a[228:231], v35, s[8:11], s90 offen offset:3072 sc1
  v_mfma_f32_16x16x32_bf16 v[128:131], v[160:163], v[244:247], v[128:131]
  v_mfma_f32_16x16x32_bf16 v[148:151], v[160:163], v[248:251], v[148:151]
  s_waitcnt lgkmcnt(2)
  v_mfma_f32_16x16x32_bf16 v[76:79], v[164:167], v[236:239], v[76:79]
  v_mfma_f32_16x16x32_bf16 v[96:99], v[164:167], v[240:243], v[96:99]
  v_mfma_f32_16x16x32_bf16 v[132:135], v[164:167], v[244:247], v[132:135]
  v_mfma_f32_16x16x32_bf16 v[152:155], v[164:167], v[248:251], v[152:155]
  s_waitcnt lgkmcnt(1)
  v_mfma_f32_16x16x32_bf16 v[80:83], v[168:171], v[236:239], v[80:83]
  v_mfma_f32_16x16x32_bf16 v[100:103], v[168:171], v[240:243], v[100:103]
  v_mfma_f32_16x16x32_bf16 v[136:139], v[168:171], v[244:247], v[136:139]
  v_mfma_f32_16x16x32_bf16 v[156:159], v[168:171], v[248:251], v[156:159]
  s_waitcnt vmcnt(7)
  s_waitcnt lgkmcnt(0)
  v_mfma_f32_16x16x32_bf16 v[64:67], v[172:175], v[252:255], v[64:67]
  v_mfma_f32_16x16x32_bf16 v[84:87], v[172:175], v[192:195], v[84:87]
  s_add_u32 s95, s42, 6144
  buffer_load_dwordx4 v[220:223], v116, s[8:11], s95 offen sc1
  v_mfma_f32_16x16x32_bf16 v[104:107], v[172:175], v[196:199], v[104:107]
  v_mfma_f32_16x16x32_bf16 v[140:143], v[172:175], v[200:203], v[140:143]
  buffer_load_dwordx4 v[224:227], v117, s[8:11], s95 offen sc1
  v_mfma_f32_16x16x32_bf16 v[68:71], a[160:163], v[252:255], v[68:71]
  v_mfma_f32_16x16x32_bf16 v[88:91], a[160:163], v[192:195], v[88:91]
  buffer_load_dwordx4 v[228:231], v118, s[8:11], s95 offen sc1
  v_mfma_f32_16x16x32_bf16 v[108:111], a[160:163], v[196:199], v[108:111]
  v_mfma_f32_16x16x32_bf16 v[144:147], a[160:163], v[200:203], v[144:147]
  buffer_load_dwordx4 v[232:235], v119, s[8:11], s95 offen sc1
  v_mfma_f32_16x16x32_bf16 v[72:75], a[164:167], v[252:255], v[72:75]
  v_mfma_f32_16x16x32_bf16 v[92:95], a[164:167], v[192:195], v[92:95]
  s_add_u32 s90, s89, 24576
  buffer_load_dwordx4 a[232:235], v35, s[8:11], s90 offen offset:0 sc1
  v_mfma_f32_16x16x32_bf16 v[128:131], a[164:167], v[196:199], v[128:131]
  v_mfma_f32_16x16x32_bf16 v[148:151], a[164:167], v[200:203], v[148:151]
  v_mfma_f32_16x16x32_bf16 v[76:79], a[168:171], v[252:255], v[76:79]
  v_mfma_f32_16x16x32_bf16 v[96:99], a[168:171], v[192:195], v[96:99]
  v_mfma_f32_16x16x32_bf16 v[132:135], a[168:171], v[196:199], v[132:135]
  v_mfma_f32_16x16x32_bf16 v[152:155], a[168:171], v[200:203], v[152:155]
  v_mfma_f32_16x16x32_bf16 v[80:83], a[172:175], v[252:255], v[80:83]
  v_mfma_f32_16x16x32_bf16 v[100:103], a[172:175], v[192:195], v[100:103]
  v_mfma_f32_16x16x32_bf16 v[136:139], a[172:175], v[196:199], v[136:139]
  v_mfma_f32_16x16x32_bf16 v[156:159], a[172:175], v[200:203], v[156:159]
  s_waitcnt vmcnt(6)
  v_mfma_f32_16x16x32_bf16 v[64:67], a[176:179], v[204:207], v[64:67]
  v_mfma_f32_16x16x32_bf16 v[84:87], a[176:179], v[208:211], v[84:87]
  s_add_u32 s95, s42, 8192
  buffer_load_dwordx4 v[236:239], v116, s[8:11], s95 offen sc1
  v_mfma_f32_16x16x32_bf16 v[104:107], a[176:179], v[212:215], v[104:107]
  v_mfma_f32_16x16x32_bf16 v[140:143], a[176:179], v[216:219], v[140:143]
  buffer_load_dwordx4 v[240:243], v117, s[8:11], s95 offen sc1
  v_mfma_f32_16x16x32_bf16 v[68:71], a[180:183], v[204:207], v[68:71]
  v_mfma_f32_16x16x32_bf16 v[88:91], a[180:183], v[208:211], v[88:91]
  buffer_load_dwordx4 v[244:247], v118, s[8:11], s95 offen sc1
  v_mfma_f32_16x16x32_bf16 v[108:111], a[180:183], v[212:215], v[108:111]
  v_mfma_f32_16x16x32_bf16 v[144:147], a[180:183], v[216:219], v[144:147]
  buffer_load_dwordx4 v[248:251], v119, s[8:11], s95 offen sc1
  v_mfma_f32_16x16x32_bf16 v[72:75], a[184:187], v[204:207], v[72:75]
  v_mfma_f32_16x16x32_bf16 v[92:95], a[184:187], v[208:211], v[92:95]
  v_mfma_f32_16x16x32_bf16 v[128:131], a[184:187], v[212:215], v[128:131]
  v_mfma_f32_16x16x32_bf16 v[148:151], a[184:187], v[216:219], v[148:151]
  v_mfma_f32_16x16x32_bf16 v[76:79], a[188:191], v[204:207], v[76:79]
  v_mfma_f32_16x16x32_bf16 v[96:99], a[188:191], v[208:211], v[96:99]
  v_mfma_f32_16x16x32_bf16 v[132:135], a[188:191], v[212:215], v[132:135]
  v_mfma_f32_16x16x32_bf16 v[152:155], a[188:191], v[216:219], v[152:155]
  v_mfma_f32_16x16x32_bf16 v[80:83], a[192:195], v[204:207], v[80:83]
  v_mfma_f32_16x16x32_bf16 v[100:103], a[192:195], v[208:211], v[100:103]
  v_mfma_f32_16x16x32_bf16 v[136:139], a[192:195], v[212:215], v[136:139]
  v_mfma_f32_16x16x32_bf16 v[156:159], a[192:195], v[216:219], v[156:159]
  s_waitcnt vmcnt(5)
  v_mfma_f32_16x16x32_bf16 v[64:67], a[196:199], v[220:223], v[64:67]
  v_mfma_f32_16x16x32_bf16 v[84:87], a[196:199], v[224:227], v[84:87]
  v_mfma_f32_16x16x32_bf16 v[104:107], a[196:199], v[228:231], v[104:107]
  v_mfma_f32_16x16x32_bf16 v[140:143], a[196:199], v[232:235], v[140:143]
  v_mfma_f32_16x16x32_bf16 v[68:71], a[200:203], v[220:223], v[68:71]
  v_mfma_f32_16x16x32_bf16 v[88:91], a[200:203], v[224:227], v[88:91]
  v_mfma_f32_16x16x32_bf16 v[108:111], a[200:203], v[228:231], v[108:111]
  v_mfma_f32_16x16x32_bf16 v[144:147], a[200:203], v[232:235], v[144:147]
  v_mfma_f32_16x16x32_bf16 v[72:75], a[204:207], v[220:223], v[72:75]
  v_mfma_f32_16x16x32_bf16 v[92:95], a[204:207], v[224:227], v[92:95]
  v_mfma_f32_16x16x32_bf16 v[128:131], a[204:207], v[228:231], v[128:131]
  v_mfma_f32_16x16x32_bf16 v[148:151], a[204:207], v[232:235], v[148:151]
  v_mfma_f32_16x16x32_bf16 v[76:79], a[208:211], v[220:223], v[76:79]
  v_mfma_f32_16x16x32_bf16 v[96:99], a[208:211], v[224:227], v[96:99]
  v_mfma_f32_16x16x32_bf16 v[132:135], a[208:211], v[228:231], v[132:135]
  v_mfma_f32_16x16x32_bf16 v[152:155], a[208:211], v[232:235], v[152:155]
  v_mfma_f32_16x16x32_bf16 v[80:83], a[212:215], v[220:223], v[80:83]
  v_mfma_f32_16x16x32_bf16 v[100:103], a[212:215], v[224:227], v[100:103]
  v_mfma_f32_16x16x32_bf16 v[136:139], a[212:215], v[228:231], v[136:139]
  v_mfma_f32_16x16x32_bf16 v[156:159], a[212:215], v[232:235], v[156:159]
  s_waitcnt vmcnt(0)
  v_mfma_f32_16x16x32_bf16 v[64:67], a[216:219], v[236:239], v[64:67]
  v_mfma_f32_16x16x32_bf16 v[84:87], a[216:219], v[240:243], v[84:87]
  v_mfma_f32_16x16x32_bf16 v[104:107], a[216:219], v[244:247], v[104:107]
  v_mfma_f32_16x16x32_bf16 v[140:143], a[216:219], v[248:251], v[140:143]
  v_mfma_f32_16x16x32_bf16 v[68:71], a[220:223], v[236:239], v[68:71]
  v_mfma_f32_16x16x32_bf16 v[88:91], a[220:223], v[240:243], v[88:91]
  v_mfma_f32_16x16x32_bf16 v[108:111], a[220:223], v[244:247], v[108:111]
  v_mfma_f32_16x16x32_bf16 v[144:147], a[220:223], v[248:251], v[144:147]
  v_mfma_f32_16x16x32_bf16 v[72:75], a[224:227], v[236:239], v[72:75]
  v_mfma_f32_16x16x32_bf16 v[92:95], a[224:227], v[240:243], v[92:95]
  v_mfma_f32_16x16x32_bf16 v[128:131], a[224:227], v[244:247], v[128:131]
  v_mfma_f32_16x16x32_bf16 v[148:151], a[224:227], v[248:251], v[148:151]
  v_mfma_f32_16x16x32_bf16 v[76:79], a[228:231], v[236:239], v[76:79]
  v_mfma_f32_16x16x32_bf16 v[96:99], a[228:231], v[240:243], v[96:99]
  v_mfma_f32_16x16x32_bf16 v[132:135], a[228:231], v[244:247], v[132:135]
  v_mfma_f32_16x16x32_bf16 v[152:155], a[228:231], v[248:251], v[152:155]
  v_mfma_f32_16x16x32_bf16 v[80:83], a[232:235], v[236:239], v[80:83]
  v_mfma_f32_16x16x32_bf16 v[100:103], a[232:235], v[240:243], v[100:103]
  v_mfma_f32_16x16x32_bf16 v[136:139], a[232:235], v[244:247], v[136:139]
  v_mfma_f32_16x16x32_bf16 v[156:159], a[232:235], v[248:251], v[156:159]
  s_add_u32 s44, s3, 1
  s_and_b32 s44, s44, 3
  s_mul_i32 s45, s44, 15360
  s_cmp_lt_u32 s44, 2
  s_cselect_b32 s46, 0, 34816
  s_add_u32 s45, s45, s46
  s_add_u32 s45, s45, 65536
  v_add_u32 v6, s45, v35
  ds_write_b128 v6, v[84:87] offset:0
  ds_write_b128 v6, v[88:91] offset:1024
  ds_write_b128 v6, v[92:95] offset:2048
  ds_write_b128 v6, v[96:99] offset:3072
  ds_write_b128 v6, v[100:103] offset:4096
  s_add_u32 s44, s3, 2
  s_and_b32 s44, s44, 3
  s_mul_i32 s45, s44, 15360
  s_cmp_lt_u32 s44, 2
  s_cselect_b32 s46, 0, 34816
  s_add_u32 s45, s45, s46
  s_add_u32 s45, s45, 65536
  v_add_u32 v6, s45, v35
  ds_write_b128 v6, v[104:107] offset:5120
  ds_write_b128 v6, v[108:111] offset:6144
  ds_write_b128 v6, v[128:131] offset:7168
  ds_write_b128 v6, v[132:135] offset:8192
  ds_write_b128 v6, v[136:139] offset:9216
  s_add_u32 s44, s3, 3
  s_and_b32 s44, s44, 3
  s_mul_i32 s45, s44, 15360
  s_cmp_lt_u32 s44, 2
  s_cselect_b32 s46, 0, 34816
  s_add_u32 s45, s45, s46
  s_add_u32 s45, s45, 65536
  v_add_u32 v6, s45, v35
  ds_write_b128 v6, v[140:143] offset:10240
  ds_write_b128 v6, v[144:147] offset:11264
  ds_write_b128 v6, v[148:151] offset:12288
  ds_write_b128 v6, v[152:155] offset:13312
  ds_write_b128 v6, v[156:159] offset:14336
  s_mul_i32 s45, s3, 15360
  s_cmp_lt_u32 s3, 2
  s_cselect_b32 s46, 0, 34816
  s_add_u32 s45, s45, s46
  s_add_u32 s45, s45, 65536
  v_add_u32 v6, s45, v35
  v_lshlrev_b32 v2, 16, v8
  v_and_b32 v3, 0xffff0000, v8
  v_add_f32 v64, v64, v2
  v_add_f32 v65, v65, v3
  v_lshlrev_b32 v4, 16, v18
  v_and_b32 v5, 0xffff0000, v18
  v_add_f32 v64, v64, v4
  v_add_f32 v65, v65, v5
  v_lshlrev_b32 v2, 16, v9
  v_and_b32 v3, 0xffff0000, v9
  v_add_f32 v66, v66, v2
  v_add_f32 v67, v67, v3
  v_lshlrev_b32 v4, 16, v19
  v_and_b32 v5, 0xffff0000, v19
  v_add_f32 v66, v66, v4
  v_add_f32 v67, v67, v5
  v_lshlrev_b32 v2, 16, v10
  v_and_b32 v3, 0xffff0000, v10
  v_add_f32 v68, v68, v2
  v_add_f32 v69, v69, v3
  v_lshlrev_b32 v4, 16, v20
  v_and_b32 v5, 0xffff0000, v20
  v_add_f32 v68, v68, v4
  v_add_f32 v69, v69, v5
  v_lshlrev_b32 v2, 16, v11
  v_and_b32 v3, 0xffff0000, v11
  v_add_f32 v70, v70, v2
  v_add_f32 v71, v71, v3
  v_lshlrev_b32 v4, 16, v21
  v_and_b32 v5, 0xffff0000, v21
  v_add_f32 v70, v70, v4
  v_add_f32 v71, v71, v5
  v_lshlrev_b32 v2, 16, v12
  v_and_b32 v3, 0xffff0000, v12
  v_add_f32 v72, v72, v2
  v_add_f32 v73, v73, v3
  v_lshlrev_b32 v4, 16, v22
  v_and_b32 v5, 0xffff0000, v22
  v_add_f32 v72, v72, v4
  v_add_f32 v73, v73, v5
  v_lshlrev_b32 v2, 16, v13
  v_and_b32 v3, 0xffff0000, v13
  v_add_f32 v74, v74, v2
  v_add_f32 v75, v75, v3
  v_lshlrev_b32 v4, 16, v23
  v_and_b32 v5, 0xffff0000, v23
  v_add_f32 v74, v74, v4
  v_add_f32 v75, v75, v5
  v_lshlrev_b32 v2, 16, v14
  v_and_b32 v3, 0xffff0000, v14
  v_add_f32 v76, v76, v2
  v_add_f32 v77, v77, v3
  v_lshlrev_b32 v4, 16, v24
  v_and_b32 v5, 0xffff0000, v24
  v_add_f32 v76, v76, v4
  v_add_f32 v77, v77, v5
  v_lshlrev_b32 v2, 16, v15
  v_and_b32 v3, 0xffff0000, v15
  v_add_f32 v78, v78, v2
  v_add_f32 v79, v79, v3
  v_lshlrev_b32 v4, 16, v25
  v_and_b32 v5, 0xffff0000, v25
  v_add_f32 v78, v78, v4
  v_add_f32 v79, v79, v5
  v_lshlrev_b32 v2, 16, v16
  v_and_b32 v3, 0xffff0000, v16
  v_add_f32 v80, v80, v2
  v_add_f32 v81, v81, v3
  v_lshlrev_b32 v4, 16, v26
  v_and_b32 v5, 0xffff0000, v26
  v_add_f32 v80, v80, v4
  v_add_f32 v81, v81, v5
  v_lshlrev_b32 v2, 16, v17
  v_and_b32 v3, 0xffff0000, v17
  v_add_f32 v82, v82, v2
  v_add_f32 v83, v83, v3
  v_lshlrev_b32 v4, 16, v27
  v_and_b32 v5, 0xffff0000, v27
  v_add_f32 v82, v82, v4
  v_add_f32 v83, v83, v5
  s_waitcnt lgkmcnt(0)
  s_barrier
  ds_read_b128 v[192:195], v6 offset:0
  ds_read_b128 v[196:199], v6 offset:5120
  ds_read_b128 v[200:203], v6 offset:10240
  ds_read_b128 v[204:207], v6 offset:1024
  ds_read_b128 v[208:211], v6 offset:6144
  ds_read_b128 v[212:215], v6 offset:11264
  ds_read_b128 v[216:219], v6 offset:2048
  ds_read_b128 v[220:223], v6 offset:7168
  ds_read_b128 v[224:227], v6 offset:12288
  ds_read_b128 v[228:231], v6 offset:3072
  ds_read_b128 v[232:235], v6 offset:8192
  ds_read_b128 v[236:239], v6 offset:13312
  ds_read_b128 v[240:243], v6 offset:4096
  ds_read_b128 v[244:247], v6 offset:9216
  ds_read_b128 v[248:251], v6 offset:14336
  s_waitcnt lgkmcnt(12)
  v_add_f32 v64, v64, v192
  v_add_f32 v65, v65, v193
  v_add_f32 v66, v66, v194
  v_add_f32 v67, v67, v195
  v_add_f32 v64, v64, v196
  v_add_f32 v65, v65, v197
  v_add_f32 v66, v66, v198
  v_add_f32 v67, v67, v199
  v_add_f32 v64, v64, v200
  v_add_f32 v65, v65, v201
  v_add_f32 v66, v66, v202
  v_add_f32 v67, v67, v203
  v_cvt_pk_bf16_f32 v64, v64, v65
  v_cvt_pk_bf16_f32 v65, v66, v67
  buffer_store_dwordx2 v[64:65], v122, s[20:23], s43 offen offset:0
  s_waitcnt lgkmcnt(9)
  v_add_f32 v68, v68, v204
  v_add_f32 v69, v69, v205
  v_add_f32 v70, v70, v206
  v_add_f32 v71, v71, v207
  v_add_f32 v68, v68, v208
  v_add_f32 v69, v69, v209
  v_add_f32 v70, v70, v210
  v_add_f32 v71, v71, v211
  v_add_f32 v68, v68, v212
  v_add_f32 v69, v69, v213
  v_add_f32 v70, v70, v214
  v_add_f32 v71, v71, v215
  v_cvt_pk_bf16_f32 v68, v68, v69
  v_cvt_pk_bf16_f32 v69, v70, v71
  buffer_store_dwordx2 v[68:69], v122, s[20:23], s43 offen offset:32
  s_waitcnt lgkmcnt(6)
  v_add_f32 v72, v72, v216
  v_add_f32 v73, v73, v217
  v_add_f32 v74, v74, v218
  v_add_f32 v75, v75, v219
  v_add_f32 v72, v72, v220
  v_add_f32 v73, v73, v221
  v_add_f32 v74, v74, v222
  v_add_f32 v75, v75, v223
  v_add_f32 v72, v72, v224
  v_add_f32 v73, v73, v225
  v_add_f32 v74, v74, v226
  v_add_f32 v75, v75, v227
  v_cvt_pk_bf16_f32 v72, v72, v73
  v_cvt_pk_bf16_f32 v73, v74, v75
  buffer_store_dwordx2 v[72:73], v122, s[20:23], s43 offen offset:64
  s_waitcnt lgkmcnt(3)
  v_add_f32 v76, v76, v228
  v_add_f32 v77, v77, v229
  v_add_f32 v78, v78, v230
  v_add_f32 v79, v79, v231
  v_add_f32 v76, v76, v232
  v_add_f32 v77, v77, v233
  v_add_f32 v78, v78, v234
  v_add_f32 v79, v79, v235
  v_add_f32 v76, v76, v236
  v_add_f32 v77, v77, v237
  v_add_f32 v78, v78, v238
  v_add_f32 v79, v79, v239
  v_cvt_pk_bf16_f32 v76, v76, v77
  v_cvt_pk_bf16_f32 v77, v78, v79
  buffer_store_dwordx2 v[76:77], v122, s[20:23], s43 offen offset:96
  s_waitcnt lgkmcnt(0)
  v_add_f32 v80, v80, v240
  v_add_f32 v81, v81, v241
  v_add_f32 v82, v82, v242
  v_add_f32 v83, v83, v243
  v_add_f32 v80, v80, v244
  v_add_f32 v81, v81, v245
  v_add_f32 v82, v82, v246
  v_add_f32 v83, v83, v247
  v_add_f32 v80, v80, v248
  v_add_f32 v81, v81, v249
  v_add_f32 v82, v82, v250
  v_add_f32 v83, v83, v251
  v_cvt_pk_bf16_f32 v80, v80, v81
  v_cvt_pk_bf16_f32 v81, v82, v83
  buffer_store_dwordx2 v[80:81], v122, s[20:23], s43 offen offset:128
  s_cmp_eq_u32 s2, 0
  s_mov_b32 s44, 1073741824
  s_cmov_b32 s44, 23494656
  buffer_store_dword v38, v36, s[8:11], s44 offen sc1
L_end:
  s_endpgm
L_fb:
  s_waitcnt lgkmcnt(0)
  s_nop 15
  v_mov_b32 v200, 0xff7fffff
  v_mov_b32 v201, 0xff7fffff
  ds_read_b128 v[128:131], v31 offset:4096
  ds_read_b64 v[132:133], v32 offset:4096
  v_mov_b32 v134, s86
  ds_read_b128 v[136:139], v31 offset:6144
  ds_read_b64 v[140:141], v32 offset:6144
  v_mov_b32 v142, s87
  s_waitcnt lgkmcnt(2)
  v_mfma_f32_32x32x16_bf16 v[64:79], v[128:131], v[8:11], 0
  v_mfma_f32_32x32x16_bf16 v[64:79], v[132:135], v[12:15], v[64:79]
  v_mfma_f32_32x32x16_bf16 v[80:95], v[128:131], v[16:19], 0
  v_mfma_f32_32x32x16_bf16 v[80:95], v[132:135], v[20:23], v[80:95]
  ds_read_b128 v[128:131], v31 offset:8192
  ds_read_b64 v[132:133], v32 offset:8192
  v_mov_b32 v134, s52
  s_nop 6
  v_max3_f32 v200, v64, v65, v200
  v_max3_f32 v200, v66, v67, v200
  v_max3_f32 v200, v68, v69, v200
  v_max3_f32 v200, v70, v71, v200
  v_max3_f32 v200, v72, v73, v200
  v_max3_f32 v200, v74, v75, v200
  v_max3_f32 v200, v76, v77, v200
  v_max3_f32 v200, v78, v79, v200
  s_waitcnt lgkmcnt(2)
  v_mfma_f32_32x32x16_bf16 v[96:111], v[136:139], v[8:11], 0
  v_mfma_f32_32x32x16_bf16 v[96:111], v[140:143], v[12:15], v[96:111]
  v_max3_f32 v201, v80, v81, v201
  v_max3_f32 v201, v82, v83, v201
  v_max3_f32 v201, v84, v85, v201
  v_max3_f32 v201, v86, v87, v201
  v_max3_f32 v201, v88, v89, v201
  v_max3_f32 v201, v90, v91, v201
  v_max3_f32 v201, v92, v93, v201
  v_max3_f32 v201, v94, v95, v201
  v_mfma_f32_32x32x16_bf16 v[64:79], v[136:139], v[16:19], 0
  v_mfma_f32_32x32x16_bf16 v[64:79], v[140:143], v[20:23], v[64:79]
  ds_read_b128 v[136:139], v31 offset:10240
  ds_read_b64 v[140:141], v32 offset:10240
  v_mov_b32 v142, s53
  v_max3_f32 v200, v96, v97, v200
  v_max3_f32 v200, v98, v99, v200
  v_max3_f32 v200, v100, v101, v200
  v_max3_f32 v200, v102, v103, v200
  v_max3_f32 v200, v104, v105, v200
  v_max3_f32 v200, v106, v107, v200
  v_max3_f32 v200, v108, v109, v200
  v_max3_f32 v200, v110, v111, v200
  s_waitcnt lgkmcnt(2)
  v_mfma_f32_32x32x16_bf16 v[80:95], v[128:131], v[8:11], 0
  v_mfma_f32_32x32x16_bf16 v[80:95], v[132:135], v[12:15], v[80:95]
  v_max3_f32 v201, v64, v65, v201
  v_max3_f32 v201, v66, v67, v201
  v_max3_f32 v201, v68, v69, v201
  v_max3_f32 v201, v70, v71, v201
  v_max3_f32 v201, v72, v73, v201
  v_max3_f32 v201, v74, v75, v201
  v_max3_f32 v201, v76, v77, v201
  v_max3_f32 v201, v78, v79, v201
  v_mfma_f32_32x32x16_bf16 v[96:111], v[128:131], v[16:19], 0
  v_mfma_f32_32x32x16_bf16 v[96:111], v[132:135], v[20:23], v[96:111]
  ds_read_b128 v[128:131], v31 offset:12288
  ds_read_b64 v[132:133], v32 offset:12288
  v_mov_b32 v134, s54
  v_max3_f32 v200, v80, v81, v200
  v_max3_f32 v200, v82, v83, v200
  v_max3_f32 v200, v84, v85, v200
  v_max3_f32 v200, v86, v87, v200
  v_max3_f32 v200, v88, v89, v200
  v_max3_f32 v200, v90, v91, v200
  v_max3_f32 v200, v92, v93, v200
  v_max3_f32 v200, v94, v95, v200
  s_waitcnt lgkmcnt(2)
  v_mfma_f32_32x32x16_bf16 v[64:79], v[136:139], v[8:11], 0
  v_mfma_f32_32x32x16_bf16 v[64:79], v[140:143], v[12:15], v[64:79]
  v_max3_f32 v201, v96, v97, v201
  v_max3_f32 v201, v98, v99, v201
  v_max3_f32 v201, v100, v101, v201
  v_max3_f32 v201, v102, v103, v201
  v_max3_f32 v201, v104, v105, v201
  v_max3_f32 v201, v106, v107, v201
  v_max3_f32 v201, v108, v109, v201
  v_max3_f32 v201, v110, v111, v201
  v_mfma_f32_32x32x16_bf16 v[80:95], v[136:139], v[16:19], 0
  v_mfma_f32_32x32x16_bf16 v[80:95], v[140:143], v[20:23], v[80:95]
  ds_read_b128 v[136:139], v31 offset:14336
  ds_read_b64 v[140:141], v32 offset:14336
  v_mov_b32 v142, s55
  v_max3_f32 v200, v64, v65, v200
  v_max3_f32 v200, v66, v67, v200
  v_max3_f32 v200, v68, v69, v200
  v_max3_f32 v200, v70, v71, v200
  v_max3_f32 v200, v72, v73, v200
  v_max3_f32 v200, v74, v75, v200
  v_max3_f32 v200, v76, v77, v200
  v_max3_f32 v200, v78, v79, v200
  s_waitcnt lgkmcnt(2)
  v_mfma_f32_32x32x16_bf16 v[96:111], v[128:131], v[8:11], 0
  v_mfma_f32_32x32x16_bf16 v[96:111], v[132:135], v[12:15], v[96:111]
  v_max3_f32 v201, v80, v81, v201
  v_max3_f32 v201, v82, v83, v201
  v_max3_f32 v201, v84, v85, v201
  v_max3_f32 v201, v86, v87, v201
  v_max3_f32 v201, v88, v89, v201
  v_max3_f32 v201, v90, v91, v201
  v_max3_f32 v201, v92, v93, v201
  v_max3_f32 v201, v94, v95, v201
  v_mfma_f32_32x32x16_bf16 v[64:79], v[128:131], v[16:19], 0
  v_mfma_f32_32x32x16_bf16 v[64:79], v[132:135], v[20:23], v[64:79]
  ds_read_b128 v[128:131], v31 offset:0
  ds_read_b64 v[132:133], v32 offset:0
  v_mov_b32 v134, s84
  v_max3_f32 v200, v96, v97, v200
  v_max3_f32 v200, v98, v99, v200
  v_max3_f32 v200, v100, v101, v200
  v_max3_f32 v200, v102, v103, v200
  v_max3_f32 v200, v104, v105, v200
  v_max3_f32 v200, v106, v107, v200
  v_max3_f32 v200, v108, v109, v200
  v_max3_f32 v200, v110, v111, v200
  s_waitcnt lgkmcnt(2)
  v_mfma_f32_32x32x16_bf16 v[80:95], v[136:139], v[8:11], 0
  v_mfma_f32_32x32x16_bf16 v[80:95], v[140:143], v[12:15], v[80:95]
  v_max3_f32 v201, v64, v65, v201
  v_max3_f32 v201, v66, v67, v201
  v_max3_f32 v201, v68, v69, v201
  v_max3_f32 v201, v70, v71, v201
  v_max3_f32 v201, v72, v73, v201
  v_max3_f32 v201, v74, v75, v201
  v_max3_f32 v201, v76, v77, v201
  v_max3_f32 v201, v78, v79, v201
  v_mfma_f32_32x32x16_bf16 v[96:111], v[136:139], v[16:19], 0
  v_mfma_f32_32x32x16_bf16 v[96:111], v[140:143], v[20:23], v[96:111]
  ds_read_b128 v[136:139], v31 offset:16384
  ds_read_b64 v[140:141], v32 offset:16384
  v_mov_b32 v142, 1.0
  v_max3_f32 v200, v80, v81, v200
  v_max3_f32 v200, v82, v83, v200
  v_max3_f32 v200, v84, v85, v200
  v_max3_f32 v200, v86, v87, v200
  v_max3_f32 v200, v88, v89, v200
  v_max3_f32 v200, v90, v91, v200
  v_max3_f32 v200, v92, v93, v200
  v_max3_f32 v200, v94, v95, v200
  s_waitcnt lgkmcnt(2)
  v_mfma_f32_32x32x16_bf16 v[64:79], v[128:131], v[8:11], 0
  v_mfma_f32_32x32x16_bf16 v[64:79], v[132:135], v[12:15], v[64:79]
  s_waitcnt lgkmcnt(0)
  v_mfma_f32_32x32x16_bf16 v[80:95], v[136:139], v[8:11], 0
  v_mfma_f32_32x32x16_bf16 v[80:95], v[140:143], v[12:15], v[80:95]
  ds_read_b128 v[128:131], v31 offset:2048
  ds_read_b64 v[132:133], v32 offset:2048
  v_mov_b32 v134, s85
  v_max3_f32 v201, v96, v97, v201
  v_max3_f32 v201, v98, v99, v201
  v_max3_f32 v201, v100, v101, v201
  v_max3_f32 v201, v102, v103, v201
  v_max3_f32 v201, v104, v105, v201
  v_max3_f32 v201, v106, v107, v201
  v_max3_f32 v201, v108, v109, v201
  v_max3_f32 v201, v110, v111, v201
  v_mfma_f32_32x32x16_bf16 v[96:111], v[136:139], v[16:19], 0
  v_mfma_f32_32x32x16_bf16 v[96:111], v[140:143], v[20:23], v[96:111]
  ds_read_b128 v[136:139], v31 offset:18432
  ds_read_b64 v[140:141], v32 offset:18432
  v_mov_b32 v142, 1.0
  v_cndmask_b32 v80, v64, v80, s[12:13]
  v_cndmask_b32 v81, v65, v81, s[14:15]
  v_cndmask_b32 v82, v66, v82, s[16:17]
  v_cndmask_b32 v83, v67, v83, s[18:19]
  v_cndmask_b32 v84, v68, v84, s[60:61]
  v_cndmask_b32 v85, v69, v85, s[62:63]
  v_cndmask_b32 v86, v70, v86, s[64:65]
  v_cndmask_b32 v87, v71, v87, s[66:67]
  v_cndmask_b32 v88, v72, v88, s[68:69]
  v_cndmask_b32 v89, v73, v89, s[70:71]
  v_cndmask_b32 v90, v74, v90, s[74:75]
  v_cndmask_b32 v91, v75, v91, s[76:77]
  v_cndmask_b32 v92, v76, v92, s[78:79]
  v_cndmask_b32 v93, v77, v93, s[80:81]
  v_cndmask_b32 v94, v78, v94, s[28:29]
  v_cndmask_b32 v95, v79, v95, s[30:31]
  v_max3_f32 v200, v80, v81, v200
  v_max3_f32 v200, v82, v83, v200
  v_max3_f32 v200, v84, v85, v200
  v_max3_f32 v200, v86, v87, v200
  v_max3_f32 v200, v88, v89, v200
  v_max3_f32 v200, v90, v91, v200
  v_max3_f32 v200, v92, v93, v200
  v_max3_f32 v200, v94, v95, v200
  s_waitcnt lgkmcnt(2)
  v_mfma_f32_32x32x16_bf16 v[64:79], v[128:131], v[8:11], 0
  v_mfma_f32_32x32x16_bf16 v[64:79], v[132:135], v[12:15], v[64:79]
  v_max3_f32 v201, v96, v97, v201
  v_max3_f32 v201, v98, v99, v201
  v_max3_f32 v201, v100, v101, v201
  v_max3_f32 v201, v102, v103, v201
  v_max3_f32 v201, v104, v105, v201
  v_max3_f32 v201, v106, v107, v201
  v_max3_f32 v201, v108, v109, v201
  v_max3_f32 v201, v110, v111, v201
  v_mfma_f32_32x32x16_bf16 v[80:95], v[128:131], v[16:19], 0
  v_mfma_f32_32x32x16_bf16 v[80:95], v[132:135], v[20:23], v[80:95]
  s_waitcnt lgkmcnt(0)
  v_mfma_f32_32x32x16_bf16 v[96:111], v[136:139], v[16:19], 0
  v_mfma_f32_32x32x16_bf16 v[96:111], v[140:143], v[20:23], v[96:111]
  v_max3_f32 v200, v64, v65, v200
  v_max3_f32 v200, v66, v67, v200
  v_max3_f32 v200, v68, v69, v200
  v_max3_f32 v200, v70, v71, v200
  v_max3_f32 v200, v72, v73, v200
  v_max3_f32 v200, v74, v75, v200
  v_max3_f32 v200, v76, v77, v200
  v_max3_f32 v200, v78, v79, v200
  s_nop 7
  v_cndmask_b32 v96, v80, v96, s[12:13]
  v_cndmask_b32 v97, v81, v97, s[14:15]
  v_cndmask_b32 v98, v82, v98, s[16:17]
  v_cndmask_b32 v99, v83, v99, s[18:19]
  v_cndmask_b32 v100, v84, v100, s[60:61]
  v_cndmask_b32 v101, v85, v101, s[62:63]
  v_cndmask_b32 v102, v86, v102, s[64:65]
  v_cndmask_b32 v103, v87, v103, s[66:67]
  v_cndmask_b32 v104, v88, v104, s[68:69]
  v_cndmask_b32 v105, v89, v105, s[70:71]
  v_cndmask_b32 v106, v90, v106, s[74:75]
  v_cndmask_b32 v107, v91, v107, s[76:77]
  v_cndmask_b32 v108, v92, v108, s[78:79]
  v_cndmask_b32 v109, v93, v109, s[80:81]
  v_cndmask_b32 v110, v94, v110, s[28:29]
  v_cndmask_b32 v111, v95, v111, s[30:31]
  v_max3_f32 v201, v96, v97, v201
  v_max3_f32 v201, v98, v99, v201
  v_max3_f32 v201, v100, v101, v201
  v_max3_f32 v201, v102, v103, v201
  v_max3_f32 v201, v104, v105, v201
  v_max3_f32 v201, v106, v107, v201
  v_max3_f32 v201, v108, v109, v201
  v_max3_f32 v201, v110, v111, v201
  ds_read_b128 v[128:131], v31 offset:4096
  ds_read_b64 v[132:133], v32 offset:4096
  v_mov_b32 v134, s86
  ds_read_b128 v[136:139], v31 offset:6144
  ds_read_b64 v[140:141], v32 offset:6144
  v_mov_b32 v142, s87
  s_mov_b64 exec, s[58:59]
  ds_read_b128 v[40:43], v33 offset:2560
  ds_read_b128 v[44:47], v33 offset:3200
  s_mov_b64 exec, -1
  s_mov_b64 exec, s[58:59]
  ds_read_b128 v[48:51], v33 offset:3840
  ds_read_b128 v[52:55], v33 offset:4480
  s_mov_b64 exec, -1
  v_mov_b32 v202, v200
  s_nop 1
  v_permlane32_swap_b32 v202, v200
  v_max_f32 v200, v202, v200
  v_mul_f32 v200, -v200, v34
  v_cvt_pk_bf16_f32 v14, v34, v200
  v_and_b32 v202, 0xffff0000, v14
  v_sub_f32 v202, v200, v202
  v_cvt_pk_bf16_f32 v15, v202, 0
  v_mov_b32 v202, v201
  s_nop 1
  v_permlane32_swap_b32 v202, v201
  v_max_f32 v201, v202, v201
  v_mul_f32 v201, -v201, v34
  v_cvt_pk_bf16_f32 v22, v34, v201
  v_and_b32 v202, 0xffff0000, v22
  v_sub_f32 v202, v201, v202
  v_cvt_pk_bf16_f32 v23, v202, 0
  s_waitcnt lgkmcnt(6)
  v_mfma_f32_32x32x16_bf16 v[64:79], v[128:131], v[8:11], 0
  v_mfma_f32_32x32x16_bf16 v[64:79], v[132:135], v[12:15], v[64:79]
  s_mov_b64 exec, s[58:59]
  ds_read_b128 v[56:59], v33 offset:5120
  ds_read_b128 v[60:63], v33 offset:5760
  s_mov_b64 exec, -1
  v_mfma_f32_32x32x16_bf16 v[80:95], v[128:131], v[16:19], 0
  s_nop 6
  v_exp_f32 v64, v64
  v_exp_f32 v65, v65
  v_exp_f32 v66, v66
  v_exp_f32 v67, v67
  v_cvt_pk_bf16_f32 v144, v64, v65
  v_exp_f32 v68, v68
  v_exp_f32 v69, v69
  v_cvt_pk_bf16_f32 v145, v66, v67
  v_exp_f32 v70, v70
  v_exp_f32 v71, v71
  v_cvt_pk_bf16_f32 v146, v68, v69
  v_exp_f32 v72, v72
  v_mfma_f32_32x32x16_bf16 v[80:95], v[132:135], v[20:23], v[80:95]
  ds_read_b128 v[128:131], v31 offset:8192
  ds_read_b64 v[132:133], v32 offset:8192
  v_mov_b32 v134, s52
  v_exp_f32 v73, v73
  v_cvt_pk_bf16_f32 v147, v70, v71
  v_exp_f32 v74, v74
  v_exp_f32 v75, v75
  v_cvt_pk_bf16_f32 v148, v72, v73
  v_exp_f32 v76, v76
  v_exp_f32 v77, v77
  v_cvt_pk_bf16_f32 v149, v74, v75
  v_exp_f32 v78, v78
  v_exp_f32 v79, v79
  v_cvt_pk_bf16_f32 v150, v76, v77
  v_cvt_pk_bf16_f32 v151, v78, v79
  s_waitcnt lgkmcnt(6)
  v_mfma_f32_32x32x16_bf16 v[160:175], v[40:43], v[144:147], 0
  v_exp_f32 v80, v80
  v_exp_f32 v81, v81
  v_exp_f32 v82, v82
  v_exp_f32 v83, v83
  v_cvt_pk_bf16_f32 v152, v80, v81
  v_exp_f32 v84, v84
  v_mfma_f32_32x32x16_bf16 v[160:175], v[44:47], v[148:151], v[160:175]
  v_exp_f32 v85, v85
  v_cvt_pk_bf16_f32 v153, v82, v83
  v_exp_f32 v86, v86
  v_exp_f32 v87, v87
  v_cvt_pk_bf16_f32 v154, v84, v85
  v_exp_f32 v88, v88
  v_mfma_f32_32x32x16_bf16 v[96:111], v[136:139], v[8:11], 0
  v_exp_f32 v89, v89
  v_cvt_pk_bf16_f32 v155, v86, v87
  v_exp_f32 v90, v90
  v_exp_f32 v91, v91
  v_cvt_pk_bf16_f32 v156, v88, v89
  v_exp_f32 v92, v92
  v_mfma_f32_32x32x16_bf16 v[96:111], v[140:143], v[12:15], v[96:111]
  v_exp_f32 v93, v93
  v_cvt_pk_bf16_f32 v157, v90, v91
  v_exp_f32 v94, v94
  v_exp_f32 v95, v95
  v_cvt_pk_bf16_f32 v158, v92, v93
  v_cvt_pk_bf16_f32 v159, v94, v95
  v_mfma_f32_32x32x16_bf16 v[176:191], v[40:43], v[152:155], 0
  s_nop 4
  v_exp_f32 v96, v96
  v_exp_f32 v97, v97
  v_exp_f32 v98, v98
  v_exp_f32 v99, v99
  v_cvt_pk_bf16_f32 v144, v96, v97
  v_exp_f32 v100, v100
  v_mfma_f32_32x32x16_bf16 v[176:191], v[44:47], v[156:159], v[176:191]
  v_exp_f32 v101, v101
  v_cvt_pk_bf16_f32 v145, v98, v99
  v_exp_f32 v102, v102
  v_exp_f32 v103, v103
  v_cvt_pk_bf16_f32 v146, v100, v101
  v_exp_f32 v104, v104
  v_mfma_f32_32x32x16_bf16 v[64:79], v[136:139], v[16:19], 0
  v_exp_f32 v105, v105
  v_cvt_pk_bf16_f32 v147, v102, v103
  v_exp_f32 v106, v106
  v_exp_f32 v107, v107
  v_cvt_pk_bf16_f32 v148, v104, v105
  v_exp_f32 v108, v108
  v_mfma_f32_32x32x16_bf16 v[64:79], v[140:143], v[20:23], v[64:79]
  s_mov_b64 exec, s[58:59]
  ds_read_b128 v[40:43], v33 offset:6400
  ds_read_b128 v[44:47], v33 offset:7040
  s_mov_b64 exec, -1
  ds_read_b128 v[136:139], v31 offset:10240
  ds_read_b64 v[140:141], v32 offset:10240
  v_mov_b32 v142, s53
  v_exp_f32 v109, v109
  v_cvt_pk_bf16_f32 v149, v106, v107
  v_exp_f32 v110, v110
  v_exp_f32 v111, v111
  v_cvt_pk_bf16_f32 v150, v108, v109
  v_cvt_pk_bf16_f32 v151, v110, v111
  s_waitcnt lgkmcnt(8)
  v_mfma_f32_32x32x16_bf16 v[160:175], v[48:51], v[144:147], v[160:175]
  v_exp_f32 v64, v64
  v_exp_f32 v65, v65
  v_exp_f32 v66, v66
  v_exp_f32 v67, v67
  v_cvt_pk_bf16_f32 v152, v64, v65
  v_exp_f32 v68, v68
  v_mfma_f32_32x32x16_bf16 v[160:175], v[52:55], v[148:151], v[160:175]
  v_exp_f32 v69, v69
  v_cvt_pk_bf16_f32 v153, v66, v67
  v_exp_f32 v70, v70
  v_exp_f32 v71, v71
  v_cvt_pk_bf16_f32 v154, v68, v69
  v_exp_f32 v72, v72
  s_waitcnt lgkmcnt(4)
  v_mfma_f32_32x32x16_bf16 v[80:95], v[128:131], v[8:11], 0
  v_exp_f32 v73, v73
  v_cvt_pk_bf16_f32 v155, v70, v71
  v_exp_f32 v74, v74
  v_exp_f32 v75, v75
  v_cvt_pk_bf16_f32 v156, v72, v73
  v_exp_f32 v76, v76
  v_mfma_f32_32x32x16_bf16 v[80:95], v[132:135], v[12:15], v[80:95]
  v_exp_f32 v77, v77
  v_cvt_pk_bf16_f32 v157, v74, v75
  v_exp_f32 v78, v78
  v_exp_f32 v79, v79
  v_cvt_pk_bf16_f32 v158, v76, v77
  v_cvt_pk_bf16_f32 v159, v78, v79
  v_mfma_f32_32x32x16_bf16 v[176:191], v[48:51], v[152:155], v[176:191]
  s_nop 4
  v_exp_f32 v80, v80
  v_exp_f32 v81, v81
  v_exp_f32 v82, v82
  v_exp_f32 v83, v83
  v_cvt_pk_bf16_f32 v144, v80, v81
  v_exp_f32 v84, v84
  v_mfma_f32_32x32x16_bf16 v[176:191], v[52:55], v[156:159], v[176:191]
  v_exp_f32 v85, v85
  v_cvt_pk_bf16_f32 v145, v82, v83
  v_exp_f32 v86, v86
  v_exp_f32 v87, v87
  v_cvt_pk_bf16_f32 v146, v84, v85
  v_exp_f32 v88, v88
  v_mfma_f32_32x32x16_bf16 v[96:111], v[128:131], v[16:19], 0
  v_exp_f32 v89, v89
  v_cvt_pk_bf16_f32 v147, v86, v87
  v_exp_f32 v90, v90
  v_exp_f32 v91, v91
  v_cvt_pk_bf16_f32 v148, v88, v89
  v_exp_f32 v92, v92
  v_mfma_f32_32x32x16_bf16 v[96:111], v[132:135], v[20:23], v[96:111]
  s_mov_b64 exec, s[58:59]
  ds_read_b128 v[48:51], v33 offset:7680
  ds_read_b128 v[52:55], v33 offset:8320
  s_mov_b64 exec, -1
  ds_read_b128 v[128:131], v31 offset:12288
  ds_read_b64 v[132:133], v32 offset:12288
  v_mov_b32 v134, s54
  v_exp_f32 v93, v93
  v_cvt_pk_bf16_f32 v149, v90, v91
  v_exp_f32 v94, v94
  v_exp_f32 v95, v95
  v_cvt_pk_bf16_f32 v150, v92, v93
  v_cvt_pk_bf16_f32 v151, v94, v95
  v_mfma_f32_32x32x16_bf16 v[160:175], v[56:59], v[144:147], v[160:175]
  v_exp_f32 v96, v96
  v_exp_f32 v97, v97
  v_exp_f32 v98, v98
  v_exp_f32 v99, v99
  v_cvt_pk_bf16_f32 v152, v96, v97
  v_exp_f32 v100, v100
  v_mfma_f32_32x32x16_bf16 v[160:175], v[60:63], v[148:151], v[160:175]
  v_exp_f32 v101, v101
  v_cvt_pk_bf16_f32 v153, v98, v99
  v_exp_f32 v102, v102
  v_exp_f32 v103, v103
  v_cvt_pk_bf16_f32 v154, v100, v101
  v_exp_f32 v104, v104
  s_waitcnt lgkmcnt(4)
  v_mfma_f32_32x32x16_bf16 v[64:79], v[136:139], v[8:11], 0
  v_exp_f32 v105, v105
  v_cvt_pk_bf16_f32 v155, v102, v103
  v_exp_f32 v106, v106
  v_exp_f32 v107, v107
  v_cvt_pk_bf16_f32 v156, v104, v105
  v_exp_f32 v108, v108
  v_mfma_f32_32x32x16_bf16 v[64:79], v[140:143], v[12:15], v[64:79]
  v_exp_f32 v109, v109
  v_cvt_pk_bf16_f32 v157, v106, v107
  v_exp_f32 v110, v110
  v_exp_f32 v111, v111
  v_cvt_pk_bf16_f32 v158, v108, v109
  v_cvt_pk_bf16_f32 v159, v110, v111
  v_mfma_f32_32x32x16_bf16 v[176:191], v[56:59], v[152:155], v[176:191]
  s_nop 4
  v_exp_f32 v64, v64
  v_exp_f32 v65, v65
  v_exp_f32 v66, v66
  v_exp_f32 v67, v67
  v_cvt_pk_bf16_f32 v144, v64, v65
  v_exp_f32 v68, v68
  v_mfma_f32_32x32x16_bf16 v[176:191], v[60:63], v[156:159], v[176:191]
  v_exp_f32 v69, v69
  v_cvt_pk_bf16_f32 v145, v66, v67
  v_exp_f32 v70, v70
  v_exp_f32 v71, v71
  v_cvt_pk_bf16_f32 v146, v68, v69
  v_exp_f32 v72, v72
  v_mfma_f32_32x32x16_bf16 v[80:95], v[136:139], v[16:19], 0
  v_exp_f32 v73, v73
  v_cvt_pk_bf16_f32 v147, v70, v71
  v_exp_f32 v74, v74
  v_exp_f32 v75, v75
  v_cvt_pk_bf16_f32 v148, v72, v73
  v_exp_f32 v76, v76
  v_mfma_f32_32x32x16_bf16 v[80:95], v[140:143], v[20:23], v[80:95]
  s_mov_b64 exec, s[58:59]
  ds_read_b128 v[56:59], v33 offset:8960
  ds_read_b128 v[60:63], v33 offset:9600
  s_mov_b64 exec, -1
  ds_read_b128 v[136:139], v31 offset:14336
  ds_read_b64 v[140:141], v32 offset:14336
  v_mov_b32 v142, s55
  v_exp_f32 v77, v77
  v_cvt_pk_bf16_f32 v149, v74, v75
  v_exp_f32 v78, v78
  v_exp_f32 v79, v79
  v_cvt_pk_bf16_f32 v150, v76, v77
  v_cvt_pk_bf16_f32 v151, v78, v79
  v_mfma_f32_32x32x16_bf16 v[160:175], v[40:43], v[144:147], v[160:175]
  v_exp_f32 v80, v80
  v_exp_f32 v81, v81
  v_exp_f32 v82, v82
  v_exp_f32 v83, v83
  v_cvt_pk_bf16_f32 v152, v80, v81
  v_exp_f32 v84, v84
  v_mfma_f32_32x32x16_bf16 v[160:175], v[44:47], v[148:151], v[160:175]
  v_exp_f32 v85, v85
  v_cvt_pk_bf16_f32 v153, v82, v83
  v_exp_f32 v86, v86
  v_exp_f32 v87, v87
  v_cvt_pk_bf16_f32 v154, v84, v85
  v_exp_f32 v88, v88
  s_waitcnt lgkmcnt(4)
  v_mfma_f32_32x32x16_bf16 v[96:111], v[128:131], v[8:11], 0
  v_exp_f32 v89, v89
  v_cvt_pk_bf16_f32 v155, v86, v87
  v_exp_f32 v90, v90
  v_exp_f32 v91, v91
  v_cvt_pk_bf16_f32 v156, v88, v89
  v_exp_f32 v92, v92
  v_mfma_f32_32x32x16_bf16 v[96:111], v[132:135], v[12:15], v[96:111]
  v_exp_f32 v93, v93
  v_cvt_pk_bf16_f32 v157, v90, v91
  v_exp_f32 v94, v94
  v_exp_f32 v95, v95
  v_cvt_pk_bf16_f32 v158, v92, v93
  v_cvt_pk_bf16_f32 v159, v94, v95
  v_mfma_f32_32x32x16_bf16 v[176:191], v[40:43], v[152:155], v[176:191]
  s_nop 4
  v_exp_f32 v96, v96
  v_exp_f32 v97, v97
  v_exp_f32 v98, v98
  v_exp_f32 v99, v99
  v_cvt_pk_bf16_f32 v144, v96, v97
  v_exp_f32 v100, v100
  v_mfma_f32_32x32x16_bf16 v[176:191], v[44:47], v[156:159], v[176:191]
  v_exp_f32 v101, v101
  v_cvt_pk_bf16_f32 v145, v98, v99
  v_exp_f32 v102, v102
  v_exp_f32 v103, v103
  v_cvt_pk_bf16_f32 v146, v100, v101
  v_exp_f32 v104, v104
  v_mfma_f32_32x32x16_bf16 v[64:79], v[128:131], v[16:19], 0
  v_exp_f32 v105, v105
  v_cvt_pk_bf16_f32 v147, v102, v103
  v_exp_f32 v106, v106
  v_exp_f32 v107, v107
  v_cvt_pk_bf16_f32 v148, v104, v105
  v_exp_f32 v108, v108
  v_mfma_f32_32x32x16_bf16 v[64:79], v[132:135], v[20:23], v[64:79]
  s_mov_b64 exec, s[58:59]
  ds_read_b128 v[40:43], v33 offset:0
  ds_read_b128 v[44:47], v33 offset:640
  s_mov_b64 exec, -1
  ds_read_b128 v[128:131], v31 offset:0
  ds_read_b64 v[132:133], v32 offset:0
  v_mov_b32 v134, s84
  v_exp_f32 v109, v109
  v_cvt_pk_bf16_f32 v149, v106, v107
  v_exp_f32 v110, v110
  v_exp_f32 v111, v111
  v_cvt_pk_bf16_f32 v150, v108, v109
  v_cvt_pk_bf16_f32 v151, v110, v111
  v_mfma_f32_32x32x16_bf16 v[160:175], v[48:51], v[144:147], v[160:175]
  v_exp_f32 v64, v64
  v_exp_f32 v65, v65
  v_exp_f32 v66, v66
  v_exp_f32 v67, v67
  v_cvt_pk_bf16_f32 v152, v64, v65
  v_exp_f32 v68, v68
  v_mfma_f32_32x32x16_bf16 v[160:175], v[52:55], v[148:151], v[160:175]
  v_exp_f32 v69, v69
  v_cvt_pk_bf16_f32 v153, v66, v67
  v_exp_f32 v70, v70
  v_exp_f32 v71, v71
  v_cvt_pk_bf16_f32 v154, v68, v69
  v_exp_f32 v72, v72
  s_waitcnt lgkmcnt(4)
  v_mfma_f32_32x32x16_bf16 v[80:95], v[136:139], v[8:11], 0
  v_exp_f32 v73, v73
  v_cvt_pk_bf16_f32 v155, v70, v71
  v_exp_f32 v74, v74
  v_exp_f32 v75, v75
  v_cvt_pk_bf16_f32 v156, v72, v73
  v_exp_f32 v76, v76
  v_mfma_f32_32x32x16_bf16 v[80:95], v[140:143], v[12:15], v[80:95]
  v_exp_f32 v77, v77
  v_cvt_pk_bf16_f32 v157, v74, v75
  v_exp_f32 v78, v78
  v_exp_f32 v79, v79
  v_cvt_pk_bf16_f32 v158, v76, v77
  v_cvt_pk_bf16_f32 v159, v78, v79
  v_mfma_f32_32x32x16_bf16 v[176:191], v[48:51], v[152:155], v[176:191]
  s_nop 4
  v_exp_f32 v80, v80
  v_exp_f32 v81, v81
  v_exp_f32 v82, v82
  v_exp_f32 v83, v83
  v_cvt_pk_bf16_f32 v144, v80, v81
  v_exp_f32 v84, v84
  v_mfma_f32_32x32x16_bf16 v[176:191], v[52:55], v[156:159], v[176:191]
  v_exp_f32 v85, v85
  v_cvt_pk_bf16_f32 v145, v82, v83
  v_exp_f32 v86, v86
  v_exp_f32 v87, v87
  v_cvt_pk_bf16_f32 v146, v84, v85
  v_exp_f32 v88, v88
  v_mfma_f32_32x32x16_bf16 v[96:111], v[136:139], v[16:19], 0
  v_exp_f32 v89, v89
  v_cvt_pk_bf16_f32 v147, v86, v87
  v_exp_f32 v90, v90
  v_exp_f32 v91, v91
  v_cvt_pk_bf16_f32 v148, v88, v89
  v_exp_f32 v92, v92
  v_mfma_f32_32x32x16_bf16 v[96:111], v[140:143], v[20:23], v[96:111]
  s_mov_b64 exec, s[58:59]
  ds_read_b128 v[48:51], v33 offset:10240
  ds_read_b128 v[52:55], v33 offset:10880
  s_mov_b64 exec, -1
  ds_read_b128 v[136:139], v31 offset:16384
  ds_read_b64 v[140:141], v32 offset:16384
  v_mov_b32 v142, 1.0
  v_exp_f32 v93, v93
  v_cvt_pk_bf16_f32 v149, v90, v91
  v_exp_f32 v94, v94
  v_exp_f32 v95, v95
  v_cvt_pk_bf16_f32 v150, v92, v93
  v_cvt_pk_bf16_f32 v151, v94, v95
  v_mfma_f32_32x32x16_bf16 v[160:175], v[56:59], v[144:147], v[160:175]
  v_exp_f32 v96, v96
  v_exp_f32 v97, v97
  v_exp_f32 v98, v98
  v_exp_f32 v99, v99
  v_mfma_f32_32x32x16_bf16 v[160:175], v[60:63], v[148:151], v[160:175]
  v_cvt_pk_bf16_f32 v152, v96, v97
  v_exp_f32 v100, v100
  v_exp_f32 v101, v101
  v_cvt_pk_bf16_f32 v153, v98, v99
  s_waitcnt lgkmcnt(4)
  v_mfma_f32_32x32x16_bf16 v[64:79], v[128:131], v[8:11], 0
  v_exp_f32 v102, v102
  v_exp_f32 v103, v103
  v_cvt_pk_bf16_f32 v154, v100, v101
  v_exp_f32 v104, v104
  v_mfma_f32_32x32x16_bf16 v[64:79], v[132:135], v[12:15], v[64:79]
  v_exp_f32 v105, v105
  v_cvt_pk_bf16_f32 v155, v102, v103
  v_exp_f32 v106, v106
  v_exp_f32 v107, v107
  s_waitcnt lgkmcnt(0)
  v_mfma_f32_32x32x16_bf16 v[80:95], v[136:139], v[8:11], 0
  v_cvt_pk_bf16_f32 v156, v104, v105
  v_exp_f32 v108, v108
  v_exp_f32 v109, v109
  v_cvt_pk_bf16_f32 v157, v106, v107
  v_mfma_f32_32x32x16_bf16 v[80:95], v[140:143], v[12:15], v[80:95]
  ds_read_b128 v[128:131], v31 offset:2048
  ds_read_b64 v[132:133], v32 offset:2048
  v_mov_b32 v134, s85
  v_exp_f32 v110, v110
  v_exp_f32 v111, v111
  v_cvt_pk_bf16_f32 v158, v108, v109
  v_cvt_pk_bf16_f32 v159, v110, v111
  v_mfma_f32_32x32x16_bf16 v[176:191], v[56:59], v[152:155], v[176:191]
  s_nop 3
  v_cndmask_b32 v80, v64, v80, s[12:13]
  v_cndmask_b32 v81, v65, v81, s[14:15]
  v_cndmask_b32 v82, v66, v82, s[16:17]
  v_cndmask_b32 v83, v67, v83, s[18:19]
  v_cndmask_b32 v84, v68, v84, s[60:61]
  v_cndmask_b32 v85, v69, v85, s[62:63]
  v_cndmask_b32 v86, v70, v86, s[64:65]
  v_cndmask_b32 v87, v71, v87, s[66:67]
  v_cndmask_b32 v88, v72, v88, s[68:69]
  v_cndmask_b32 v89, v73, v89, s[70:71]
  v_cndmask_b32 v90, v74, v90, s[74:75]
  v_cndmask_b32 v91, v75, v91, s[76:77]
  v_cndmask_b32 v92, v76, v92, s[78:79]
  v_cndmask_b32 v93, v77, v93, s[80:81]
  v_cndmask_b32 v94, v78, v94, s[28:29]
  v_cndmask_b32 v95, v79, v95, s[30:31]
  v_exp_f32 v80, v80
  v_mfma_f32_32x32x16_bf16 v[176:191], v[60:63], v[156:159], v[176:191]
  v_exp_f32 v81, v81
  v_exp_f32 v82, v82
  v_exp_f32 v83, v83
  v_cvt_pk_bf16_f32 v144, v80, v81
  v_exp_f32 v84, v84
  v_exp_f32 v85, v85
  v_cvt_pk_bf16_f32 v145, v82, v83
  v_exp_f32 v86, v86
  v_exp_f32 v87, v87
  v_cvt_pk_bf16_f32 v146, v84, v85
  v_exp_f32 v88, v88
  v_mfma_f32_32x32x16_bf16 v[96:111], v[136:139], v[16:19], 0
  v_exp_f32 v89, v89
  v_cvt_pk_bf16_f32 v147, v86, v87
  v_exp_f32 v90, v90
  v_exp_f32 v91, v91
  v_cvt_pk_bf16_f32 v148, v88, v89
  v_exp_f32 v92, v92
  v_exp_f32 v93, v93
  v_cvt_pk_bf16_f32 v149, v90, v91
  v_exp_f32 v94, v94
  v_exp_f32 v95, v95
  v_mfma_f32_32x32x16_bf16 v[96:111], v[140:143], v[20:23], v[96:111]
  s_mov_b64 exec, s[58:59]
  ds_read_b128 v[56:59], v33 offset:1280
  ds_read_b128 v[60:63], v33 offset:1920
  s_mov_b64 exec, -1
  ds_read_b128 v[136:139], v31 offset:18432
  ds_read_b64 v[140:141], v32 offset:18432
  v_mov_b32 v142, 1.0
  v_cvt_pk_bf16_f32 v150, v92, v93
  v_cvt_pk_bf16_f32 v151, v94, v95
  v_bfi_b32 v64, v192, 0, v144
  v_and_b32 v72, v192, v144
  v_bfi_b32 v65, v193, 0, v145
  v_and_b32 v73, v193, v145
  v_bfi_b32 v66, v194, 0, v146
  v_and_b32 v74, v194, v146
  v_bfi_b32 v67, v195, 0, v147
  v_and_b32 v75, v195, v147
  v_bfi_b32 v68, v196, 0, v148
  v_and_b32 v76, v196, v148
  v_bfi_b32 v69, v197, 0, v149
  v_and_b32 v77, v197, v149
  v_bfi_b32 v70, v198, 0, v150
  v_and_b32 v78, v198, v150
  v_bfi_b32 v71, v199, 0, v151
  v_and_b32 v79, v199, v151
  v_mfma_f32_32x32x16_bf16 v[160:175], v[40:43], v[64:67], v[160:175]
  v_exp_f32 v96, v96
  v_exp_f32 v97, v97
  v_exp_f32 v98, v98
  v_exp_f32 v99, v99
  v_mfma_f32_32x32x16_bf16 v[160:175], v[44:47], v[68:71], v[160:175]
  v_cvt_pk_bf16_f32 v152, v96, v97
  v_exp_f32 v100, v100
  v_exp_f32 v101, v101
  v_cvt_pk_bf16_f32 v153, v98, v99
  v_mfma_f32_32x32x16_bf16 v[160:175], v[48:51], v[72:75], v[160:175]
  v_exp_f32 v102, v102
  v_exp_f32 v103, v103
  v_cvt_pk_bf16_f32 v154, v100, v101
  v_exp_f32 v104, v104
  v_mfma_f32_32x32x16_bf16 v[160:175], v[52:55], v[76:79], v[160:175]
  v_exp_f32 v105, v105
  v_cvt_pk_bf16_f32 v155, v102, v103
  v_exp_f32 v106, v106
  v_exp_f32 v107, v107
  s_waitcnt lgkmcnt(4)
  v_mfma_f32_32x32x16_bf16 v[64:79], v[128:131], v[8:11], 0
  v_cvt_pk_bf16_f32 v156, v104, v105
  v_exp_f32 v108, v108
  v_exp_f32 v109, v109
  v_cvt_pk_bf16_f32 v157, v106, v107
  v_mfma_f32_32x32x16_bf16 v[64:79], v[132:135], v[12:15], v[64:79]
  s_mov_b64 exec, s[58:59]
  ds_read_b128 v[40:43], v33 offset:11520
  ds_read_b128 v[44:47], v33 offset:12160
  s_mov_b64 exec, -1
  v_exp_f32 v110, v110
  v_exp_f32 v111, v111
  v_cvt_pk_bf16_f32 v158, v108, v109
  v_cvt_pk_bf16_f32 v159, v110, v111
  v_mfma_f32_32x32x16_bf16 v[176:191], v[48:51], v[152:155], v[176:191]
  s_nop 2
  v_exp_f32 v64, v64
  v_exp_f32 v65, v65
  v_exp_f32 v66, v66
  v_exp_f32 v67, v67
  v_mfma_f32_32x32x16_bf16 v[176:191], v[52:55], v[156:159], v[176:191]
  v_cvt_pk_bf16_f32 v144, v64, v65
  v_exp_f32 v68, v68
  v_exp_f32 v69, v69
  v_cvt_pk_bf16_f32 v145, v66, v67
  v_mfma_f32_32x32x16_bf16 v[80:95], v[128:131], v[16:19], 0
  v_exp_f32 v70, v70
  v_exp_f32 v71, v71
  v_cvt_pk_bf16_f32 v146, v68, v69
  v_exp_f32 v72, v72
  v_mfma_f32_32x32x16_bf16 v[80:95], v[132:135], v[20:23], v[80:95]
  v_exp_f32 v73, v73
  v_cvt_pk_bf16_f32 v147, v70, v71
  v_exp_f32 v74, v74
  v_exp_f32 v75, v75
  s_waitcnt lgkmcnt(2)
  v_mfma_f32_32x32x16_bf16 v[96:111], v[136:139], v[16:19], 0
  v_cvt_pk_bf16_f32 v148, v72, v73
  v_exp_f32 v76, v76
  v_exp_f32 v77, v77
  v_cvt_pk_bf16_f32 v149, v74, v75
  v_mfma_f32_32x32x16_bf16 v[96:111], v[140:143], v[20:23], v[96:111]
  v_exp_f32 v78, v78
  v_exp_f32 v79, v79
  v_cvt_pk_bf16_f32 v150, v76, v77
  v_cvt_pk_bf16_f32 v151, v78, v79
  v_mfma_f32_32x32x16_bf16 v[160:175], v[56:59], v[144:147], v[160:175]
  s_nop 6
  v_cndmask_b32 v96, v80, v96, s[12:13]
  v_cndmask_b32 v97, v81, v97, s[14:15]
  v_cndmask_b32 v98, v82, v98, s[16:17]
  v_cndmask_b32 v99, v83, v99, s[18:19]
  v_cndmask_b32 v100, v84, v100, s[60:61]
  v_cndmask_b32 v101, v85, v101, s[62:63]
  v_cndmask_b32 v102, v86, v102, s[64:65]
  v_cndmask_b32 v103, v87, v103, s[66:67]
  v_cndmask_b32 v104, v88, v104, s[68:69]
  v_cndmask_b32 v105, v89, v105, s[70:71]
  v_cndmask_b32 v106, v90, v106, s[74:75]
  v_cndmask_b32 v107, v91, v107, s[76:77]
  v_cndmask_b32 v108, v92, v108, s[78:79]
  v_cndmask_b32 v109, v93, v109, s[80:81]
  v_cndmask_b32 v110, v94, v110, s[28:29]
  v_cndmask_b32 v111, v95, v111, s[30:31]
  v_exp_f32 v96, v96
  v_exp_f32 v97, v97
  v_exp_f32 v98, v98
  v_exp_f32 v99, v99
  v_cvt_pk_bf16_f32 v152, v96, v97
  v_exp_f32 v100, v100
  v_exp_f32 v101, v101
  v_cvt_pk_bf16_f32 v153, v98, v99
  v_exp_f32 v102, v102
  v_exp_f32 v103, v103
  v_cvt_pk_bf16_f32 v154, v100, v101
  v_exp_f32 v104, v104
  v_mfma_f32_32x32x16_bf16 v[160:175], v[60:63], v[148:151], v[160:175]
  v_exp_f32 v105, v105
  v_cvt_pk_bf16_f32 v155, v102, v103
  v_exp_f32 v106, v106
  v_exp_f32 v107, v107
  v_cvt_pk_bf16_f32 v156, v104, v105
  v_exp_f32 v108, v108
  v_exp_f32 v109, v109
  v_cvt_pk_bf16_f32 v157, v106, v107
  v_exp_f32 v110, v110
  v_exp_f32 v111, v111
  v_cvt_pk_bf16_f32 v158, v108, v109
  v_cvt_pk_bf16_f32 v159, v110, v111
  v_bfi_b32 v80, v192, 0, v152
  v_and_b32 v88, v192, v152
  v_bfi_b32 v81, v193, 0, v153
  v_and_b32 v89, v193, v153
  v_bfi_b32 v82, v194, 0, v154
  v_and_b32 v90, v194, v154
  v_bfi_b32 v83, v195, 0, v155
  v_and_b32 v91, v195, v155
  v_bfi_b32 v84, v196, 0, v156
  v_and_b32 v92, v196, v156
  v_bfi_b32 v85, v197, 0, v157
  v_and_b32 v93, v197, v157
  v_bfi_b32 v86, v198, 0, v158
  v_and_b32 v94, v198, v158
  v_bfi_b32 v87, v199, 0, v159
  v_and_b32 v95, v199, v159
  v_mfma_f32_32x32x16_bf16 v[176:191], v[56:59], v[80:83], v[176:191]
  v_mfma_f32_32x32x16_bf16 v[176:191], v[60:63], v[84:87], v[176:191]
  s_waitcnt lgkmcnt(0)
  v_mfma_f32_32x32x16_bf16 v[176:191], v[40:43], v[88:91], v[176:191]
  v_mfma_f32_32x32x16_bf16 v[176:191], v[44:47], v[92:95], v[176:191]
  v_mov_b32 v202, v168
  v_mov_b32 v200, v168
  s_nop 1
  v_permlane32_swap_b32 v202, v200
  s_nop 6
  v_mov_b32 v202, v184
  v_mov_b32 v201, v184
  s_nop 1
  v_permlane32_swap_b32 v202, v201
  s_nop 1
  s_branch L_norm
.section .rodata,"a"
.p2align 6
.amdhsa_kernel parallel_sum__sliding_block__mixer_channel_mlp__prompt_kernel
  .amdhsa_next_free_vgpr 512
  .amdhsa_next_free_sgpr 102
  .amdhsa_accum_offset 256
  .amdhsa_group_segment_fixed_size 0
  .amdhsa_kernarg_size 88
  .amdhsa_user_sgpr_count 2
  .amdhsa_user_sgpr_kernarg_segment_ptr 1
  .amdhsa_system_sgpr_workgroup_id_x 1
.end_amdhsa_kernel
```
